```python
import torch

def _softmax(x, axis=-1):
    return torch.softmax(x, dim=axis)
def _gelu(x):
    return torch.nn.functional.gelu(x, approximate="tanh")
def _silu(x):
    return torch.nn.functional.silu(x)
def _sigmoid(x):
    return torch.sigmoid(x)
def _layernorm(x, axis=-1, eps=1e-5):
    m = x.mean(dim=axis, keepdim=True)
    v = x.var(dim=axis, keepdim=True, unbiased=False)
    return (x - m) / torch.sqrt(v + eps)
def _scatter_add(tgt, idx, src, axis=0):
    return tgt.clone().index_add_(axis, idx, src)
def _segment_sum(src, seg, n):
    out = torch.zeros((n,) + src.shape[1:], dtype=src.dtype)
    return out.index_add_(0, seg, src)
def _pad(x, pw):
    flat = tuple(v for pair in reversed(pw) for v in pair)
    return torch.nn.functional.pad(x, flat)

kernel_name = 'concat_heads__mha_block_cached__mha_block_cached__near_ridge'

def setup_inputs():

    _w = (lambda a: (lambda t: t.to(torch.bfloat16) if t.is_floating_point() else t)(torch.as_tensor(a)))
    def _A_setup():
        B, Sq, D = 8, 144, 512
        H, Sk, Dh = 32, 512, 128
        return {
            "x": _w((lambda *s: torch.randn(*s, dtype=torch.bfloat16) * 0.8)(B, Sq, D)),
            "k_cache": _w((lambda *s: torch.randn(*s, dtype=torch.bfloat16) * 0.8)(B, H, Sk, Dh)),
            "v_cache": _w((lambda *s: torch.randn(*s, dtype=torch.bfloat16) * 0.05)(B, H, Sk, Dh)),
            "wq": _w((lambda *s: torch.randn(*s, dtype=torch.bfloat16) * 0.8)(D, H * Dh) * (D ** -0.5)),
            "wo": _w((lambda *s: torch.randn(*s, dtype=torch.bfloat16) * 0.05)(H * Dh, D) * ((H * Dh) ** -0.5)),
        }
    _A_in = _A_setup()

    def _B_setup():
        B, Sq, D = 8, 144, 512
        H, Sk, Dh = 32, 512, 128
        return {
            "x": _w((lambda *s: torch.randn(*s, dtype=torch.bfloat16) * 0.8)(B, Sq, D)),
            "k_cache": _w((lambda *s: torch.randn(*s, dtype=torch.bfloat16) * 0.8)(B, H, Sk, Dh)),
            "v_cache": _w((lambda *s: torch.randn(*s, dtype=torch.bfloat16) * 0.05)(B, H, Sk, Dh)),
            "wq": _w((lambda *s: torch.randn(*s, dtype=torch.bfloat16) * 0.8)(D, H * Dh) * (D ** -0.5)),
            "wo": _w((lambda *s: torch.randn(*s, dtype=torch.bfloat16) * 0.05)(H * Dh, D) * ((H * Dh) ** -0.5)),
        }
    _B_in = _B_setup()

    return {
        "A_x": _A_in["x"],
        "A_k_cache": _A_in["k_cache"],
        "A_v_cache": _A_in["v_cache"],
        "A_wq": _A_in["wq"],
        "A_wo": _A_in["wo"],
        "B_x": _B_in["x"],
        "B_k_cache": _B_in["k_cache"],
        "B_v_cache": _B_in["v_cache"],
        "B_wq": _B_in["wq"],
        "B_wo": _B_in["wo"],
    }

def reference(A_x, A_k_cache, A_v_cache, A_wq, A_wo, B_x, B_k_cache, B_v_cache, B_wq, B_wo):
    def _A_ref(x, k_cache, v_cache, wq, wo):
        B, Sq, D = x.shape
        H, Dh = 32, 128
        q = (lambda x, *d: x.permute(*d))((x @ wq).reshape(B, Sq, H, Dh), 0, 2, 1, 3)
        scores = torch.einsum("bhqd,bhkd->bhqk", q, k_cache) * (Dh ** -0.5)
        p = _softmax(scores, axis=-1)
        o = torch.einsum("bhqk,bhkd->bhqd", p, v_cache)
        return (lambda x, *d: x.permute(*d))(o, 0, 2, 1, 3).reshape(B, Sq, H * Dh) @ wo

    def _B_ref(x, k_cache, v_cache, wq, wo):
        B, Sq, D = x.shape
        H, Dh = 32, 128
        q = (lambda x, *d: x.permute(*d))((x @ wq).reshape(B, Sq, H, Dh), 0, 2, 1, 3)
        scores = torch.einsum("bhqd,bhkd->bhqk", q, k_cache) * (Dh ** -0.5)
        p = _softmax(scores, axis=-1)
        o = torch.einsum("bhqk,bhkd->bhqd", p, v_cache)
        return (lambda x, *d: x.permute(*d))(o, 0, 2, 1, 3).reshape(B, Sq, H * Dh) @ wo

    a = _A_ref(A_x, A_k_cache, A_v_cache, A_wq, A_wo)
    b = _B_ref(B_x, B_k_cache, B_v_cache, B_wq, B_wo)
    return torch.concatenate([a, b], axis=-1)
```

```asm
; @launch kernel=attn_kernel grid=(512,1,1) block=(256,1,1) lds=81920
; @launch kernel=oproj_kernel grid=(256,1,1) block=(512,1,1) lds=131072
; @launch kernel=reduce_kernel grid=(640,1,1) block=(256,1,1) lds=0
.amdgcn_target "amdgcn-amd-amdhsa--gfx950"
.text
.globl attn_kernel
.p2align 8
.type attn_kernel,@function
attn_kernel:
    s_cmp_ge_u32 s2, 512
    s_cbranch_scc1 L1_done
    s_load_dwordx16 s[4:19], s[0:1], 0
    s_load_dwordx8 s[20:27], s[0:1], 64
    s_load_dwordx2 s[28:29], s[0:1], 96
    s_cmp_ge_u32 s2, 256
    s_cbranch_scc0 L1_pra
    s_setprio 1
L1_pra:
    s_and_b32 s34, s2, 7
    s_lshr_b32 s35, s2, 3
    s_lshr_b32 s30, s34, 2
    s_and_b32 s34, s34, 3
    s_lshl_b32 s34, s34, 3
    s_and_b32 s31, s35, 7
    s_add_u32 s31, s31, s34
    s_lshr_b32 s32, s35, 3
    v_and_b32 v255, 63, v0
    v_lshrrev_b32 v249, 6, v0
    s_nop 0
    v_readfirstlane_b32 s33, v249
    s_waitcnt lgkmcnt(0)
    s_cmp_eq_u32 s30, 0
    s_cselect_b64 s[4:5], s[4:5], s[14:15]
    s_cselect_b64 s[6:7], s[6:7], s[16:17]
    s_cselect_b64 s[8:9], s[8:9], s[18:19]
    s_cselect_b64 s[10:11], s[10:11], s[20:21]
    s_lshl_b32 s34, s32, 5
    s_add_u32 s34, s34, s31
    s_lshl_b32 s34, s34, 17
    s_add_u32 s36, s6, s34
    s_addc_u32 s37, s7, 0
    s_and_b32 s37, s37, 0xffff
    s_mov_b32 s38, 131072
    s_mov_b32 s39, 0x00020000
    s_add_u32 s40, s8, s34
    s_addc_u32 s41, s9, 0
    s_and_b32 s41, s41, 0xffff
    s_mov_b32 s42, 131072
    s_mov_b32 s43, 0x00020000
    s_lshl_b32 s34, s31, 8
    s_sub_u32 s35, 4194304, s34
    s_add_u32 s44, s10, s34
    s_addc_u32 s45, s11, 0
    s_and_b32 s45, s45, 0xffff
    s_mov_b32 s46, s35
    s_mov_b32 s47, 0x00020000
    s_mul_i32 s35, s32, 147456
    s_add_u32 s48, s4, s35
    s_addc_u32 s49, s5, 0
    s_and_b32 s49, s49, 0xffff
    s_mov_b32 s50, 147456
    s_mov_b32 s51, 0x00020000
    s_mul_i32 s35, s30, 9437184
    s_lshl_b32 s56, s32, 5
    s_add_u32 s56, s56, s31
    s_mul_i32 s56, s56, 36864
    s_add_u32 s35, s35, s56
    s_add_u32 s52, s28, s35
    s_addc_u32 s53, s29, 0
    s_and_b32 s53, s53, 0xffff
    s_mov_b32 s54, 36864
    s_mov_b32 s55, 0x00020000
    s_lshr_b32 s68, s2, 3
    s_add_u32 s68, s68, s32
    s_lshl_b32 s68, s68, 1
    s_and_b32 s68, s68, 15
    s_lshr_b32 s69, s68, 1
    s_mov_b32 s56, 0x3e0293ee
    s_mov_b32 s71, 0x41000000
    s_lshl_b32 s57, s33, 10
    s_lshl_b32 s70, s33, 12
    v_lshrrev_b32 v249, 4, v255
    v_and_b32 v250, 15, v255
    s_lshl_b32 s58, s33, 2
    v_add_u32 v251, s58, v249
    v_xor_b32 v252, v250, v251
    v_lshlrev_b32 v252, 4, v252
    v_lshl_add_u32 v247, v251, 8, v252
    v_and_b32 v252, 7, v251
    v_lshlrev_b32 v252, 1, v252
    v_xor_b32 v252, v250, v252
    v_lshlrev_b32 v252, 4, v252
    v_lshl_add_u32 v248, v251, 8, v252
    v_lshlrev_b32 v252, 4, v250
    v_lshl_add_u32 v92, v251, 8, v252
    v_lshrrev_b32 v249, 4, v255
    v_and_b32 v250, 15, v255
    s_and_b32 s64, s33, 1
    s_lshl_b32 s64, s64, 2
    v_or_b32 v251, s64, v249
    v_lshrrev_b32 v252, 1, v250
    v_xor_b32 v251, v251, v252
    v_lshlrev_b32 v251, 5, v251
    v_and_b32 v252, 1, v255
    v_lshl_add_u32 v251, v252, 4, v251
    v_mul_u32_u24 v252, 8192, v249
    v_add_u32 v80, v251, v252
    v_mov_b32 v81, v80
    s_lshl_b32 s64, s33, 2
    v_add_u32 v251, s64, v249
    v_xor_b32 v251, v251, v255
    v_and_b32 v251, 7, v251
    v_lshlrev_b32 v251, 4, v251
    v_lshrrev_b32 v252, 3, v255
    s_lshl_b32 s64, s33, 3
    v_add_u32 v252, s64, v252
    v_lshl_add_u32 v82, v252, 10, v251
    v_lshrrev_b32 v251, 1, v250
    v_xor_b32 v251, v251, v249
    v_lshlrev_b32 v251, 4, v251
    v_lshl_add_u32 v251, v250, 7, v251
    v_add_u32 v83, 40960, v251
    v_xor_b32 v84, 64, v83
    s_lshl_b32 s64, s33, 12
    v_add_u32 v85, s64, v83
    v_add_u32 v86, s64, v84
    v_bfe_u32 v250, v255, 2, 2
    v_and_b32 v251, 1, v249
    v_lshl_add_u32 v251, v251, 2, v250
    v_lshl_add_u32 v252, v249, 3, v250
    s_lshl_b32 s64, s33, 1
    v_xor_b32 v251, s64, v251
    v_lshlrev_b32 v251, 5, v251
    v_lshl_add_u32 v251, v252, 8, v251
    v_and_b32 v252, 3, v255
    v_lshl_add_u32 v72, v252, 3, v251
    v_xor_b32 v73, 32, v72
    v_xor_b32 v74, 64, v72
    v_xor_b32 v75, 96, v72
    v_xor_b32 v76, 128, v72
    v_xor_b32 v77, 160, v72
    v_xor_b32 v78, 192, v72
    v_xor_b32 v79, 224, v72
    s_lshl_b32 s60, s33, 13
    s_mul_i32 s62, s33, 65536
    s_lshl_b32 s63, s33, 11
    s_lshl_b32 s67, s33, 10
    s_add_u32 s65, s68, 0
    s_and_b32 s65, s65, 15
    s_mul_i32 s64, s65, 262144
    s_add_u32 s64, s64, s62
    s_add_u32 m0, s63, 32768
    s_nop 0
    buffer_load_dwordx4 v80, s[44:47], s64 offen lds
    s_add_u32 m0, s63, 33792
    s_add_u32 s64, s64, 32768
    buffer_load_dwordx4 v81, s[44:47], s64 offen lds
    s_add_u32 s65, s68, 0
    s_and_b32 s65, s65, 15
    s_lshl_b32 s66, s65, 6
    s_add_u32 m0, s67, 61440
    s_nop 0
    buffer_load_dwordx4 v82, s[48:51], s66 offen lds
    s_add_u32 m0, s67, 65536
    s_add_u32 s66, s66, 32768
    buffer_load_dwordx4 v82, s[48:51], s66 offen lds
    s_add_u32 m0, s67, 69632
    s_add_u32 s66, s66, 32768
    buffer_load_dwordx4 v82, s[48:51], s66 offen lds
    s_add_u32 m0, s67, 73728
    s_add_u32 s66, s66, 32768
    buffer_load_dwordx4 v82, s[48:51], s66 offen lds
    s_add_u32 m0, s67, 77824
    s_add_u32 s66, s66, 32768
    buffer_load_dwordx4 v82, s[48:51], s66 offen lds
    s_add_u32 s65, s68, 1
    s_and_b32 s65, s65, 15
    s_mul_i32 s64, s65, 262144
    s_add_u32 s64, s64, s62
    s_add_u32 m0, s63, 0
    s_nop 0
    buffer_load_dwordx4 v80, s[44:47], s64 offen lds
    s_add_u32 m0, s63, 1024
    s_add_u32 s64, s64, 32768
    buffer_load_dwordx4 v81, s[44:47], s64 offen lds
    s_waitcnt vmcnt(2)
    s_barrier
    s_add_u32 s65, s68, 2
    s_and_b32 s65, s65, 15
    s_mul_i32 s64, s65, 262144
    s_add_u32 s64, s64, s62
    s_add_u32 m0, s63, 8192
    s_nop 0
    buffer_load_dwordx4 v80, s[44:47], s64 offen lds
    s_add_u32 m0, s63, 9216
    s_add_u32 s64, s64, 32768
    buffer_load_dwordx4 v81, s[44:47], s64 offen lds
    s_add_u32 s65, s68, 3
    s_and_b32 s65, s65, 15
    s_mul_i32 s64, s65, 262144
    s_add_u32 s64, s64, s62
    s_add_u32 m0, s63, 16384
    s_nop 0
    buffer_load_dwordx4 v80, s[44:47], s64 offen lds
    s_add_u32 m0, s63, 17408
    s_add_u32 s64, s64, 32768
    buffer_load_dwordx4 v81, s[44:47], s64 offen lds
    s_add_u32 s65, s68, 2
    s_and_b32 s65, s65, 15
    s_lshl_b32 s66, s65, 6
    s_add_u32 m0, s67, 40960
    s_nop 0
    buffer_load_dwordx4 v82, s[48:51], s66 offen lds
    s_add_u32 m0, s67, 45056
    s_add_u32 s66, s66, 32768
    buffer_load_dwordx4 v82, s[48:51], s66 offen lds
    s_add_u32 m0, s67, 49152
    s_add_u32 s66, s66, 32768
    buffer_load_dwordx4 v82, s[48:51], s66 offen lds
    s_add_u32 m0, s67, 53248
    s_add_u32 s66, s66, 32768
    buffer_load_dwordx4 v82, s[48:51], s66 offen lds
    s_add_u32 m0, s67, 57344
    s_add_u32 s66, s66, 32768
    buffer_load_dwordx4 v82, s[48:51], s66 offen lds
    ds_read_b64_tr_b16 v[144:145], v72 offset:32768
    ds_read_b64_tr_b16 v[146:147], v72 offset:33792
    ds_read_b64_tr_b16 v[148:149], v73 offset:32768
    ds_read_b64_tr_b16 v[150:151], v73 offset:33792
    ds_read_b64_tr_b16 v[152:153], v74 offset:32768
    ds_read_b64_tr_b16 v[154:155], v74 offset:33792
    ds_read_b64_tr_b16 v[156:157], v75 offset:32768
    ds_read_b64_tr_b16 v[158:159], v75 offset:33792
    ds_read_b64_tr_b16 v[160:161], v76 offset:32768
    ds_read_b64_tr_b16 v[162:163], v76 offset:33792
    ds_read_b64_tr_b16 v[164:165], v77 offset:32768
    ds_read_b64_tr_b16 v[166:167], v77 offset:33792
    ds_read_b64_tr_b16 v[168:169], v78 offset:32768
    ds_read_b64_tr_b16 v[170:171], v78 offset:33792
    ds_read_b64_tr_b16 v[172:173], v79 offset:32768
    ds_read_b64_tr_b16 v[174:175], v79 offset:33792
    ds_read_b128 v[96:99], v85 offset:20480
    ds_read_b128 v[100:103], v85 offset:22528
    ds_read_b128 v[104:107], v83 offset:36864
    ds_read_b128 v[108:111], v86 offset:20480
    ds_read_b128 v[112:115], v86 offset:22528
    ds_read_b128 v[116:119], v84 offset:36864
    s_waitcnt vmcnt(9) lgkmcnt(0)
    s_barrier
    s_add_u32 s65, s68, 4
    s_and_b32 s65, s65, 15
    s_mul_i32 s64, s65, 262144
    s_add_u32 s64, s64, s62
    s_add_u32 m0, s63, 24576
    s_nop 0
    buffer_load_dwordx4 v80, s[44:47], s64 offen lds
    s_add_u32 m0, s63, 25600
    s_add_u32 s64, s64, 32768
    buffer_load_dwordx4 v81, s[44:47], s64 offen lds
    s_add_u32 s65, s68, 5
    s_and_b32 s65, s65, 15
    s_mul_i32 s64, s65, 262144
    s_add_u32 s64, s64, s62
    s_add_u32 m0, s63, 32768
    s_nop 0
    buffer_load_dwordx4 v80, s[44:47], s64 offen lds
    s_add_u32 m0, s63, 33792
    s_add_u32 s64, s64, 32768
    buffer_load_dwordx4 v81, s[44:47], s64 offen lds
    s_add_u32 s65, s68, 4
    s_and_b32 s65, s65, 15
    s_lshl_b32 s66, s65, 6
    s_add_u32 m0, s67, 61440
    s_nop 0
    buffer_load_dwordx4 v82, s[48:51], s66 offen lds
    s_add_u32 m0, s67, 65536
    s_add_u32 s66, s66, 32768
    buffer_load_dwordx4 v82, s[48:51], s66 offen lds
    s_add_u32 m0, s67, 69632
    s_add_u32 s66, s66, 32768
    buffer_load_dwordx4 v82, s[48:51], s66 offen lds
    s_add_u32 m0, s67, 73728
    s_add_u32 s66, s66, 32768
    buffer_load_dwordx4 v82, s[48:51], s66 offen lds
    s_add_u32 m0, s67, 77824
    s_add_u32 s66, s66, 32768
    buffer_load_dwordx4 v82, s[48:51], s66 offen lds
    ds_read_b64_tr_b16 v[176:177], v72 offset:0
    ds_read_b64_tr_b16 v[178:179], v72 offset:1024
    v_mfma_f32_16x16x32_bf16 v[0:3], v[144:147], v[96:99], 0
    v_mfma_f32_16x16x32_bf16 v[32:35], v[144:147], v[100:103], 0
    v_mfma_f32_16x16x32_bf16 v[64:67], v[144:147], v[104:107], 0
    ds_read_b64_tr_b16 v[180:181], v73 offset:0
    ds_read_b64_tr_b16 v[182:183], v73 offset:1024
    v_mfma_f32_16x16x32_bf16 v[4:7], v[148:151], v[96:99], 0
    v_mfma_f32_16x16x32_bf16 v[36:39], v[148:151], v[100:103], 0
    v_mfma_f32_16x16x32_bf16 v[68:71], v[148:151], v[104:107], 0
    ds_read_b64_tr_b16 v[184:185], v74 offset:0
    ds_read_b64_tr_b16 v[186:187], v74 offset:1024
    v_mfma_f32_16x16x32_bf16 v[8:11], v[152:155], v[96:99], 0
    v_mfma_f32_16x16x32_bf16 v[40:43], v[152:155], v[100:103], 0
    ds_read_b64_tr_b16 v[188:189], v75 offset:0
    ds_read_b64_tr_b16 v[190:191], v75 offset:1024
    v_mfma_f32_16x16x32_bf16 v[12:15], v[156:159], v[96:99], 0
    v_mfma_f32_16x16x32_bf16 v[44:47], v[156:159], v[100:103], 0
    ds_read_b64_tr_b16 v[192:193], v76 offset:0
    ds_read_b64_tr_b16 v[194:195], v76 offset:1024
    v_mfma_f32_16x16x32_bf16 v[16:19], v[160:163], v[96:99], 0
    v_mfma_f32_16x16x32_bf16 v[48:51], v[160:163], v[100:103], 0
    ds_read_b64_tr_b16 v[196:197], v77 offset:0
    ds_read_b64_tr_b16 v[198:199], v77 offset:1024
    v_mfma_f32_16x16x32_bf16 v[20:23], v[164:167], v[96:99], 0
    v_mfma_f32_16x16x32_bf16 v[52:55], v[164:167], v[100:103], 0
    ds_read_b64_tr_b16 v[200:201], v78 offset:0
    ds_read_b64_tr_b16 v[202:203], v78 offset:1024
    v_mfma_f32_16x16x32_bf16 v[24:27], v[168:171], v[96:99], 0
    v_mfma_f32_16x16x32_bf16 v[56:59], v[168:171], v[100:103], 0
    ds_read_b64_tr_b16 v[204:205], v79 offset:0
    ds_read_b64_tr_b16 v[206:207], v79 offset:1024
    v_mfma_f32_16x16x32_bf16 v[28:31], v[172:175], v[96:99], 0
    v_mfma_f32_16x16x32_bf16 v[60:63], v[172:175], v[100:103], 0
    s_waitcnt vmcnt(9) lgkmcnt(0)
    s_barrier
    s_add_u32 s65, s68, 6
    s_and_b32 s65, s65, 15
    s_mul_i32 s64, s65, 262144
    s_add_u32 s64, s64, s62
    s_add_u32 m0, s63, 0
    s_nop 0
    buffer_load_dwordx4 v80, s[44:47], s64 offen lds
    s_add_u32 m0, s63, 1024
    s_add_u32 s64, s64, 32768
    buffer_load_dwordx4 v81, s[44:47], s64 offen lds
    s_lshl_b32 s59, s69, 14
    buffer_load_dwordx4 v[208:211], v92, s[36:39], s59 offen nt
    s_lshl_b32 s59, s69, 14
    s_add_u32 s59, s59, 4096
    buffer_load_dwordx4 v[212:215], v92, s[36:39], s59 offen nt
    ds_read_b64_tr_b16 v[144:145], v72 offset:8192
    ds_read_b64_tr_b16 v[146:147], v72 offset:9216
    ds_read_b128 v[120:123], v85 offset:0
    v_mfma_f32_16x16x32_bf16 v[0:3], v[176:179], v[108:111], v[0:3]
    v_mfma_f32_16x16x32_bf16 v[32:35], v[176:179], v[112:115], v[32:35]
    v_mfma_f32_16x16x32_bf16 v[64:67], v[176:179], v[116:119], v[64:67]
    ds_read_b64_tr_b16 v[148:149], v73 offset:8192
    ds_read_b64_tr_b16 v[150:151], v73 offset:9216
    ds_read_b128 v[124:127], v85 offset:2048
    v_mfma_f32_16x16x32_bf16 v[4:7], v[180:183], v[108:111], v[4:7]
    v_mfma_f32_16x16x32_bf16 v[36:39], v[180:183], v[112:115], v[36:39]
    v_mfma_f32_16x16x32_bf16 v[68:71], v[180:183], v[116:119], v[68:71]
    ds_read_b64_tr_b16 v[152:153], v74 offset:8192
    ds_read_b64_tr_b16 v[154:155], v74 offset:9216
    ds_read_b128 v[128:131], v83 offset:16384
    v_mfma_f32_16x16x32_bf16 v[8:11], v[184:187], v[108:111], v[8:11]
    v_mfma_f32_16x16x32_bf16 v[40:43], v[184:187], v[112:115], v[40:43]
    ds_read_b64_tr_b16 v[156:157], v75 offset:8192
    ds_read_b64_tr_b16 v[158:159], v75 offset:9216
    ds_read_b128 v[132:135], v86 offset:0
    v_mfma_f32_16x16x32_bf16 v[12:15], v[188:191], v[108:111], v[12:15]
    v_mfma_f32_16x16x32_bf16 v[44:47], v[188:191], v[112:115], v[44:47]
    ds_read_b64_tr_b16 v[160:161], v76 offset:8192
    ds_read_b64_tr_b16 v[162:163], v76 offset:9216
    ds_read_b128 v[136:139], v86 offset:2048
    v_mfma_f32_16x16x32_bf16 v[16:19], v[192:195], v[108:111], v[16:19]
    v_mfma_f32_16x16x32_bf16 v[48:51], v[192:195], v[112:115], v[48:51]
    ds_read_b64_tr_b16 v[164:165], v77 offset:8192
    ds_read_b64_tr_b16 v[166:167], v77 offset:9216
    ds_read_b128 v[140:143], v84 offset:16384
    v_mfma_f32_16x16x32_bf16 v[20:23], v[196:199], v[108:111], v[20:23]
    v_mfma_f32_16x16x32_bf16 v[52:55], v[196:199], v[112:115], v[52:55]
    ds_read_b64_tr_b16 v[168:169], v78 offset:8192
    ds_read_b64_tr_b16 v[170:171], v78 offset:9216
    v_mfma_f32_16x16x32_bf16 v[24:27], v[200:203], v[108:111], v[24:27]
    v_mfma_f32_16x16x32_bf16 v[56:59], v[200:203], v[112:115], v[56:59]
    ds_read_b64_tr_b16 v[172:173], v79 offset:8192
    ds_read_b64_tr_b16 v[174:175], v79 offset:9216
    v_mfma_f32_16x16x32_bf16 v[28:31], v[204:207], v[108:111], v[28:31]
    v_mfma_f32_16x16x32_bf16 v[60:63], v[204:207], v[112:115], v[60:63]
    s_waitcnt vmcnt(13) lgkmcnt(0)
    s_barrier
    s_add_u32 s65, s68, 7
    s_and_b32 s65, s65, 15
    s_mul_i32 s64, s65, 262144
    s_add_u32 s64, s64, s62
    s_add_u32 m0, s63, 8192
    s_nop 0
    buffer_load_dwordx4 v80, s[44:47], s64 offen lds
    s_add_u32 m0, s63, 9216
    s_add_u32 s64, s64, 32768
    buffer_load_dwordx4 v81, s[44:47], s64 offen lds
    s_add_u32 s65, s68, 6
    s_and_b32 s65, s65, 15
    s_lshl_b32 s66, s65, 6
    s_add_u32 m0, s67, 40960
    s_nop 0
    buffer_load_dwordx4 v82, s[48:51], s66 offen lds
    s_add_u32 m0, s67, 45056
    s_add_u32 s66, s66, 32768
    buffer_load_dwordx4 v82, s[48:51], s66 offen lds
    s_add_u32 m0, s67, 49152
    s_add_u32 s66, s66, 32768
    buffer_load_dwordx4 v82, s[48:51], s66 offen lds
    s_add_u32 m0, s67, 53248
    s_add_u32 s66, s66, 32768
    buffer_load_dwordx4 v82, s[48:51], s66 offen lds
    s_add_u32 m0, s67, 57344
    s_add_u32 s66, s66, 32768
    buffer_load_dwordx4 v82, s[48:51], s66 offen lds
    ds_read_b64_tr_b16 v[176:177], v72 offset:16384
    ds_read_b64_tr_b16 v[178:179], v72 offset:17408
    v_mfma_f32_16x16x32_bf16 v[0:3], v[144:147], v[120:123], v[0:3]
    v_mfma_f32_16x16x32_bf16 v[32:35], v[144:147], v[124:127], v[32:35]
    v_mfma_f32_16x16x32_bf16 v[64:67], v[144:147], v[128:131], v[64:67]
    ds_read_b64_tr_b16 v[180:181], v73 offset:16384
    ds_read_b64_tr_b16 v[182:183], v73 offset:17408
    v_mfma_f32_16x16x32_bf16 v[4:7], v[148:151], v[120:123], v[4:7]
    v_mfma_f32_16x16x32_bf16 v[36:39], v[148:151], v[124:127], v[36:39]
    v_mfma_f32_16x16x32_bf16 v[68:71], v[148:151], v[128:131], v[68:71]
    ds_read_b64_tr_b16 v[184:185], v74 offset:16384
    ds_read_b64_tr_b16 v[186:187], v74 offset:17408
    v_mfma_f32_16x16x32_bf16 v[8:11], v[152:155], v[120:123], v[8:11]
    v_mfma_f32_16x16x32_bf16 v[40:43], v[152:155], v[124:127], v[40:43]
    ds_read_b64_tr_b16 v[188:189], v75 offset:16384
    ds_read_b64_tr_b16 v[190:191], v75 offset:17408
    v_mfma_f32_16x16x32_bf16 v[12:15], v[156:159], v[120:123], v[12:15]
    v_mfma_f32_16x16x32_bf16 v[44:47], v[156:159], v[124:127], v[44:47]
    ds_read_b64_tr_b16 v[192:193], v76 offset:16384
    ds_read_b64_tr_b16 v[194:195], v76 offset:17408
    v_mfma_f32_16x16x32_bf16 v[16:19], v[160:163], v[120:123], v[16:19]
    v_mfma_f32_16x16x32_bf16 v[48:51], v[160:163], v[124:127], v[48:51]
    ds_read_b64_tr_b16 v[196:197], v77 offset:16384
    ds_read_b64_tr_b16 v[198:199], v77 offset:17408
    v_mfma_f32_16x16x32_bf16 v[20:23], v[164:167], v[120:123], v[20:23]
    v_mfma_f32_16x16x32_bf16 v[52:55], v[164:167], v[124:127], v[52:55]
    ds_read_b64_tr_b16 v[200:201], v78 offset:16384
    ds_read_b64_tr_b16 v[202:203], v78 offset:17408
    v_mfma_f32_16x16x32_bf16 v[24:27], v[168:171], v[120:123], v[24:27]
    v_mfma_f32_16x16x32_bf16 v[56:59], v[168:171], v[124:127], v[56:59]
    ds_read_b64_tr_b16 v[204:205], v79 offset:16384
    ds_read_b64_tr_b16 v[206:207], v79 offset:17408
    v_mfma_f32_16x16x32_bf16 v[28:31], v[172:175], v[120:123], v[28:31]
    v_mfma_f32_16x16x32_bf16 v[60:63], v[172:175], v[124:127], v[60:63]
    s_waitcnt vmcnt(11) lgkmcnt(0)
    s_barrier
    s_add_u32 s65, s68, 8
    s_and_b32 s65, s65, 15
    s_mul_i32 s64, s65, 262144
    s_add_u32 s64, s64, s62
    s_add_u32 m0, s63, 16384
    s_nop 0
    buffer_load_dwordx4 v80, s[44:47], s64 offen lds
    s_add_u32 m0, s63, 17408
    s_add_u32 s64, s64, 32768
    buffer_load_dwordx4 v81, s[44:47], s64 offen lds
    s_lshl_b32 s59, s69, 14
    s_add_u32 s59, s59, 8192
    buffer_load_dwordx4 v[216:219], v92, s[36:39], s59 offen nt
    s_lshl_b32 s59, s69, 14
    s_add_u32 s59, s59, 12288
    buffer_load_dwordx4 v[220:223], v92, s[36:39], s59 offen nt
    ds_read_b64_tr_b16 v[144:145], v72 offset:24576
    ds_read_b64_tr_b16 v[146:147], v72 offset:25600
    ds_read_b128 v[96:99], v85 offset:20480
    v_mfma_f32_16x16x32_bf16 v[0:3], v[176:179], v[132:135], v[0:3]
    v_mfma_f32_16x16x32_bf16 v[32:35], v[176:179], v[136:139], v[32:35]
    v_mfma_f32_16x16x32_bf16 v[64:67], v[176:179], v[140:143], v[64:67]
    ds_read_b64_tr_b16 v[148:149], v73 offset:24576
    ds_read_b64_tr_b16 v[150:151], v73 offset:25600
    ds_read_b128 v[100:103], v85 offset:22528
    v_mfma_f32_16x16x32_bf16 v[4:7], v[180:183], v[132:135], v[4:7]
    v_mfma_f32_16x16x32_bf16 v[36:39], v[180:183], v[136:139], v[36:39]
    v_mfma_f32_16x16x32_bf16 v[68:71], v[180:183], v[140:143], v[68:71]
    ds_read_b64_tr_b16 v[152:153], v74 offset:24576
    ds_read_b64_tr_b16 v[154:155], v74 offset:25600
    ds_read_b128 v[104:107], v83 offset:36864
    v_mfma_f32_16x16x32_bf16 v[8:11], v[184:187], v[132:135], v[8:11]
    v_mfma_f32_16x16x32_bf16 v[40:43], v[184:187], v[136:139], v[40:43]
    ds_read_b64_tr_b16 v[156:157], v75 offset:24576
    ds_read_b64_tr_b16 v[158:159], v75 offset:25600
    ds_read_b128 v[108:111], v86 offset:20480
    v_mfma_f32_16x16x32_bf16 v[12:15], v[188:191], v[132:135], v[12:15]
    v_mfma_f32_16x16x32_bf16 v[44:47], v[188:191], v[136:139], v[44:47]
    ds_read_b64_tr_b16 v[160:161], v76 offset:24576
    ds_read_b64_tr_b16 v[162:163], v76 offset:25600
    ds_read_b128 v[112:115], v86 offset:22528
    v_mfma_f32_16x16x32_bf16 v[16:19], v[192:195], v[132:135], v[16:19]
    v_mfma_f32_16x16x32_bf16 v[48:51], v[192:195], v[136:139], v[48:51]
    ds_read_b64_tr_b16 v[164:165], v77 offset:24576
    ds_read_b64_tr_b16 v[166:167], v77 offset:25600
    ds_read_b128 v[116:119], v84 offset:36864
    v_mfma_f32_16x16x32_bf16 v[20:23], v[196:199], v[132:135], v[20:23]
    v_mfma_f32_16x16x32_bf16 v[52:55], v[196:199], v[136:139], v[52:55]
    ds_read_b64_tr_b16 v[168:169], v78 offset:24576
    ds_read_b64_tr_b16 v[170:171], v78 offset:25600
    v_mfma_f32_16x16x32_bf16 v[24:27], v[200:203], v[132:135], v[24:27]
    v_mfma_f32_16x16x32_bf16 v[56:59], v[200:203], v[136:139], v[56:59]
    ds_read_b64_tr_b16 v[172:173], v79 offset:24576
    ds_read_b64_tr_b16 v[174:175], v79 offset:25600
    v_mfma_f32_16x16x32_bf16 v[28:31], v[204:207], v[132:135], v[28:31]
    v_mfma_f32_16x16x32_bf16 v[60:63], v[204:207], v[136:139], v[60:63]
    s_waitcnt vmcnt(15) lgkmcnt(0)
    s_barrier
    s_add_u32 s65, s68, 9
    s_and_b32 s65, s65, 15
    s_mul_i32 s64, s65, 262144
    s_add_u32 s64, s64, s62
    s_add_u32 m0, s63, 24576
    s_nop 0
    buffer_load_dwordx4 v80, s[44:47], s64 offen lds
    s_add_u32 m0, s63, 25600
    s_add_u32 s64, s64, 32768
    buffer_load_dwordx4 v81, s[44:47], s64 offen lds
    s_add_u32 s65, s68, 8
    s_and_b32 s65, s65, 15
    s_lshl_b32 s66, s65, 6
    s_add_u32 m0, s67, 61440
    s_nop 0
    buffer_load_dwordx4 v82, s[48:51], s66 offen lds
    s_add_u32 m0, s67, 65536
    s_add_u32 s66, s66, 32768
    buffer_load_dwordx4 v82, s[48:51], s66 offen lds
    s_add_u32 m0, s67, 69632
    s_add_u32 s66, s66, 32768
    buffer_load_dwordx4 v82, s[48:51], s66 offen lds
    s_add_u32 m0, s67, 73728
    s_add_u32 s66, s66, 32768
    buffer_load_dwordx4 v82, s[48:51], s66 offen lds
    s_add_u32 m0, s67, 77824
    s_add_u32 s66, s66, 32768
    buffer_load_dwordx4 v82, s[48:51], s66 offen lds
    ds_read_b64_tr_b16 v[176:177], v72 offset:32768
    ds_read_b64_tr_b16 v[178:179], v72 offset:33792
    v_mfma_f32_16x16x32_bf16 v[0:3], v[144:147], v[96:99], v[0:3]
    v_mfma_f32_16x16x32_bf16 v[32:35], v[144:147], v[100:103], v[32:35]
    v_mfma_f32_16x16x32_bf16 v[64:67], v[144:147], v[104:107], v[64:67]
    ds_read_b64_tr_b16 v[180:181], v73 offset:32768
    ds_read_b64_tr_b16 v[182:183], v73 offset:33792
    v_mfma_f32_16x16x32_bf16 v[4:7], v[148:151], v[96:99], v[4:7]
    v_mfma_f32_16x16x32_bf16 v[36:39], v[148:151], v[100:103], v[36:39]
    v_mfma_f32_16x16x32_bf16 v[68:71], v[148:151], v[104:107], v[68:71]
    ds_read_b64_tr_b16 v[184:185], v74 offset:32768
    ds_read_b64_tr_b16 v[186:187], v74 offset:33792
    v_mfma_f32_16x16x32_bf16 v[8:11], v[152:155], v[96:99], v[8:11]
    v_mfma_f32_16x16x32_bf16 v[40:43], v[152:155], v[100:103], v[40:43]
    ds_read_b64_tr_b16 v[188:189], v75 offset:32768
    ds_read_b64_tr_b16 v[190:191], v75 offset:33792
    v_mfma_f32_16x16x32_bf16 v[12:15], v[156:159], v[96:99], v[12:15]
    v_mfma_f32_16x16x32_bf16 v[44:47], v[156:159], v[100:103], v[44:47]
    ds_read_b64_tr_b16 v[192:193], v76 offset:32768
    ds_read_b64_tr_b16 v[194:195], v76 offset:33792
    v_mfma_f32_16x16x32_bf16 v[16:19], v[160:163], v[96:99], v[16:19]
    v_mfma_f32_16x16x32_bf16 v[48:51], v[160:163], v[100:103], v[48:51]
    ds_read_b64_tr_b16 v[196:197], v77 offset:32768
    ds_read_b64_tr_b16 v[198:199], v77 offset:33792
    v_mfma_f32_16x16x32_bf16 v[20:23], v[164:167], v[96:99], v[20:23]
    v_mfma_f32_16x16x32_bf16 v[52:55], v[164:167], v[100:103], v[52:55]
    ds_read_b64_tr_b16 v[200:201], v78 offset:32768
    ds_read_b64_tr_b16 v[202:203], v78 offset:33792
    v_mfma_f32_16x16x32_bf16 v[24:27], v[168:171], v[96:99], v[24:27]
    v_mfma_f32_16x16x32_bf16 v[56:59], v[168:171], v[100:103], v[56:59]
    ds_read_b64_tr_b16 v[204:205], v79 offset:32768
    ds_read_b64_tr_b16 v[206:207], v79 offset:33792
    v_mfma_f32_16x16x32_bf16 v[28:31], v[172:175], v[96:99], v[28:31]
    v_mfma_f32_16x16x32_bf16 v[60:63], v[172:175], v[100:103], v[60:63]
    s_waitcnt vmcnt(11) lgkmcnt(0)
    s_barrier
    s_add_u32 s65, s68, 10
    s_and_b32 s65, s65, 15
    s_mul_i32 s64, s65, 262144
    s_add_u32 s64, s64, s62
    s_add_u32 m0, s63, 32768
    s_nop 0
    buffer_load_dwordx4 v80, s[44:47], s64 offen lds
    s_add_u32 m0, s63, 33792
    s_add_u32 s64, s64, 32768
    buffer_load_dwordx4 v81, s[44:47], s64 offen lds
    s_lshl_b32 s59, s69, 14
    buffer_load_dwordx4 v[224:227], v92, s[40:43], s59 offen nt
    s_lshl_b32 s59, s69, 14
    s_add_u32 s59, s59, 4096
    buffer_load_dwordx4 v[228:231], v92, s[40:43], s59 offen nt
    ds_read_b64_tr_b16 v[144:145], v72 offset:0
    ds_read_b64_tr_b16 v[146:147], v72 offset:1024
    ds_read_b128 v[120:123], v85 offset:0
    v_mfma_f32_16x16x32_bf16 v[0:3], v[176:179], v[108:111], v[0:3]
    v_mfma_f32_16x16x32_bf16 v[32:35], v[176:179], v[112:115], v[32:35]
    v_mfma_f32_16x16x32_bf16 v[64:67], v[176:179], v[116:119], v[64:67]
    ds_read_b64_tr_b16 v[148:149], v73 offset:0
    ds_read_b64_tr_b16 v[150:151], v73 offset:1024
    ds_read_b128 v[124:127], v85 offset:2048
    v_mfma_f32_16x16x32_bf16 v[4:7], v[180:183], v[108:111], v[4:7]
    v_mfma_f32_16x16x32_bf16 v[36:39], v[180:183], v[112:115], v[36:39]
    v_mfma_f32_16x16x32_bf16 v[68:71], v[180:183], v[116:119], v[68:71]
    ds_read_b64_tr_b16 v[152:153], v74 offset:0
    ds_read_b64_tr_b16 v[154:155], v74 offset:1024
    ds_read_b128 v[128:131], v83 offset:16384
    v_mfma_f32_16x16x32_bf16 v[8:11], v[184:187], v[108:111], v[8:11]
    v_mfma_f32_16x16x32_bf16 v[40:43], v[184:187], v[112:115], v[40:43]
    ds_read_b64_tr_b16 v[156:157], v75 offset:0
    ds_read_b64_tr_b16 v[158:159], v75 offset:1024
    ds_read_b128 v[132:135], v86 offset:0
    v_mfma_f32_16x16x32_bf16 v[12:15], v[188:191], v[108:111], v[12:15]
    v_mfma_f32_16x16x32_bf16 v[44:47], v[188:191], v[112:115], v[44:47]
    ds_read_b64_tr_b16 v[160:161], v76 offset:0
    ds_read_b64_tr_b16 v[162:163], v76 offset:1024
    ds_read_b128 v[136:139], v86 offset:2048
    v_mfma_f32_16x16x32_bf16 v[16:19], v[192:195], v[108:111], v[16:19]
    v_mfma_f32_16x16x32_bf16 v[48:51], v[192:195], v[112:115], v[48:51]
    ds_read_b64_tr_b16 v[164:165], v77 offset:0
    ds_read_b64_tr_b16 v[166:167], v77 offset:1024
    ds_read_b128 v[140:143], v84 offset:16384
    v_mfma_f32_16x16x32_bf16 v[20:23], v[196:199], v[108:111], v[20:23]
    v_mfma_f32_16x16x32_bf16 v[52:55], v[196:199], v[112:115], v[52:55]
    ds_read_b64_tr_b16 v[168:169], v78 offset:0
    ds_read_b64_tr_b16 v[170:171], v78 offset:1024
    v_mfma_f32_16x16x32_bf16 v[24:27], v[200:203], v[108:111], v[24:27]
    v_mfma_f32_16x16x32_bf16 v[56:59], v[200:203], v[112:115], v[56:59]
    ds_read_b64_tr_b16 v[172:173], v79 offset:0
    ds_read_b64_tr_b16 v[174:175], v79 offset:1024
    v_mfma_f32_16x16x32_bf16 v[28:31], v[204:207], v[108:111], v[28:31]
    v_mfma_f32_16x16x32_bf16 v[60:63], v[204:207], v[112:115], v[60:63]
    s_waitcnt vmcnt(15) lgkmcnt(0)
    s_barrier
    s_add_u32 s65, s68, 11
    s_and_b32 s65, s65, 15
    s_mul_i32 s64, s65, 262144
    s_add_u32 s64, s64, s62
    s_add_u32 m0, s63, 0
    s_nop 0
    buffer_load_dwordx4 v80, s[44:47], s64 offen lds
    s_add_u32 m0, s63, 1024
    s_add_u32 s64, s64, 32768
    buffer_load_dwordx4 v81, s[44:47], s64 offen lds
    s_add_u32 s65, s68, 10
    s_and_b32 s65, s65, 15
    s_lshl_b32 s66, s65, 6
    s_add_u32 m0, s67, 40960
    s_nop 0
    buffer_load_dwordx4 v82, s[48:51], s66 offen lds
    s_add_u32 m0, s67, 45056
    s_add_u32 s66, s66, 32768
    buffer_load_dwordx4 v82, s[48:51], s66 offen lds
    s_add_u32 m0, s67, 49152
    s_add_u32 s66, s66, 32768
    buffer_load_dwordx4 v82, s[48:51], s66 offen lds
    s_add_u32 m0, s67, 53248
    s_add_u32 s66, s66, 32768
    buffer_load_dwordx4 v82, s[48:51], s66 offen lds
    s_add_u32 m0, s67, 57344
    s_add_u32 s66, s66, 32768
    buffer_load_dwordx4 v82, s[48:51], s66 offen lds
    ds_read_b64_tr_b16 v[176:177], v72 offset:8192
    ds_read_b64_tr_b16 v[178:179], v72 offset:9216
    v_mfma_f32_16x16x32_bf16 v[0:3], v[144:147], v[120:123], v[0:3]
    v_mfma_f32_16x16x32_bf16 v[32:35], v[144:147], v[124:127], v[32:35]
    v_mfma_f32_16x16x32_bf16 v[64:67], v[144:147], v[128:131], v[64:67]
    ds_read_b64_tr_b16 v[180:181], v73 offset:8192
    ds_read_b64_tr_b16 v[182:183], v73 offset:9216
    v_mfma_f32_16x16x32_bf16 v[4:7], v[148:151], v[120:123], v[4:7]
    v_mfma_f32_16x16x32_bf16 v[36:39], v[148:151], v[124:127], v[36:39]
    v_mfma_f32_16x16x32_bf16 v[68:71], v[148:151], v[128:131], v[68:71]
    ds_read_b64_tr_b16 v[184:185], v74 offset:8192
    ds_read_b64_tr_b16 v[186:187], v74 offset:9216
    v_mfma_f32_16x16x32_bf16 v[8:11], v[152:155], v[120:123], v[8:11]
    v_mfma_f32_16x16x32_bf16 v[40:43], v[152:155], v[124:127], v[40:43]
    ds_read_b64_tr_b16 v[188:189], v75 offset:8192
    ds_read_b64_tr_b16 v[190:191], v75 offset:9216
    v_mfma_f32_16x16x32_bf16 v[12:15], v[156:159], v[120:123], v[12:15]
    v_mfma_f32_16x16x32_bf16 v[44:47], v[156:159], v[124:127], v[44:47]
    ds_read_b64_tr_b16 v[192:193], v76 offset:8192
    ds_read_b64_tr_b16 v[194:195], v76 offset:9216
    v_mfma_f32_16x16x32_bf16 v[16:19], v[160:163], v[120:123], v[16:19]
    v_mfma_f32_16x16x32_bf16 v[48:51], v[160:163], v[124:127], v[48:51]
    ds_read_b64_tr_b16 v[196:197], v77 offset:8192
    ds_read_b64_tr_b16 v[198:199], v77 offset:9216
    v_mfma_f32_16x16x32_bf16 v[20:23], v[164:167], v[120:123], v[20:23]
    v_mfma_f32_16x16x32_bf16 v[52:55], v[164:167], v[124:127], v[52:55]
    ds_read_b64_tr_b16 v[200:201], v78 offset:8192
    ds_read_b64_tr_b16 v[202:203], v78 offset:9216
    v_mfma_f32_16x16x32_bf16 v[24:27], v[168:171], v[120:123], v[24:27]
    v_mfma_f32_16x16x32_bf16 v[56:59], v[168:171], v[124:127], v[56:59]
    ds_read_b64_tr_b16 v[204:205], v79 offset:8192
    ds_read_b64_tr_b16 v[206:207], v79 offset:9216
    v_mfma_f32_16x16x32_bf16 v[28:31], v[172:175], v[120:123], v[28:31]
    v_mfma_f32_16x16x32_bf16 v[60:63], v[172:175], v[124:127], v[60:63]
    s_waitcnt vmcnt(11) lgkmcnt(0)
    s_barrier
    s_add_u32 s65, s68, 12
    s_and_b32 s65, s65, 15
    s_mul_i32 s64, s65, 262144
    s_add_u32 s64, s64, s62
    s_add_u32 m0, s63, 8192
    s_nop 0
    buffer_load_dwordx4 v80, s[44:47], s64 offen lds
    s_add_u32 m0, s63, 9216
    s_add_u32 s64, s64, 32768
    buffer_load_dwordx4 v81, s[44:47], s64 offen lds
    s_lshl_b32 s59, s69, 14
    s_add_u32 s59, s59, 8192
    buffer_load_dwordx4 v[232:235], v92, s[40:43], s59 offen nt
    s_lshl_b32 s59, s69, 14
    s_add_u32 s59, s59, 12288
    buffer_load_dwordx4 v[236:239], v92, s[40:43], s59 offen nt
    ds_read_b64_tr_b16 v[144:145], v72 offset:16384
    ds_read_b64_tr_b16 v[146:147], v72 offset:17408
    ds_read_b128 v[96:99], v85 offset:20480
    v_mfma_f32_16x16x32_bf16 v[0:3], v[176:179], v[132:135], v[0:3]
    v_mfma_f32_16x16x32_bf16 v[32:35], v[176:179], v[136:139], v[32:35]
    v_mfma_f32_16x16x32_bf16 v[64:67], v[176:179], v[140:143], v[64:67]
    ds_read_b64_tr_b16 v[148:149], v73 offset:16384
    ds_read_b64_tr_b16 v[150:151], v73 offset:17408
    ds_read_b128 v[100:103], v85 offset:22528
    v_mfma_f32_16x16x32_bf16 v[4:7], v[180:183], v[132:135], v[4:7]
    v_mfma_f32_16x16x32_bf16 v[36:39], v[180:183], v[136:139], v[36:39]
    v_mfma_f32_16x16x32_bf16 v[68:71], v[180:183], v[140:143], v[68:71]
    ds_read_b64_tr_b16 v[152:153], v74 offset:16384
    ds_read_b64_tr_b16 v[154:155], v74 offset:17408
    ds_read_b128 v[104:107], v83 offset:36864
    v_mfma_f32_16x16x32_bf16 v[8:11], v[184:187], v[132:135], v[8:11]
    v_mfma_f32_16x16x32_bf16 v[40:43], v[184:187], v[136:139], v[40:43]
    ds_read_b64_tr_b16 v[156:157], v75 offset:16384
    ds_read_b64_tr_b16 v[158:159], v75 offset:17408
    ds_read_b128 v[108:111], v86 offset:20480
    v_mfma_f32_16x16x32_bf16 v[12:15], v[188:191], v[132:135], v[12:15]
    v_mfma_f32_16x16x32_bf16 v[44:47], v[188:191], v[136:139], v[44:47]
    ds_read_b64_tr_b16 v[160:161], v76 offset:16384
    ds_read_b64_tr_b16 v[162:163], v76 offset:17408
    ds_read_b128 v[112:115], v86 offset:22528
    v_mfma_f32_16x16x32_bf16 v[16:19], v[192:195], v[132:135], v[16:19]
    v_mfma_f32_16x16x32_bf16 v[48:51], v[192:195], v[136:139], v[48:51]
    ds_read_b64_tr_b16 v[164:165], v77 offset:16384
    ds_read_b64_tr_b16 v[166:167], v77 offset:17408
    ds_read_b128 v[116:119], v84 offset:36864
    v_mfma_f32_16x16x32_bf16 v[20:23], v[196:199], v[132:135], v[20:23]
    v_mfma_f32_16x16x32_bf16 v[52:55], v[196:199], v[136:139], v[52:55]
    ds_read_b64_tr_b16 v[168:169], v78 offset:16384
    ds_read_b64_tr_b16 v[170:171], v78 offset:17408
    v_mfma_f32_16x16x32_bf16 v[24:27], v[200:203], v[132:135], v[24:27]
    v_mfma_f32_16x16x32_bf16 v[56:59], v[200:203], v[136:139], v[56:59]
    ds_read_b64_tr_b16 v[172:173], v79 offset:16384
    ds_read_b64_tr_b16 v[174:175], v79 offset:17408
    v_mfma_f32_16x16x32_bf16 v[28:31], v[204:207], v[132:135], v[28:31]
    v_mfma_f32_16x16x32_bf16 v[60:63], v[204:207], v[136:139], v[60:63]
    s_waitcnt vmcnt(15) lgkmcnt(0)
    s_barrier
    s_add_u32 s65, s68, 13
    s_and_b32 s65, s65, 15
    s_mul_i32 s64, s65, 262144
    s_add_u32 s64, s64, s62
    s_add_u32 m0, s63, 16384
    s_nop 0
    buffer_load_dwordx4 v80, s[44:47], s64 offen lds
    s_add_u32 m0, s63, 17408
    s_add_u32 s64, s64, 32768
    buffer_load_dwordx4 v81, s[44:47], s64 offen lds
    s_add_u32 s65, s68, 12
    s_and_b32 s65, s65, 15
    s_lshl_b32 s66, s65, 6
    s_add_u32 m0, s67, 61440
    s_nop 0
    buffer_load_dwordx4 v82, s[48:51], s66 offen lds
    s_add_u32 m0, s67, 65536
    s_add_u32 s66, s66, 32768
    buffer_load_dwordx4 v82, s[48:51], s66 offen lds
    s_add_u32 m0, s67, 69632
    s_add_u32 s66, s66, 32768
    buffer_load_dwordx4 v82, s[48:51], s66 offen lds
    s_add_u32 m0, s67, 73728
    s_add_u32 s66, s66, 32768
    buffer_load_dwordx4 v82, s[48:51], s66 offen lds
    s_add_u32 m0, s67, 77824
    s_add_u32 s66, s66, 32768
    buffer_load_dwordx4 v82, s[48:51], s66 offen lds
    ds_read_b64_tr_b16 v[176:177], v72 offset:24576
    ds_read_b64_tr_b16 v[178:179], v72 offset:25600
    v_mfma_f32_16x16x32_bf16 v[0:3], v[144:147], v[96:99], v[0:3]
    v_mfma_f32_16x16x32_bf16 v[32:35], v[144:147], v[100:103], v[32:35]
    v_mfma_f32_16x16x32_bf16 v[64:67], v[144:147], v[104:107], v[64:67]
    ds_read_b64_tr_b16 v[180:181], v73 offset:24576
    ds_read_b64_tr_b16 v[182:183], v73 offset:25600
    v_mfma_f32_16x16x32_bf16 v[4:7], v[148:151], v[96:99], v[4:7]
    v_mfma_f32_16x16x32_bf16 v[36:39], v[148:151], v[100:103], v[36:39]
    v_mfma_f32_16x16x32_bf16 v[68:71], v[148:151], v[104:107], v[68:71]
    ds_read_b64_tr_b16 v[184:185], v74 offset:24576
    ds_read_b64_tr_b16 v[186:187], v74 offset:25600
    v_mfma_f32_16x16x32_bf16 v[8:11], v[152:155], v[96:99], v[8:11]
    v_mfma_f32_16x16x32_bf16 v[40:43], v[152:155], v[100:103], v[40:43]
    ds_read_b64_tr_b16 v[188:189], v75 offset:24576
    ds_read_b64_tr_b16 v[190:191], v75 offset:25600
    v_mfma_f32_16x16x32_bf16 v[12:15], v[156:159], v[96:99], v[12:15]
    v_mfma_f32_16x16x32_bf16 v[44:47], v[156:159], v[100:103], v[44:47]
    ds_read_b64_tr_b16 v[192:193], v76 offset:24576
    ds_read_b64_tr_b16 v[194:195], v76 offset:25600
    v_mfma_f32_16x16x32_bf16 v[16:19], v[160:163], v[96:99], v[16:19]
    v_mfma_f32_16x16x32_bf16 v[48:51], v[160:163], v[100:103], v[48:51]
    ds_read_b64_tr_b16 v[196:197], v77 offset:24576
    ds_read_b64_tr_b16 v[198:199], v77 offset:25600
    v_mfma_f32_16x16x32_bf16 v[20:23], v[164:167], v[96:99], v[20:23]
    v_mfma_f32_16x16x32_bf16 v[52:55], v[164:167], v[100:103], v[52:55]
    ds_read_b64_tr_b16 v[200:201], v78 offset:24576
    ds_read_b64_tr_b16 v[202:203], v78 offset:25600
    v_mfma_f32_16x16x32_bf16 v[24:27], v[168:171], v[96:99], v[24:27]
    v_mfma_f32_16x16x32_bf16 v[56:59], v[168:171], v[100:103], v[56:59]
    ds_read_b64_tr_b16 v[204:205], v79 offset:24576
    ds_read_b64_tr_b16 v[206:207], v79 offset:25600
    v_mfma_f32_16x16x32_bf16 v[28:31], v[172:175], v[96:99], v[28:31]
    v_mfma_f32_16x16x32_bf16 v[60:63], v[172:175], v[100:103], v[60:63]
    s_waitcnt vmcnt(11) lgkmcnt(0)
    s_barrier
    s_add_u32 s65, s68, 14
    s_and_b32 s65, s65, 15
    s_mul_i32 s64, s65, 262144
    s_add_u32 s64, s64, s62
    s_add_u32 m0, s63, 24576
    s_nop 0
    buffer_load_dwordx4 v80, s[44:47], s64 offen lds
    s_add_u32 m0, s63, 25600
    s_add_u32 s64, s64, 32768
    buffer_load_dwordx4 v81, s[44:47], s64 offen lds
    ds_read_b64_tr_b16 v[144:145], v72 offset:32768
    ds_read_b64_tr_b16 v[146:147], v72 offset:33792
    ds_read_b128 v[120:123], v85 offset:0
    v_mfma_f32_16x16x32_bf16 v[0:3], v[176:179], v[108:111], v[0:3]
    v_mfma_f32_16x16x32_bf16 v[32:35], v[176:179], v[112:115], v[32:35]
    v_mfma_f32_16x16x32_bf16 v[64:67], v[176:179], v[116:119], v[64:67]
    ds_read_b64_tr_b16 v[148:149], v73 offset:32768
    ds_read_b64_tr_b16 v[150:151], v73 offset:33792
    ds_read_b128 v[124:127], v85 offset:2048
    v_mfma_f32_16x16x32_bf16 v[4:7], v[180:183], v[108:111], v[4:7]
    v_mfma_f32_16x16x32_bf16 v[36:39], v[180:183], v[112:115], v[36:39]
    v_mfma_f32_16x16x32_bf16 v[68:71], v[180:183], v[116:119], v[68:71]
    ds_read_b64_tr_b16 v[152:153], v74 offset:32768
    ds_read_b64_tr_b16 v[154:155], v74 offset:33792
    ds_read_b128 v[128:131], v83 offset:16384
    v_mfma_f32_16x16x32_bf16 v[8:11], v[184:187], v[108:111], v[8:11]
    v_mfma_f32_16x16x32_bf16 v[40:43], v[184:187], v[112:115], v[40:43]
    ds_read_b64_tr_b16 v[156:157], v75 offset:32768
    ds_read_b64_tr_b16 v[158:159], v75 offset:33792
    ds_read_b128 v[132:135], v86 offset:0
    v_mfma_f32_16x16x32_bf16 v[12:15], v[188:191], v[108:111], v[12:15]
    v_mfma_f32_16x16x32_bf16 v[44:47], v[188:191], v[112:115], v[44:47]
    ds_read_b64_tr_b16 v[160:161], v76 offset:32768
    ds_read_b64_tr_b16 v[162:163], v76 offset:33792
    ds_read_b128 v[136:139], v86 offset:2048
    v_mfma_f32_16x16x32_bf16 v[16:19], v[192:195], v[108:111], v[16:19]
    v_mfma_f32_16x16x32_bf16 v[48:51], v[192:195], v[112:115], v[48:51]
    ds_read_b64_tr_b16 v[164:165], v77 offset:32768
    ds_read_b64_tr_b16 v[166:167], v77 offset:33792
    ds_read_b128 v[140:143], v84 offset:16384
    v_mfma_f32_16x16x32_bf16 v[20:23], v[196:199], v[108:111], v[20:23]
    v_mfma_f32_16x16x32_bf16 v[52:55], v[196:199], v[112:115], v[52:55]
    ds_read_b64_tr_b16 v[168:169], v78 offset:32768
    ds_read_b64_tr_b16 v[170:171], v78 offset:33792
    v_mfma_f32_16x16x32_bf16 v[24:27], v[200:203], v[108:111], v[24:27]
    v_mfma_f32_16x16x32_bf16 v[56:59], v[200:203], v[112:115], v[56:59]
    ds_read_b64_tr_b16 v[172:173], v79 offset:32768
    ds_read_b64_tr_b16 v[174:175], v79 offset:33792
    v_mfma_f32_16x16x32_bf16 v[28:31], v[204:207], v[108:111], v[28:31]
    v_mfma_f32_16x16x32_bf16 v[60:63], v[204:207], v[112:115], v[60:63]
    s_waitcnt vmcnt(13) lgkmcnt(0)
    s_barrier
    s_add_u32 s65, s68, 15
    s_and_b32 s65, s65, 15
    s_mul_i32 s64, s65, 262144
    s_add_u32 s64, s64, s62
    s_add_u32 m0, s63, 32768
    s_nop 0
    buffer_load_dwordx4 v80, s[44:47], s64 offen lds
    s_add_u32 m0, s63, 33792
    s_add_u32 s64, s64, 32768
    buffer_load_dwordx4 v81, s[44:47], s64 offen lds
    s_add_u32 s65, s68, 14
    s_and_b32 s65, s65, 15
    s_lshl_b32 s66, s65, 6
    s_add_u32 m0, s67, 40960
    s_nop 0
    buffer_load_dwordx4 v82, s[48:51], s66 offen lds
    s_add_u32 m0, s67, 45056
    s_add_u32 s66, s66, 32768
    buffer_load_dwordx4 v82, s[48:51], s66 offen lds
    s_add_u32 m0, s67, 49152
    s_add_u32 s66, s66, 32768
    buffer_load_dwordx4 v82, s[48:51], s66 offen lds
    s_add_u32 m0, s67, 53248
    s_add_u32 s66, s66, 32768
    buffer_load_dwordx4 v82, s[48:51], s66 offen lds
    s_add_u32 m0, s67, 57344
    s_add_u32 s66, s66, 32768
    buffer_load_dwordx4 v82, s[48:51], s66 offen lds
    ds_read_b64_tr_b16 v[176:177], v72 offset:0
    ds_read_b64_tr_b16 v[178:179], v72 offset:1024
    v_mfma_f32_16x16x32_bf16 v[0:3], v[144:147], v[120:123], v[0:3]
    v_mfma_f32_16x16x32_bf16 v[32:35], v[144:147], v[124:127], v[32:35]
    v_mfma_f32_16x16x32_bf16 v[64:67], v[144:147], v[128:131], v[64:67]
    ds_read_b64_tr_b16 v[180:181], v73 offset:0
    ds_read_b64_tr_b16 v[182:183], v73 offset:1024
    v_mfma_f32_16x16x32_bf16 v[4:7], v[148:151], v[120:123], v[4:7]
    v_mfma_f32_16x16x32_bf16 v[36:39], v[148:151], v[124:127], v[36:39]
    v_mfma_f32_16x16x32_bf16 v[68:71], v[148:151], v[128:131], v[68:71]
    ds_read_b64_tr_b16 v[184:185], v74 offset:0
    ds_read_b64_tr_b16 v[186:187], v74 offset:1024
    v_mfma_f32_16x16x32_bf16 v[8:11], v[152:155], v[120:123], v[8:11]
    v_mfma_f32_16x16x32_bf16 v[40:43], v[152:155], v[124:127], v[40:43]
    ds_read_b64_tr_b16 v[188:189], v75 offset:0
    ds_read_b64_tr_b16 v[190:191], v75 offset:1024
    v_mfma_f32_16x16x32_bf16 v[12:15], v[156:159], v[120:123], v[12:15]
    v_mfma_f32_16x16x32_bf16 v[44:47], v[156:159], v[124:127], v[44:47]
    ds_read_b64_tr_b16 v[192:193], v76 offset:0
    ds_read_b64_tr_b16 v[194:195], v76 offset:1024
    v_mfma_f32_16x16x32_bf16 v[16:19], v[160:163], v[120:123], v[16:19]
    v_mfma_f32_16x16x32_bf16 v[48:51], v[160:163], v[124:127], v[48:51]
    ds_read_b64_tr_b16 v[196:197], v77 offset:0
    ds_read_b64_tr_b16 v[198:199], v77 offset:1024
    v_mfma_f32_16x16x32_bf16 v[20:23], v[164:167], v[120:123], v[20:23]
    v_mfma_f32_16x16x32_bf16 v[52:55], v[164:167], v[124:127], v[52:55]
    ds_read_b64_tr_b16 v[200:201], v78 offset:0
    ds_read_b64_tr_b16 v[202:203], v78 offset:1024
    v_mfma_f32_16x16x32_bf16 v[24:27], v[168:171], v[120:123], v[24:27]
    v_mfma_f32_16x16x32_bf16 v[56:59], v[168:171], v[124:127], v[56:59]
    ds_read_b64_tr_b16 v[204:205], v79 offset:0
    ds_read_b64_tr_b16 v[206:207], v79 offset:1024
    v_mfma_f32_16x16x32_bf16 v[28:31], v[172:175], v[120:123], v[28:31]
    v_mfma_f32_16x16x32_bf16 v[60:63], v[172:175], v[124:127], v[60:63]
    s_waitcnt vmcnt(9) lgkmcnt(0)
    s_barrier
    ds_read_b64_tr_b16 v[144:145], v72 offset:8192
    ds_read_b64_tr_b16 v[146:147], v72 offset:9216
    ds_read_b128 v[96:99], v85 offset:20480
    v_mfma_f32_16x16x32_bf16 v[0:3], v[176:179], v[132:135], v[0:3]
    v_mfma_f32_16x16x32_bf16 v[32:35], v[176:179], v[136:139], v[32:35]
    v_mfma_f32_16x16x32_bf16 v[64:67], v[176:179], v[140:143], v[64:67]
    ds_read_b64_tr_b16 v[148:149], v73 offset:8192
    ds_read_b64_tr_b16 v[150:151], v73 offset:9216
    ds_read_b128 v[100:103], v85 offset:22528
    v_mfma_f32_16x16x32_bf16 v[4:7], v[180:183], v[132:135], v[4:7]
    v_mfma_f32_16x16x32_bf16 v[36:39], v[180:183], v[136:139], v[36:39]
    v_mfma_f32_16x16x32_bf16 v[68:71], v[180:183], v[140:143], v[68:71]
    ds_read_b64_tr_b16 v[152:153], v74 offset:8192
    ds_read_b64_tr_b16 v[154:155], v74 offset:9216
    ds_read_b128 v[104:107], v83 offset:36864
    v_mfma_f32_16x16x32_bf16 v[8:11], v[184:187], v[132:135], v[8:11]
    v_mfma_f32_16x16x32_bf16 v[40:43], v[184:187], v[136:139], v[40:43]
    ds_read_b64_tr_b16 v[156:157], v75 offset:8192
    ds_read_b64_tr_b16 v[158:159], v75 offset:9216
    ds_read_b128 v[108:111], v86 offset:20480
    v_mfma_f32_16x16x32_bf16 v[12:15], v[188:191], v[132:135], v[12:15]
    v_mfma_f32_16x16x32_bf16 v[44:47], v[188:191], v[136:139], v[44:47]
    ds_read_b64_tr_b16 v[160:161], v76 offset:8192
    ds_read_b64_tr_b16 v[162:163], v76 offset:9216
    ds_read_b128 v[112:115], v86 offset:22528
    v_mfma_f32_16x16x32_bf16 v[16:19], v[192:195], v[132:135], v[16:19]
    v_mfma_f32_16x16x32_bf16 v[48:51], v[192:195], v[136:139], v[48:51]
    ds_read_b64_tr_b16 v[164:165], v77 offset:8192
    ds_read_b64_tr_b16 v[166:167], v77 offset:9216
    ds_read_b128 v[116:119], v84 offset:36864
    v_mfma_f32_16x16x32_bf16 v[20:23], v[196:199], v[132:135], v[20:23]
    v_mfma_f32_16x16x32_bf16 v[52:55], v[196:199], v[136:139], v[52:55]
    ds_read_b64_tr_b16 v[168:169], v78 offset:8192
    ds_read_b64_tr_b16 v[170:171], v78 offset:9216
    v_mfma_f32_16x16x32_bf16 v[24:27], v[200:203], v[132:135], v[24:27]
    v_mfma_f32_16x16x32_bf16 v[56:59], v[200:203], v[136:139], v[56:59]
    ds_read_b64_tr_b16 v[172:173], v79 offset:8192
    ds_read_b64_tr_b16 v[174:175], v79 offset:9216
    v_mfma_f32_16x16x32_bf16 v[28:31], v[204:207], v[132:135], v[28:31]
    v_mfma_f32_16x16x32_bf16 v[60:63], v[204:207], v[136:139], v[60:63]
    s_waitcnt vmcnt(9) lgkmcnt(0)
    s_barrier
    s_add_u32 m0, s57, 0
    s_add_u32 s59, s69, 1
    s_and_b32 s59, s59, 7
    s_lshl_b32 s59, s59, 14
    buffer_load_dwordx4 v247, s[36:39], s59 offen nt lds
    s_add_u32 m0, s57, 4096
    s_add_u32 s59, s59, 4096
    buffer_load_dwordx4 v247, s[36:39], s59 offen nt lds
    s_add_u32 m0, s57, 8192
    s_add_u32 s59, s59, 4096
    buffer_load_dwordx4 v247, s[36:39], s59 offen nt lds
    s_add_u32 m0, s57, 12288
    s_add_u32 s59, s59, 4096
    buffer_load_dwordx4 v247, s[36:39], s59 offen nt lds
    s_add_u32 m0, s57, 65536
    s_add_u32 s59, s69, 1
    s_and_b32 s59, s59, 7
    s_lshl_b32 s59, s59, 14
    buffer_load_dwordx4 v248, s[40:43], s59 offen nt lds
    s_add_u32 m0, s57, 69632
    s_add_u32 s59, s59, 4096
    buffer_load_dwordx4 v248, s[40:43], s59 offen nt lds
    s_add_u32 m0, s57, 73728
    s_add_u32 s59, s59, 4096
    buffer_load_dwordx4 v248, s[40:43], s59 offen nt lds
    s_add_u32 m0, s57, 77824
    s_add_u32 s59, s59, 4096
    buffer_load_dwordx4 v248, s[40:43], s59 offen nt lds
    ds_read_b64_tr_b16 v[176:177], v72 offset:16384
    ds_read_b64_tr_b16 v[178:179], v72 offset:17408
    v_mfma_f32_16x16x32_bf16 v[0:3], v[144:147], v[96:99], v[0:3]
    v_mfma_f32_16x16x32_bf16 v[32:35], v[144:147], v[100:103], v[32:35]
    v_mfma_f32_16x16x32_bf16 v[64:67], v[144:147], v[104:107], v[64:67]
    ds_read_b64_tr_b16 v[180:181], v73 offset:16384
    ds_read_b64_tr_b16 v[182:183], v73 offset:17408
    v_mfma_f32_16x16x32_bf16 v[4:7], v[148:151], v[96:99], v[4:7]
    v_mfma_f32_16x16x32_bf16 v[36:39], v[148:151], v[100:103], v[36:39]
    v_mfma_f32_16x16x32_bf16 v[68:71], v[148:151], v[104:107], v[68:71]
    ds_read_b64_tr_b16 v[184:185], v74 offset:16384
    ds_read_b64_tr_b16 v[186:187], v74 offset:17408
    v_mfma_f32_16x16x32_bf16 v[8:11], v[152:155], v[96:99], v[8:11]
    v_mfma_f32_16x16x32_bf16 v[40:43], v[152:155], v[100:103], v[40:43]
    ds_read_b64_tr_b16 v[188:189], v75 offset:16384
    ds_read_b64_tr_b16 v[190:191], v75 offset:17408
    v_mfma_f32_16x16x32_bf16 v[12:15], v[156:159], v[96:99], v[12:15]
    v_mfma_f32_16x16x32_bf16 v[44:47], v[156:159], v[100:103], v[44:47]
    ds_read_b64_tr_b16 v[192:193], v76 offset:16384
    ds_read_b64_tr_b16 v[194:195], v76 offset:17408
    v_mfma_f32_16x16x32_bf16 v[16:19], v[160:163], v[96:99], v[16:19]
    v_mfma_f32_16x16x32_bf16 v[48:51], v[160:163], v[100:103], v[48:51]
    ds_read_b64_tr_b16 v[196:197], v77 offset:16384
    ds_read_b64_tr_b16 v[198:199], v77 offset:17408
    v_mfma_f32_16x16x32_bf16 v[20:23], v[164:167], v[96:99], v[20:23]
    v_mfma_f32_16x16x32_bf16 v[52:55], v[164:167], v[100:103], v[52:55]
    ds_read_b64_tr_b16 v[200:201], v78 offset:16384
    ds_read_b64_tr_b16 v[202:203], v78 offset:17408
    v_mfma_f32_16x16x32_bf16 v[24:27], v[168:171], v[96:99], v[24:27]
    v_mfma_f32_16x16x32_bf16 v[56:59], v[168:171], v[100:103], v[56:59]
    ds_read_b64_tr_b16 v[204:205], v79 offset:16384
    ds_read_b64_tr_b16 v[206:207], v79 offset:17408
    v_mfma_f32_16x16x32_bf16 v[28:31], v[172:175], v[96:99], v[28:31]
    v_mfma_f32_16x16x32_bf16 v[60:63], v[172:175], v[100:103], v[60:63]
    s_waitcnt vmcnt(8) lgkmcnt(0)
    s_barrier
    ds_read_b64_tr_b16 v[144:145], v72 offset:24576
    ds_read_b64_tr_b16 v[146:147], v72 offset:25600
    ds_read_b128 v[120:123], v85 offset:0
    v_mfma_f32_16x16x32_bf16 v[0:3], v[176:179], v[108:111], v[0:3]
    v_mfma_f32_16x16x32_bf16 v[32:35], v[176:179], v[112:115], v[32:35]
    v_mfma_f32_16x16x32_bf16 v[64:67], v[176:179], v[116:119], v[64:67]
    ds_read_b64_tr_b16 v[148:149], v73 offset:24576
    ds_read_b64_tr_b16 v[150:151], v73 offset:25600
    ds_read_b128 v[124:127], v85 offset:2048
    v_mfma_f32_16x16x32_bf16 v[4:7], v[180:183], v[108:111], v[4:7]
    v_mfma_f32_16x16x32_bf16 v[36:39], v[180:183], v[112:115], v[36:39]
    v_mfma_f32_16x16x32_bf16 v[68:71], v[180:183], v[116:119], v[68:71]
    ds_read_b64_tr_b16 v[152:153], v74 offset:24576
    ds_read_b64_tr_b16 v[154:155], v74 offset:25600
    ds_read_b128 v[128:131], v83 offset:16384
    v_mfma_f32_16x16x32_bf16 v[8:11], v[184:187], v[108:111], v[8:11]
    v_mfma_f32_16x16x32_bf16 v[40:43], v[184:187], v[112:115], v[40:43]
    ds_read_b64_tr_b16 v[156:157], v75 offset:24576
    ds_read_b64_tr_b16 v[158:159], v75 offset:25600
    ds_read_b128 v[132:135], v86 offset:0
    v_mfma_f32_16x16x32_bf16 v[12:15], v[188:191], v[108:111], v[12:15]
    v_mfma_f32_16x16x32_bf16 v[44:47], v[188:191], v[112:115], v[44:47]
    ds_read_b64_tr_b16 v[160:161], v76 offset:24576
    ds_read_b64_tr_b16 v[162:163], v76 offset:25600
    ds_read_b128 v[136:139], v86 offset:2048
    v_mfma_f32_16x16x32_bf16 v[16:19], v[192:195], v[108:111], v[16:19]
    v_mfma_f32_16x16x32_bf16 v[48:51], v[192:195], v[112:115], v[48:51]
    ds_read_b64_tr_b16 v[164:165], v77 offset:24576
    ds_read_b64_tr_b16 v[166:167], v77 offset:25600
    ds_read_b128 v[140:143], v84 offset:16384
    v_mfma_f32_16x16x32_bf16 v[20:23], v[196:199], v[108:111], v[20:23]
    v_mfma_f32_16x16x32_bf16 v[52:55], v[196:199], v[112:115], v[52:55]
    ds_read_b64_tr_b16 v[168:169], v78 offset:24576
    ds_read_b64_tr_b16 v[170:171], v78 offset:25600
    v_mfma_f32_16x16x32_bf16 v[24:27], v[200:203], v[108:111], v[24:27]
    v_mfma_f32_16x16x32_bf16 v[56:59], v[200:203], v[112:115], v[56:59]
    ds_read_b64_tr_b16 v[172:173], v79 offset:24576
    ds_read_b64_tr_b16 v[174:175], v79 offset:25600
    v_mfma_f32_16x16x32_bf16 v[28:31], v[204:207], v[108:111], v[28:31]
    v_mfma_f32_16x16x32_bf16 v[60:63], v[204:207], v[112:115], v[60:63]
    s_waitcnt vmcnt(8) lgkmcnt(0)
    s_barrier
    s_add_u32 m0, s57, 16384
    s_add_u32 s59, s69, 2
    s_and_b32 s59, s59, 7
    s_lshl_b32 s59, s59, 14
    buffer_load_dwordx4 v247, s[36:39], s59 offen nt lds
    s_add_u32 m0, s57, 20480
    s_add_u32 s59, s59, 4096
    buffer_load_dwordx4 v247, s[36:39], s59 offen nt lds
    s_add_u32 m0, s57, 24576
    s_add_u32 s59, s59, 4096
    buffer_load_dwordx4 v247, s[36:39], s59 offen nt lds
    s_add_u32 m0, s57, 28672
    s_add_u32 s59, s59, 4096
    buffer_load_dwordx4 v247, s[36:39], s59 offen nt lds
    ds_read_b64_tr_b16 v[176:177], v72 offset:32768
    ds_read_b64_tr_b16 v[178:179], v72 offset:33792
    v_mfma_f32_16x16x32_bf16 v[0:3], v[144:147], v[120:123], v[0:3]
    v_mfma_f32_16x16x32_bf16 v[32:35], v[144:147], v[124:127], v[32:35]
    v_mfma_f32_16x16x32_bf16 v[64:67], v[144:147], v[128:131], v[64:67]
    ds_read_b64_tr_b16 v[180:181], v73 offset:32768
    ds_read_b64_tr_b16 v[182:183], v73 offset:33792
    v_mfma_f32_16x16x32_bf16 v[4:7], v[148:151], v[120:123], v[4:7]
    v_mfma_f32_16x16x32_bf16 v[36:39], v[148:151], v[124:127], v[36:39]
    v_mfma_f32_16x16x32_bf16 v[68:71], v[148:151], v[128:131], v[68:71]
    ds_read_b64_tr_b16 v[184:185], v74 offset:32768
    ds_read_b64_tr_b16 v[186:187], v74 offset:33792
    v_mfma_f32_16x16x32_bf16 v[8:11], v[152:155], v[120:123], v[8:11]
    v_mfma_f32_16x16x32_bf16 v[40:43], v[152:155], v[124:127], v[40:43]
    ds_read_b64_tr_b16 v[188:189], v75 offset:32768
    ds_read_b64_tr_b16 v[190:191], v75 offset:33792
    v_mfma_f32_16x16x32_bf16 v[12:15], v[156:159], v[120:123], v[12:15]
    v_mfma_f32_16x16x32_bf16 v[44:47], v[156:159], v[124:127], v[44:47]
    ds_read_b64_tr_b16 v[192:193], v76 offset:32768
    ds_read_b64_tr_b16 v[194:195], v76 offset:33792
    v_mfma_f32_16x16x32_bf16 v[16:19], v[160:163], v[120:123], v[16:19]
    v_mfma_f32_16x16x32_bf16 v[48:51], v[160:163], v[124:127], v[48:51]
    ds_read_b64_tr_b16 v[196:197], v77 offset:32768
    ds_read_b64_tr_b16 v[198:199], v77 offset:33792
    v_mfma_f32_16x16x32_bf16 v[20:23], v[164:167], v[120:123], v[20:23]
    v_mfma_f32_16x16x32_bf16 v[52:55], v[164:167], v[124:127], v[52:55]
    ds_read_b64_tr_b16 v[200:201], v78 offset:32768
    ds_read_b64_tr_b16 v[202:203], v78 offset:33792
    v_mfma_f32_16x16x32_bf16 v[24:27], v[168:171], v[120:123], v[24:27]
    v_mfma_f32_16x16x32_bf16 v[56:59], v[168:171], v[124:127], v[56:59]
    ds_read_b64_tr_b16 v[204:205], v79 offset:32768
    ds_read_b64_tr_b16 v[206:207], v79 offset:33792
    v_mfma_f32_16x16x32_bf16 v[28:31], v[172:175], v[120:123], v[28:31]
    v_mfma_f32_16x16x32_bf16 v[60:63], v[172:175], v[124:127], v[60:63]
    s_waitcnt vmcnt(12) lgkmcnt(0)
    s_barrier
    v_mfma_f32_16x16x32_bf16 v[0:3], v[176:179], v[132:135], v[0:3]
    v_mfma_f32_16x16x32_bf16 v[32:35], v[176:179], v[136:139], v[32:35]
    v_mfma_f32_16x16x32_bf16 v[64:67], v[176:179], v[140:143], v[64:67]
    v_mfma_f32_16x16x32_bf16 v[4:7], v[180:183], v[132:135], v[4:7]
    v_mfma_f32_16x16x32_bf16 v[36:39], v[180:183], v[136:139], v[36:39]
    v_mfma_f32_16x16x32_bf16 v[68:71], v[180:183], v[140:143], v[68:71]
    v_mfma_f32_16x16x32_bf16 v[8:11], v[184:187], v[132:135], v[8:11]
    v_mfma_f32_16x16x32_bf16 v[40:43], v[184:187], v[136:139], v[40:43]
    v_mfma_f32_16x16x32_bf16 v[12:15], v[188:191], v[132:135], v[12:15]
    v_mfma_f32_16x16x32_bf16 v[44:47], v[188:191], v[136:139], v[44:47]
    v_mfma_f32_16x16x32_bf16 v[16:19], v[192:195], v[132:135], v[16:19]
    v_mfma_f32_16x16x32_bf16 v[48:51], v[192:195], v[136:139], v[48:51]
    v_mfma_f32_16x16x32_bf16 v[20:23], v[196:199], v[132:135], v[20:23]
    v_mfma_f32_16x16x32_bf16 v[52:55], v[196:199], v[136:139], v[52:55]
    v_mfma_f32_16x16x32_bf16 v[24:27], v[200:203], v[132:135], v[24:27]
    v_mfma_f32_16x16x32_bf16 v[56:59], v[200:203], v[136:139], v[56:59]
    v_mfma_f32_16x16x32_bf16 v[28:31], v[204:207], v[132:135], v[28:31]
    v_mfma_f32_16x16x32_bf16 v[60:63], v[204:207], v[136:139], v[60:63]
    v_lshrrev_b32 v249, 4, v255
    v_and_b32 v250, 15, v255
    s_lshl_b32 s58, s33, 2
    v_lshrrev_b32 v251, 1, v249
    v_or_b32 v251, s58, v251
    v_xor_b32 v251, v251, v250
    v_lshlrev_b32 v251, 4, v251
    v_lshl_add_u32 v251, v250, 8, v251
    v_and_b32 v252, 1, v249
    v_lshl_add_u32 v251, v252, 3, v251
    v_add_u32 v252, s70, v251
    v_xor_b32 v253, v249, v250
    v_lshlrev_b32 v253, 4, v253
    v_lshl_add_u32 v253, v250, 8, v253
    v_add_u32 v254, s70, v253
    v_xor_b32 v240, 0, v252
    v_cvt_pk_bf16_f32 v144, v0, v1
    v_cvt_pk_bf16_f32 v145, v2, v3
    ds_write_b64 v240, v[144:145] offset:32768
    v_cvt_pk_bf16_f32 v160, v32, v33
    v_cvt_pk_bf16_f32 v161, v34, v35
    ds_write_b64 v240, v[160:161] offset:49152
    v_xor_b32 v241, 32, v252
    v_cvt_pk_bf16_f32 v146, v4, v5
    v_cvt_pk_bf16_f32 v147, v6, v7
    ds_write_b64 v241, v[146:147] offset:32768
    v_cvt_pk_bf16_f32 v162, v36, v37
    v_cvt_pk_bf16_f32 v163, v38, v39
    ds_write_b64 v241, v[162:163] offset:49152
    v_xor_b32 v242, 64, v252
    v_cvt_pk_bf16_f32 v148, v8, v9
    v_cvt_pk_bf16_f32 v149, v10, v11
    ds_write_b64 v242, v[148:149] offset:32768
    v_cvt_pk_bf16_f32 v164, v40, v41
    v_cvt_pk_bf16_f32 v165, v42, v43
    ds_write_b64 v242, v[164:165] offset:49152
    v_xor_b32 v243, 96, v252
    v_cvt_pk_bf16_f32 v150, v12, v13
    v_cvt_pk_bf16_f32 v151, v14, v15
    ds_write_b64 v243, v[150:151] offset:32768
    v_cvt_pk_bf16_f32 v166, v44, v45
    v_cvt_pk_bf16_f32 v167, v46, v47
    ds_write_b64 v243, v[166:167] offset:49152
    v_xor_b32 v240, 128, v252
    v_cvt_pk_bf16_f32 v152, v16, v17
    v_cvt_pk_bf16_f32 v153, v18, v19
    ds_write_b64 v240, v[152:153] offset:32768
    v_cvt_pk_bf16_f32 v168, v48, v49
    v_cvt_pk_bf16_f32 v169, v50, v51
    ds_write_b64 v240, v[168:169] offset:49152
    v_xor_b32 v241, 160, v252
    v_cvt_pk_bf16_f32 v154, v20, v21
    v_cvt_pk_bf16_f32 v155, v22, v23
    ds_write_b64 v241, v[154:155] offset:32768
    v_cvt_pk_bf16_f32 v170, v52, v53
    v_cvt_pk_bf16_f32 v171, v54, v55
    ds_write_b64 v241, v[170:171] offset:49152
    v_xor_b32 v242, 192, v252
    v_cvt_pk_bf16_f32 v156, v24, v25
    v_cvt_pk_bf16_f32 v157, v26, v27
    ds_write_b64 v242, v[156:157] offset:32768
    v_cvt_pk_bf16_f32 v172, v56, v57
    v_cvt_pk_bf16_f32 v173, v58, v59
    ds_write_b64 v242, v[172:173] offset:49152
    v_xor_b32 v243, 224, v252
    v_cvt_pk_bf16_f32 v158, v28, v29
    v_cvt_pk_bf16_f32 v159, v30, v31
    ds_write_b64 v243, v[158:159] offset:32768
    v_cvt_pk_bf16_f32 v174, v60, v61
    v_cvt_pk_bf16_f32 v175, v62, v63
    ds_write_b64 v243, v[174:175] offset:49152
    v_xor_b32 v240, 0, v254
    ds_read_b128 v[96:99], v240 offset:32768
    ds_read_b128 v[112:115], v240 offset:49152
    v_xor_b32 v241, 64, v254
    ds_read_b128 v[100:103], v241 offset:32768
    ds_read_b128 v[116:119], v241 offset:49152
    v_xor_b32 v242, 128, v254
    ds_read_b128 v[104:107], v242 offset:32768
    ds_read_b128 v[120:123], v242 offset:49152
    v_xor_b32 v243, 192, v254
    ds_read_b128 v[108:111], v243 offset:32768
    ds_read_b128 v[124:127], v243 offset:49152
    v_cvt_pk_bf16_f32 v176, v64, v65
    v_cvt_pk_bf16_f32 v177, v66, v67
    v_xor_b32 v249, 0, v252
    ds_write_b64 v249, v[176:177] offset:32768
    v_cvt_pk_bf16_f32 v178, v68, v69
    v_cvt_pk_bf16_f32 v179, v70, v71
    v_xor_b32 v250, 32, v252
    ds_write_b64 v250, v[178:179] offset:32768
    s_waitcnt lgkmcnt(0)
    s_barrier
    v_xor_b32 v240, 0, v253
    ds_read_b128 v[128:131], v240 offset:32768
    v_xor_b32 v241, 64, v253
    ds_read_b128 v[132:135], v241 offset:36864
    v_xor_b32 v242, 128, v253
    ds_read_b128 v[136:139], v242 offset:40960
    v_xor_b32 v243, 192, v253
    ds_read_b128 v[140:143], v243 offset:45056
    v_mov_b32 v192, 0x3f803f80
    v_mov_b32 v193, 0x3f803f80
    v_mov_b32 v194, 0x3f803f80
    v_mov_b32 v195, 0x3f803f80
    s_waitcnt lgkmcnt(0)
    s_barrier
    ds_write_b128 v247, v[208:211] offset:32768
    ds_write_b128 v247, v[212:215] offset:36864
    ds_write_b128 v247, v[216:219] offset:40960
    ds_write_b128 v247, v[220:223] offset:45056
    ds_write_b128 v248, v[224:227] offset:49152
    ds_write_b128 v248, v[228:231] offset:53248
    ds_write_b128 v248, v[232:235] offset:57344
    ds_write_b128 v248, v[236:239] offset:61440
    s_waitcnt lgkmcnt(0)
    v_xor_b32 v235, 0, v253
    v_xor_b32 v236, 64, v253
    v_xor_b32 v237, 128, v253
    v_xor_b32 v238, 192, v253
    v_lshrrev_b32 v251, 2, v255
    v_and_b32 v252, 7, v251
    v_lshlrev_b32 v252, 5, v252
    v_lshl_add_u32 v252, v251, 8, v252
    v_and_b32 v251, 3, v255
    v_lshl_add_u32 v252, v251, 3, v252
    v_add_u32 v252, 49152, v252
    v_xor_b32 v239, 0, v252
    v_xor_b32 v240, 32, v252
    v_xor_b32 v241, 64, v252
    v_xor_b32 v242, 96, v252
    v_xor_b32 v243, 128, v252
    v_xor_b32 v244, 160, v252
    v_xor_b32 v245, 192, v252
    v_xor_b32 v246, 224, v252
    v_mov_b32 v232, 0xf149f2ca
    v_mov_b32 v233, 0xf149f2ca
    v_mov_b32 v234, 0xf149f2ca
    s_waitcnt vmcnt(12)
    s_barrier
    ds_read_b128 v[196:199], v235 offset:32768
    ds_read_b128 v[200:203], v236 offset:32768
    ds_read_b128 v[204:207], v237 offset:32768
    ds_read_b128 v[208:211], v238 offset:32768
    ds_read_b128 v[212:215], v235 offset:36864
    ds_read_b128 v[216:219], v236 offset:36864
    ds_read_b128 v[220:223], v237 offset:36864
    ds_read_b128 v[224:227], v238 offset:36864
    s_setprio 2
    s_waitcnt lgkmcnt(4)
    v_mfma_f32_16x16x32_bf16 v[144:147], v[196:199], v[96:99], 0
    v_mfma_f32_16x16x32_bf16 v[160:163], v[196:199], v[112:115], 0
    v_mfma_f32_16x16x32_bf16 v[144:147], v[200:203], v[100:103], v[144:147]
    v_mfma_f32_16x16x32_bf16 v[160:163], v[200:203], v[116:119], v[160:163]
    v_mfma_f32_16x16x32_bf16 v[144:147], v[204:207], v[104:107], v[144:147]
    v_mfma_f32_16x16x32_bf16 v[160:163], v[204:207], v[120:123], v[160:163]
    v_mfma_f32_16x16x32_bf16 v[144:147], v[208:211], v[108:111], v[144:147]
    v_mfma_f32_16x16x32_bf16 v[160:163], v[208:211], v[124:127], v[160:163]
    ds_read_b128 v[196:199], v235 offset:40960
    ds_read_b128 v[200:203], v236 offset:40960
    ds_read_b128 v[204:207], v237 offset:40960
    ds_read_b128 v[208:211], v238 offset:40960
    s_waitcnt lgkmcnt(4)
    v_mfma_f32_16x16x32_bf16 v[148:151], v[212:215], v[96:99], 0
    v_mfma_f32_16x16x32_bf16 v[164:167], v[212:215], v[112:115], 0
    v_mfma_f32_16x16x32_bf16 v[148:151], v[216:219], v[100:103], v[148:151]
    v_mfma_f32_16x16x32_bf16 v[164:167], v[216:219], v[116:119], v[164:167]
    v_mfma_f32_16x16x32_bf16 v[148:151], v[220:223], v[104:107], v[148:151]
    v_mfma_f32_16x16x32_bf16 v[164:167], v[220:223], v[120:123], v[164:167]
    v_mfma_f32_16x16x32_bf16 v[148:151], v[224:227], v[108:111], v[148:151]
    v_mfma_f32_16x16x32_bf16 v[164:167], v[224:227], v[124:127], v[164:167]
    ds_read_b128 v[212:215], v235 offset:45056
    ds_read_b128 v[216:219], v236 offset:45056
    ds_read_b128 v[220:223], v237 offset:45056
    ds_read_b128 v[224:227], v238 offset:45056
    s_waitcnt lgkmcnt(4)
    v_mfma_f32_16x16x32_bf16 v[152:155], v[196:199], v[96:99], 0
    v_mfma_f32_16x16x32_bf16 v[168:171], v[196:199], v[112:115], 0
    v_max3_f32 v252, v144, v145, v146
    v_mfma_f32_16x16x32_bf16 v[152:155], v[200:203], v[100:103], v[152:155]
    v_mfma_f32_16x16x32_bf16 v[168:171], v[200:203], v[116:119], v[168:171]
    v_max3_f32 v253, v160, v161, v162
    v_mfma_f32_16x16x32_bf16 v[152:155], v[204:207], v[104:107], v[152:155]
    v_mfma_f32_16x16x32_bf16 v[168:171], v[204:207], v[120:123], v[168:171]
    v_max_f32 v252, v252, v147
    v_mfma_f32_16x16x32_bf16 v[152:155], v[208:211], v[108:111], v[152:155]
    v_mfma_f32_16x16x32_bf16 v[168:171], v[208:211], v[124:127], v[168:171]
    v_max_f32 v253, v253, v163
    v_add_u32 v196, s70, v235
    ds_read_b128 v[196:199], v196 offset:32768
    v_add_u32 v200, s70, v236
    ds_read_b128 v[200:203], v200 offset:32768
    v_add_u32 v204, s70, v237
    ds_read_b128 v[204:207], v204 offset:32768
    v_add_u32 v208, s70, v238
    ds_read_b128 v[208:211], v208 offset:32768
    s_waitcnt lgkmcnt(4)
    v_mfma_f32_16x16x32_bf16 v[156:159], v[212:215], v[96:99], 0
    v_mfma_f32_16x16x32_bf16 v[172:175], v[212:215], v[112:115], 0
    v_max3_f32 v252, v252, v148, v149
    v_mfma_f32_16x16x32_bf16 v[156:159], v[216:219], v[100:103], v[156:159]
    v_mfma_f32_16x16x32_bf16 v[172:175], v[216:219], v[116:119], v[172:175]
    v_max3_f32 v253, v253, v164, v165
    v_mfma_f32_16x16x32_bf16 v[156:159], v[220:223], v[104:107], v[156:159]
    v_mfma_f32_16x16x32_bf16 v[172:175], v[220:223], v[120:123], v[172:175]
    v_max3_f32 v252, v252, v150, v151
    v_mfma_f32_16x16x32_bf16 v[156:159], v[224:227], v[108:111], v[156:159]
    v_mfma_f32_16x16x32_bf16 v[172:175], v[224:227], v[124:127], v[172:175]
    v_max3_f32 v253, v253, v166, v167
    s_waitcnt lgkmcnt(0)
    v_mfma_f32_16x16x32_bf16 v[176:179], v[196:199], v[128:131], 0
    v_max3_f32 v252, v252, v152, v153
    v_mfma_f32_16x16x32_bf16 v[176:179], v[200:203], v[132:135], v[176:179]
    v_max3_f32 v253, v253, v168, v169
    v_mfma_f32_16x16x32_bf16 v[176:179], v[204:207], v[136:139], v[176:179]
    v_max3_f32 v252, v252, v154, v155
    v_mfma_f32_16x16x32_bf16 v[176:179], v[208:211], v[140:143], v[176:179]
    v_max3_f32 v253, v253, v170, v171
    s_setprio 0
    v_max3_f32 v252, v252, v156, v157
    v_max3_f32 v253, v253, v172, v173
    v_max3_f32 v252, v252, v158, v159
    v_max3_f32 v253, v253, v174, v175
    s_nop 1
    v_max3_f32 v254, v176, v177, v178
    v_max_f32 v254, v254, v179
    v_fma_f32 v249, v252, s56, -v232
    v_fma_f32 v250, v253, s56, -v233
    v_fma_f32 v251, v254, s56, -v234
    v_max3_f32 v249, v249, v250, v251
    v_cmp_lt_f32 s[72:73], s71, v249
    s_waitcnt vmcnt(12)
    s_barrier
    ds_read_b64_tr_b16 v[196:197], v239 offset:0
    ds_read_b64_tr_b16 v[198:199], v239 offset:4096
    ds_read_b64_tr_b16 v[200:201], v240 offset:0
    ds_read_b64_tr_b16 v[202:203], v240 offset:4096
    ds_read_b64_tr_b16 v[204:205], v241 offset:0
    ds_read_b64_tr_b16 v[206:207], v241 offset:4096
    ds_read_b64_tr_b16 v[208:209], v242 offset:0
    ds_read_b64_tr_b16 v[210:211], v242 offset:4096
    ds_read_b64_tr_b16 v[212:213], v243 offset:0
    ds_read_b64_tr_b16 v[214:215], v243 offset:4096
    ds_read_b64_tr_b16 v[216:217], v244 offset:0
    ds_read_b64_tr_b16 v[218:219], v244 offset:4096
    ds_read_b64_tr_b16 v[220:221], v245 offset:0
    ds_read_b64_tr_b16 v[222:223], v245 offset:4096
    s_add_u32 m0, s57, 32768
    s_add_u32 s59, s69, 3
    s_and_b32 s59, s59, 7
    s_lshl_b32 s59, s59, 14
    buffer_load_dwordx4 v247, s[36:39], s59 offen nt lds
    s_add_u32 m0, s57, 36864
    s_add_u32 s59, s59, 4096
    buffer_load_dwordx4 v247, s[36:39], s59 offen nt lds
    s_add_u32 m0, s57, 40960
    s_add_u32 s59, s59, 4096
    buffer_load_dwordx4 v247, s[36:39], s59 offen nt lds
    s_add_u32 m0, s57, 45056
    s_add_u32 s59, s59, 4096
    buffer_load_dwordx4 v247, s[36:39], s59 offen nt lds
    s_cmp_lg_u64 s[72:73], 0
    s_cbranch_scc0 L1_nr0
    v_mov_b32 v249, v252
    v_mov_b32 v250, v253
    v_mov_b32 v251, v254
    v_permlane32_swap_b32 v252, v249
    v_permlane32_swap_b32 v253, v250
    v_permlane32_swap_b32 v254, v251
    v_max_f32 v252, v252, v249
    v_max_f32 v253, v253, v250
    v_max_f32 v254, v254, v251
    v_mov_b32 v249, v252
    v_mov_b32 v250, v253
    v_mov_b32 v251, v254
    v_permlane16_swap_b32 v252, v249
    v_permlane16_swap_b32 v253, v250
    v_permlane16_swap_b32 v254, v251
    v_max_f32 v252, v252, v249
    v_max_f32 v253, v253, v250
    v_max_f32 v254, v254, v251
    v_mul_f32 v252, s56, v252
    v_max_f32 v252, v252, v232
    v_sub_f32 v249, v232, v252
    v_exp_f32 v249, v249
    v_mov_b32 v232, v252
    v_mul_f32 v253, s56, v253
    v_max_f32 v253, v253, v233
    v_sub_f32 v249, v233, v253
    v_exp_f32 v249, v249
    v_mov_b32 v233, v253
    v_mul_f32 v254, s56, v254
    v_max_f32 v254, v254, v234
    v_sub_f32 v249, v234, v254
    v_exp_f32 v249, v249
    v_mov_b32 v234, v254
    s_nop 1
L1_nr0:
    v_fma_f32 v144, v144, s56, -v232
    v_fma_f32 v145, v145, s56, -v232
    v_fma_f32 v146, v146, s56, -v232
    v_fma_f32 v147, v147, s56, -v232
    v_fma_f32 v148, v148, s56, -v232
    v_fma_f32 v149, v149, s56, -v232
    v_fma_f32 v150, v150, s56, -v232
    v_fma_f32 v151, v151, s56, -v232
    v_exp_f32 v144, v144
    v_exp_f32 v145, v145
    v_exp_f32 v146, v146
    v_exp_f32 v147, v147
    v_exp_f32 v148, v148
    v_exp_f32 v149, v149
    v_exp_f32 v150, v150
    v_exp_f32 v151, v151
    v_cvt_pk_bf16_f32 v144, v144, v145
    v_cvt_pk_bf16_f32 v145, v146, v147
    v_cvt_pk_bf16_f32 v146, v148, v149
    v_cvt_pk_bf16_f32 v147, v150, v151
    v_fma_f32 v160, v160, s56, -v233
    v_fma_f32 v161, v161, s56, -v233
    v_fma_f32 v162, v162, s56, -v233
    v_fma_f32 v163, v163, s56, -v233
    v_fma_f32 v164, v164, s56, -v233
    v_fma_f32 v165, v165, s56, -v233
    v_fma_f32 v166, v166, s56, -v233
    v_fma_f32 v167, v167, s56, -v233
    v_exp_f32 v160, v160
    v_exp_f32 v161, v161
    v_exp_f32 v162, v162
    v_exp_f32 v163, v163
    v_exp_f32 v164, v164
    v_exp_f32 v165, v165
    v_exp_f32 v166, v166
    v_exp_f32 v167, v167
    v_cvt_pk_bf16_f32 v160, v160, v161
    v_cvt_pk_bf16_f32 v161, v162, v163
    v_cvt_pk_bf16_f32 v162, v164, v165
    v_cvt_pk_bf16_f32 v163, v166, v167
    s_setprio 2
    v_mfma_f32_16x16x32_bf16 v[180:183], v[192:195], v[144:147], 0
    v_mfma_f32_16x16x32_bf16 v[184:187], v[192:195], v[160:163], 0
    s_waitcnt lgkmcnt(10)
    v_mfma_f32_16x16x32_bf16 v[0:3], v[196:199], v[144:147], 0
    v_fma_f32 v152, v152, s56, -v232
    v_fma_f32 v153, v153, s56, -v232
    v_fma_f32 v154, v154, s56, -v232
    v_fma_f32 v155, v155, s56, -v232
    v_mfma_f32_16x16x32_bf16 v[32:35], v[196:199], v[160:163], 0
    v_fma_f32 v156, v156, s56, -v232
    v_fma_f32 v157, v157, s56, -v232
    v_fma_f32 v158, v158, s56, -v232
    ds_read_b64_tr_b16 v[224:225], v246 offset:0
    ds_read_b64_tr_b16 v[226:227], v246 offset:4096
    v_mfma_f32_16x16x32_bf16 v[4:7], v[200:203], v[144:147], 0
    v_fma_f32 v159, v159, s56, -v232
    v_exp_f32 v152, v152
    v_exp_f32 v153, v153
    v_exp_f32 v154, v154
    v_mfma_f32_16x16x32_bf16 v[36:39], v[200:203], v[160:163], 0
    v_exp_f32 v155, v155
    v_exp_f32 v156, v156
    v_exp_f32 v157, v157
    ds_read_b64_tr_b16 v[228:229], v239 offset:8192
    ds_read_b64_tr_b16 v[230:231], v239 offset:12288
    s_waitcnt lgkmcnt(10)
    v_mfma_f32_16x16x32_bf16 v[8:11], v[204:207], v[144:147], 0
    v_exp_f32 v158, v158
    v_exp_f32 v159, v159
    v_cvt_pk_bf16_f32 v152, v152, v153
    v_cvt_pk_bf16_f32 v153, v154, v155
    v_mfma_f32_16x16x32_bf16 v[40:43], v[204:207], v[160:163], 0
    v_cvt_pk_bf16_f32 v154, v156, v157
    v_cvt_pk_bf16_f32 v155, v158, v159
    v_fma_f32 v168, v168, s56, -v233
    ds_read_b64_tr_b16 v[196:197], v240 offset:8192
    ds_read_b64_tr_b16 v[198:199], v240 offset:12288
    v_mfma_f32_16x16x32_bf16 v[12:15], v[208:211], v[144:147], 0
    v_fma_f32 v169, v169, s56, -v233
    v_fma_f32 v170, v170, s56, -v233
    v_fma_f32 v171, v171, s56, -v233
    v_fma_f32 v172, v172, s56, -v233
    v_mfma_f32_16x16x32_bf16 v[44:47], v[208:211], v[160:163], 0
    v_fma_f32 v173, v173, s56, -v233
    v_fma_f32 v174, v174, s56, -v233
    v_fma_f32 v175, v175, s56, -v233
    ds_read_b64_tr_b16 v[200:201], v241 offset:8192
    ds_read_b64_tr_b16 v[202:203], v241 offset:12288
    s_waitcnt lgkmcnt(10)
    v_mfma_f32_16x16x32_bf16 v[16:19], v[212:215], v[144:147], 0
    v_exp_f32 v168, v168
    v_exp_f32 v169, v169
    v_exp_f32 v170, v170
    v_exp_f32 v171, v171
    v_mfma_f32_16x16x32_bf16 v[48:51], v[212:215], v[160:163], 0
    v_exp_f32 v172, v172
    v_exp_f32 v173, v173
    v_exp_f32 v174, v174
    ds_read_b64_tr_b16 v[204:205], v242 offset:8192
    ds_read_b64_tr_b16 v[206:207], v242 offset:12288
    v_mfma_f32_16x16x32_bf16 v[20:23], v[216:219], v[144:147], 0
    v_exp_f32 v175, v175
    v_cvt_pk_bf16_f32 v168, v168, v169
    v_cvt_pk_bf16_f32 v169, v170, v171
    v_cvt_pk_bf16_f32 v170, v172, v173
    v_mfma_f32_16x16x32_bf16 v[52:55], v[216:219], v[160:163], 0
    v_cvt_pk_bf16_f32 v171, v174, v175
    v_fma_f32 v176, v176, s56, -v234
    v_fma_f32 v177, v177, s56, -v234
    ds_read_b64_tr_b16 v[208:209], v243 offset:8192
    ds_read_b64_tr_b16 v[210:211], v243 offset:12288
    s_waitcnt lgkmcnt(10)
    v_mfma_f32_16x16x32_bf16 v[24:27], v[220:223], v[144:147], 0
    v_fma_f32 v178, v178, s56, -v234
    v_fma_f32 v179, v179, s56, -v234
    v_exp_f32 v176, v176
    v_exp_f32 v177, v177
    v_mfma_f32_16x16x32_bf16 v[56:59], v[220:223], v[160:163], 0
    v_exp_f32 v178, v178
    v_exp_f32 v179, v179
    v_cvt_pk_bf16_f32 v176, v176, v177
    ds_read_b64_tr_b16 v[212:213], v244 offset:8192
    ds_read_b64_tr_b16 v[214:215], v244 offset:12288
    v_mfma_f32_16x16x32_bf16 v[28:31], v[224:227], v[144:147], 0
    v_cvt_pk_bf16_f32 v177, v178, v179
    v_mfma_f32_16x16x32_bf16 v[60:63], v[224:227], v[160:163], 0
    ds_read_b64_tr_b16 v[216:217], v245 offset:8192
    ds_read_b64_tr_b16 v[218:219], v245 offset:12288
    v_mfma_f32_16x16x32_bf16 v[180:183], v[192:195], v[152:155], v[180:183]
    v_mfma_f32_16x16x32_bf16 v[184:187], v[192:195], v[168:171], v[184:187]
    v_mfma_f32_16x16x16_bf16 v[188:191], v[192:193], v[176:177], 0
    s_waitcnt lgkmcnt(10)
    v_mfma_f32_16x16x32_bf16 v[0:3], v[228:231], v[152:155], v[0:3]
    v_mfma_f32_16x16x32_bf16 v[32:35], v[228:231], v[168:171], v[32:35]
    ds_read_b64_tr_b16 v[220:221], v246 offset:8192
    ds_read_b64_tr_b16 v[222:223], v246 offset:12288
    v_mfma_f32_16x16x32_bf16 v[4:7], v[196:199], v[152:155], v[4:7]
    v_mfma_f32_16x16x32_bf16 v[36:39], v[196:199], v[168:171], v[36:39]
    v_add_u32 v224, s70, v239
    ds_read_b64_tr_b16 v[224:225], v224 offset:0
    v_add_u32 v226, s70, v240
    ds_read_b64_tr_b16 v[226:227], v226 offset:0
    s_waitcnt lgkmcnt(10)
    v_mfma_f32_16x16x32_bf16 v[8:11], v[200:203], v[152:155], v[8:11]
    v_mfma_f32_16x16x32_bf16 v[40:43], v[200:203], v[168:171], v[40:43]
    v_add_u32 v228, s70, v241
    ds_read_b64_tr_b16 v[228:229], v228 offset:0
    v_add_u32 v230, s70, v242
    ds_read_b64_tr_b16 v[230:231], v230 offset:0
    v_mfma_f32_16x16x32_bf16 v[12:15], v[204:207], v[152:155], v[12:15]
    v_mfma_f32_16x16x32_bf16 v[44:47], v[204:207], v[168:171], v[44:47]
    v_add_u32 v196, s70, v243
    ds_read_b64_tr_b16 v[196:197], v196 offset:0
    v_add_u32 v198, s70, v244
    ds_read_b64_tr_b16 v[198:199], v198 offset:0
    s_waitcnt lgkmcnt(10)
    v_mfma_f32_16x16x32_bf16 v[16:19], v[208:211], v[152:155], v[16:19]
    v_mfma_f32_16x16x32_bf16 v[48:51], v[208:211], v[168:171], v[48:51]
    v_add_u32 v200, s70, v245
    ds_read_b64_tr_b16 v[200:201], v200 offset:0
    v_add_u32 v202, s70, v246
    ds_read_b64_tr_b16 v[202:203], v202 offset:0
    v_mfma_f32_16x16x32_bf16 v[20:23], v[212:215], v[152:155], v[20:23]
    v_mfma_f32_16x16x32_bf16 v[52:55], v[212:215], v[168:171], v[52:55]
    s_waitcnt lgkmcnt(8)
    v_mfma_f32_16x16x32_bf16 v[24:27], v[216:219], v[152:155], v[24:27]
    v_mfma_f32_16x16x32_bf16 v[56:59], v[216:219], v[168:171], v[56:59]
    v_mfma_f32_16x16x32_bf16 v[28:31], v[220:223], v[152:155], v[28:31]
    v_mfma_f32_16x16x32_bf16 v[60:63], v[220:223], v[168:171], v[60:63]
    s_waitcnt lgkmcnt(4)
    v_mfma_f32_16x16x16_bf16 v[64:67], v[224:225], v[176:177], 0
    v_mfma_f32_16x16x16_bf16 v[68:71], v[226:227], v[176:177], 0
    v_mfma_f32_16x16x16_bf16 v[72:75], v[228:229], v[176:177], 0
    v_mfma_f32_16x16x16_bf16 v[76:79], v[230:231], v[176:177], 0
    s_waitcnt lgkmcnt(0)
    v_mfma_f32_16x16x16_bf16 v[80:83], v[196:197], v[176:177], 0
    v_mfma_f32_16x16x16_bf16 v[84:87], v[198:199], v[176:177], 0
    v_mfma_f32_16x16x16_bf16 v[88:91], v[200:201], v[176:177], 0
    v_mfma_f32_16x16x16_bf16 v[92:95], v[202:203], v[176:177], 0
    s_waitcnt vmcnt(12)
    s_barrier
    s_add_u32 m0, s57, 49152
    s_add_u32 s59, s69, 2
    s_and_b32 s59, s59, 7
    s_lshl_b32 s59, s59, 14
    buffer_load_dwordx4 v248, s[40:43], s59 offen nt lds
    s_add_u32 m0, s57, 53248
    s_add_u32 s59, s59, 4096
    buffer_load_dwordx4 v248, s[40:43], s59 offen nt lds
    s_add_u32 m0, s57, 57344
    s_add_u32 s59, s59, 4096
    buffer_load_dwordx4 v248, s[40:43], s59 offen nt lds
    s_add_u32 m0, s57, 61440
    s_add_u32 s59, s59, 4096
    buffer_load_dwordx4 v248, s[40:43], s59 offen nt lds
L1_redo1:
    ds_read_b128 v[196:199], v235 offset:0
    ds_read_b128 v[200:203], v236 offset:0
    ds_read_b128 v[204:207], v237 offset:0
    ds_read_b128 v[208:211], v238 offset:0
    ds_read_b128 v[212:215], v235 offset:4096
    ds_read_b128 v[216:219], v236 offset:4096
    ds_read_b128 v[220:223], v237 offset:4096
    ds_read_b128 v[224:227], v238 offset:4096
    s_setprio 2
    s_waitcnt lgkmcnt(4)
    v_mfma_f32_16x16x32_bf16 v[144:147], v[196:199], v[96:99], 0
    v_mfma_f32_16x16x32_bf16 v[160:163], v[196:199], v[112:115], 0
    v_mfma_f32_16x16x32_bf16 v[144:147], v[200:203], v[100:103], v[144:147]
    v_mfma_f32_16x16x32_bf16 v[160:163], v[200:203], v[116:119], v[160:163]
    v_mfma_f32_16x16x32_bf16 v[144:147], v[204:207], v[104:107], v[144:147]
    v_mfma_f32_16x16x32_bf16 v[160:163], v[204:207], v[120:123], v[160:163]
    v_mfma_f32_16x16x32_bf16 v[144:147], v[208:211], v[108:111], v[144:147]
    v_mfma_f32_16x16x32_bf16 v[160:163], v[208:211], v[124:127], v[160:163]
    ds_read_b128 v[196:199], v235 offset:8192
    ds_read_b128 v[200:203], v236 offset:8192
    ds_read_b128 v[204:207], v237 offset:8192
    ds_read_b128 v[208:211], v238 offset:8192
    s_waitcnt lgkmcnt(4)
    v_mfma_f32_16x16x32_bf16 v[148:151], v[212:215], v[96:99], 0
    v_mfma_f32_16x16x32_bf16 v[164:167], v[212:215], v[112:115], 0
    v_mfma_f32_16x16x32_bf16 v[148:151], v[216:219], v[100:103], v[148:151]
    v_max3_f32 v252, v144, v145, v146
    v_max3_f32 v253, v160, v161, v162
    v_max_f32 v252, v252, v147
    v_max_f32 v253, v253, v163
    v_mfma_f32_16x16x32_bf16 v[164:167], v[216:219], v[116:119], v[164:167]
    v_fma_f32 v144, v144, s56, -v232
    v_fma_f32 v145, v145, s56, -v232
    v_fma_f32 v146, v146, s56, -v232
    v_fma_f32 v147, v147, s56, -v232
    v_mfma_f32_16x16x32_bf16 v[148:151], v[220:223], v[104:107], v[148:151]
    v_exp_f32 v144, v144
    v_exp_f32 v145, v145
    v_exp_f32 v146, v146
    v_exp_f32 v147, v147
    v_mfma_f32_16x16x32_bf16 v[164:167], v[220:223], v[120:123], v[164:167]
    v_cvt_pk_bf16_f32 v144, v144, v145
    v_cvt_pk_bf16_f32 v145, v146, v147
    v_fma_f32 v160, v160, s56, -v233
    v_fma_f32 v161, v161, s56, -v233
    v_mfma_f32_16x16x32_bf16 v[148:151], v[224:227], v[108:111], v[148:151]
    v_fma_f32 v162, v162, s56, -v233
    v_fma_f32 v163, v163, s56, -v233
    v_exp_f32 v160, v160
    v_exp_f32 v161, v161
    v_mfma_f32_16x16x32_bf16 v[164:167], v[224:227], v[124:127], v[164:167]
    v_exp_f32 v162, v162
    v_exp_f32 v163, v163
    v_cvt_pk_bf16_f32 v160, v160, v161
    v_cvt_pk_bf16_f32 v161, v162, v163
    ds_read_b128 v[212:215], v235 offset:12288
    ds_read_b128 v[216:219], v236 offset:12288
    ds_read_b128 v[220:223], v237 offset:12288
    ds_read_b128 v[224:227], v238 offset:12288
    s_waitcnt lgkmcnt(4)
    v_mfma_f32_16x16x32_bf16 v[152:155], v[196:199], v[96:99], 0
    v_mfma_f32_16x16x32_bf16 v[168:171], v[196:199], v[112:115], 0
    v_mfma_f32_16x16x32_bf16 v[152:155], v[200:203], v[100:103], v[152:155]
    v_max3_f32 v252, v252, v148, v149
    v_max3_f32 v253, v253, v164, v165
    v_max3_f32 v252, v252, v150, v151
    v_max3_f32 v253, v253, v166, v167
    v_mfma_f32_16x16x32_bf16 v[168:171], v[200:203], v[116:119], v[168:171]
    v_fma_f32 v148, v148, s56, -v232
    v_fma_f32 v149, v149, s56, -v232
    v_fma_f32 v150, v150, s56, -v232
    v_fma_f32 v151, v151, s56, -v232
    v_mfma_f32_16x16x32_bf16 v[152:155], v[204:207], v[104:107], v[152:155]
    v_exp_f32 v148, v148
    v_exp_f32 v149, v149
    v_exp_f32 v150, v150
    v_exp_f32 v151, v151
    v_mfma_f32_16x16x32_bf16 v[168:171], v[204:207], v[120:123], v[168:171]
    v_cvt_pk_bf16_f32 v146, v148, v149
    v_cvt_pk_bf16_f32 v147, v150, v151
    v_fma_f32 v164, v164, s56, -v233
    v_fma_f32 v165, v165, s56, -v233
    v_mfma_f32_16x16x32_bf16 v[152:155], v[208:211], v[108:111], v[152:155]
    v_fma_f32 v166, v166, s56, -v233
    v_fma_f32 v167, v167, s56, -v233
    v_exp_f32 v164, v164
    v_exp_f32 v165, v165
    v_mfma_f32_16x16x32_bf16 v[168:171], v[208:211], v[124:127], v[168:171]
    v_exp_f32 v166, v166
    v_exp_f32 v167, v167
    v_cvt_pk_bf16_f32 v162, v164, v165
    v_cvt_pk_bf16_f32 v163, v166, v167
    v_add_u32 v196, s70, v235
    ds_read_b128 v[196:199], v196 offset:0
    v_add_u32 v200, s70, v236
    ds_read_b128 v[200:203], v200 offset:0
    v_add_u32 v204, s70, v237
    ds_read_b128 v[204:207], v204 offset:0
    v_add_u32 v208, s70, v238
    ds_read_b128 v[208:211], v208 offset:0
    s_waitcnt lgkmcnt(4)
    v_mfma_f32_16x16x32_bf16 v[156:159], v[212:215], v[96:99], 0
    v_mfma_f32_16x16x32_bf16 v[172:175], v[212:215], v[112:115], 0
    v_mfma_f32_16x16x32_bf16 v[156:159], v[216:219], v[100:103], v[156:159]
    v_max3_f32 v252, v252, v152, v153
    v_max3_f32 v253, v253, v168, v169
    v_max3_f32 v252, v252, v154, v155
    v_max3_f32 v253, v253, v170, v171
    v_mfma_f32_16x16x32_bf16 v[172:175], v[216:219], v[116:119], v[172:175]
    v_fma_f32 v152, v152, s56, -v232
    v_fma_f32 v153, v153, s56, -v232
    v_fma_f32 v154, v154, s56, -v232
    v_fma_f32 v155, v155, s56, -v232
    v_mfma_f32_16x16x32_bf16 v[156:159], v[220:223], v[104:107], v[156:159]
    v_exp_f32 v152, v152
    v_exp_f32 v153, v153
    v_exp_f32 v154, v154
    v_exp_f32 v155, v155
    v_mfma_f32_16x16x32_bf16 v[172:175], v[220:223], v[120:123], v[172:175]
    v_cvt_pk_bf16_f32 v152, v152, v153
    v_cvt_pk_bf16_f32 v153, v154, v155
    v_fma_f32 v168, v168, s56, -v233
    v_fma_f32 v169, v169, s56, -v233
    v_mfma_f32_16x16x32_bf16 v[156:159], v[224:227], v[108:111], v[156:159]
    v_fma_f32 v170, v170, s56, -v233
    v_fma_f32 v171, v171, s56, -v233
    v_exp_f32 v168, v168
    v_exp_f32 v169, v169
    v_mfma_f32_16x16x32_bf16 v[172:175], v[224:227], v[124:127], v[172:175]
    v_exp_f32 v170, v170
    v_exp_f32 v171, v171
    v_cvt_pk_bf16_f32 v168, v168, v169
    v_cvt_pk_bf16_f32 v169, v170, v171
    s_waitcnt lgkmcnt(0)
    v_mfma_f32_16x16x32_bf16 v[176:179], v[196:199], v[128:131], 0
    v_mfma_f32_16x16x32_bf16 v[176:179], v[200:203], v[132:135], v[176:179]
    v_mfma_f32_16x16x32_bf16 v[176:179], v[204:207], v[136:139], v[176:179]
    v_mfma_f32_16x16x32_bf16 v[176:179], v[208:211], v[140:143], v[176:179]
    s_setprio 0
    v_max3_f32 v252, v252, v156, v157
    v_max3_f32 v253, v253, v172, v173
    v_max3_f32 v252, v252, v158, v159
    v_max3_f32 v253, v253, v174, v175
    s_nop 2
    v_max3_f32 v254, v176, v177, v178
    v_max_f32 v254, v254, v179
    v_fma_f32 v249, v252, s56, -v232
    v_fma_f32 v250, v253, s56, -v233
    v_fma_f32 v251, v254, s56, -v234
    v_max3_f32 v249, v249, v250, v251
    v_cmp_lt_f32 s[72:73], s71, v249
    s_nop 1
    s_cmp_lg_u64 s[72:73], 0
    s_cbranch_scc0 L1_nr1
    v_mov_b32 v249, v252
    v_mov_b32 v250, v253
    v_mov_b32 v251, v254
    v_permlane32_swap_b32 v252, v249
    v_permlane32_swap_b32 v253, v250
    v_permlane32_swap_b32 v254, v251
    v_max_f32 v252, v252, v249
    v_max_f32 v253, v253, v250
    v_max_f32 v254, v254, v251
    v_mov_b32 v249, v252
    v_mov_b32 v250, v253
    v_mov_b32 v251, v254
    v_permlane16_swap_b32 v252, v249
    v_permlane16_swap_b32 v253, v250
    v_permlane16_swap_b32 v254, v251
    v_max_f32 v252, v252, v249
    v_max_f32 v253, v253, v250
    v_max_f32 v254, v254, v251
    v_mul_f32 v252, s56, v252
    v_max_f32 v252, v252, v232
    v_sub_f32 v249, v232, v252
    v_exp_f32 v249, v249
    v_mov_b32 v232, v252
    v_mul_f32 v0, v0, v249
    v_mul_f32 v1, v1, v249
    v_mul_f32 v2, v2, v249
    v_mul_f32 v3, v3, v249
    v_mul_f32 v4, v4, v249
    v_mul_f32 v5, v5, v249
    v_mul_f32 v6, v6, v249
    v_mul_f32 v7, v7, v249
    v_mul_f32 v8, v8, v249
    v_mul_f32 v9, v9, v249
    v_mul_f32 v10, v10, v249
    v_mul_f32 v11, v11, v249
    v_mul_f32 v12, v12, v249
    v_mul_f32 v13, v13, v249
    v_mul_f32 v14, v14, v249
    v_mul_f32 v15, v15, v249
    v_mul_f32 v16, v16, v249
    v_mul_f32 v17, v17, v249
    v_mul_f32 v18, v18, v249
    v_mul_f32 v19, v19, v249
    v_mul_f32 v20, v20, v249
    v_mul_f32 v21, v21, v249
    v_mul_f32 v22, v22, v249
    v_mul_f32 v23, v23, v249
    v_mul_f32 v24, v24, v249
    v_mul_f32 v25, v25, v249
    v_mul_f32 v26, v26, v249
    v_mul_f32 v27, v27, v249
    v_mul_f32 v28, v28, v249
    v_mul_f32 v29, v29, v249
    v_mul_f32 v30, v30, v249
    v_mul_f32 v31, v31, v249
    v_mul_f32 v180, v180, v249
    v_mul_f32 v181, v181, v249
    v_mul_f32 v182, v182, v249
    v_mul_f32 v183, v183, v249
    v_mul_f32 v253, s56, v253
    v_max_f32 v253, v253, v233
    v_sub_f32 v249, v233, v253
    v_exp_f32 v249, v249
    v_mov_b32 v233, v253
    v_mul_f32 v32, v32, v249
    v_mul_f32 v33, v33, v249
    v_mul_f32 v34, v34, v249
    v_mul_f32 v35, v35, v249
    v_mul_f32 v36, v36, v249
    v_mul_f32 v37, v37, v249
    v_mul_f32 v38, v38, v249
    v_mul_f32 v39, v39, v249
    v_mul_f32 v40, v40, v249
    v_mul_f32 v41, v41, v249
    v_mul_f32 v42, v42, v249
    v_mul_f32 v43, v43, v249
    v_mul_f32 v44, v44, v249
    v_mul_f32 v45, v45, v249
    v_mul_f32 v46, v46, v249
    v_mul_f32 v47, v47, v249
    v_mul_f32 v48, v48, v249
    v_mul_f32 v49, v49, v249
    v_mul_f32 v50, v50, v249
    v_mul_f32 v51, v51, v249
    v_mul_f32 v52, v52, v249
    v_mul_f32 v53, v53, v249
    v_mul_f32 v54, v54, v249
    v_mul_f32 v55, v55, v249
    v_mul_f32 v56, v56, v249
    v_mul_f32 v57, v57, v249
    v_mul_f32 v58, v58, v249
    v_mul_f32 v59, v59, v249
    v_mul_f32 v60, v60, v249
    v_mul_f32 v61, v61, v249
    v_mul_f32 v62, v62, v249
    v_mul_f32 v63, v63, v249
    v_mul_f32 v184, v184, v249
    v_mul_f32 v185, v185, v249
    v_mul_f32 v186, v186, v249
    v_mul_f32 v187, v187, v249
    v_mul_f32 v254, s56, v254
    v_max_f32 v254, v254, v234
    v_sub_f32 v249, v234, v254
    v_exp_f32 v249, v249
    v_mov_b32 v234, v254
    v_mul_f32 v64, v64, v249
    v_mul_f32 v65, v65, v249
    v_mul_f32 v66, v66, v249
    v_mul_f32 v67, v67, v249
    v_mul_f32 v68, v68, v249
    v_mul_f32 v69, v69, v249
    v_mul_f32 v70, v70, v249
    v_mul_f32 v71, v71, v249
    v_mul_f32 v72, v72, v249
    v_mul_f32 v73, v73, v249
    v_mul_f32 v74, v74, v249
    v_mul_f32 v75, v75, v249
    v_mul_f32 v76, v76, v249
    v_mul_f32 v77, v77, v249
    v_mul_f32 v78, v78, v249
    v_mul_f32 v79, v79, v249
    v_mul_f32 v80, v80, v249
    v_mul_f32 v81, v81, v249
    v_mul_f32 v82, v82, v249
    v_mul_f32 v83, v83, v249
    v_mul_f32 v84, v84, v249
    v_mul_f32 v85, v85, v249
    v_mul_f32 v86, v86, v249
    v_mul_f32 v87, v87, v249
    v_mul_f32 v88, v88, v249
    v_mul_f32 v89, v89, v249
    v_mul_f32 v90, v90, v249
    v_mul_f32 v91, v91, v249
    v_mul_f32 v92, v92, v249
    v_mul_f32 v93, v93, v249
    v_mul_f32 v94, v94, v249
    v_mul_f32 v95, v95, v249
    v_mul_f32 v188, v188, v249
    v_mul_f32 v189, v189, v249
    v_mul_f32 v190, v190, v249
    v_mul_f32 v191, v191, v249
    s_nop 1
    s_branch L1_redo1
L1_nr1:
    s_waitcnt vmcnt(12)
    s_barrier
    ds_read_b64_tr_b16 v[196:197], v239 offset:16384
    ds_read_b64_tr_b16 v[198:199], v239 offset:20480
    ds_read_b64_tr_b16 v[200:201], v240 offset:16384
    ds_read_b64_tr_b16 v[202:203], v240 offset:20480
    ds_read_b64_tr_b16 v[204:205], v241 offset:16384
    ds_read_b64_tr_b16 v[206:207], v241 offset:20480
    ds_read_b64_tr_b16 v[208:209], v242 offset:16384
    ds_read_b64_tr_b16 v[210:211], v242 offset:20480
    ds_read_b64_tr_b16 v[212:213], v243 offset:16384
    ds_read_b64_tr_b16 v[214:215], v243 offset:20480
    ds_read_b64_tr_b16 v[216:217], v244 offset:16384
    ds_read_b64_tr_b16 v[218:219], v244 offset:20480
    ds_read_b64_tr_b16 v[220:221], v245 offset:16384
    ds_read_b64_tr_b16 v[222:223], v245 offset:20480
    s_add_u32 m0, s57, 0
    s_add_u32 s59, s69, 4
    s_and_b32 s59, s59, 7
    s_lshl_b32 s59, s59, 14
    buffer_load_dwordx4 v247, s[36:39], s59 offen nt lds
    s_add_u32 m0, s57, 4096
    s_add_u32 s59, s59, 4096
    buffer_load_dwordx4 v247, s[36:39], s59 offen nt lds
    s_add_u32 m0, s57, 8192
    s_add_u32 s59, s59, 4096
    buffer_load_dwordx4 v247, s[36:39], s59 offen nt lds
    s_add_u32 m0, s57, 12288
    s_add_u32 s59, s59, 4096
    buffer_load_dwordx4 v247, s[36:39], s59 offen nt lds
    s_setprio 2
    v_mfma_f32_16x16x32_bf16 v[180:183], v[192:195], v[144:147], v[180:183]
    v_mfma_f32_16x16x32_bf16 v[184:187], v[192:195], v[160:163], v[184:187]
    s_waitcnt lgkmcnt(10)
    v_mfma_f32_16x16x32_bf16 v[0:3], v[196:199], v[144:147], v[0:3]
    v_fma_f32 v156, v156, s56, -v232
    v_fma_f32 v157, v157, s56, -v232
    v_mfma_f32_16x16x32_bf16 v[32:35], v[196:199], v[160:163], v[32:35]
    v_fma_f32 v158, v158, s56, -v232
    v_fma_f32 v159, v159, s56, -v232
    ds_read_b64_tr_b16 v[224:225], v246 offset:16384
    ds_read_b64_tr_b16 v[226:227], v246 offset:20480
    v_mfma_f32_16x16x32_bf16 v[4:7], v[200:203], v[144:147], v[4:7]
    v_exp_f32 v156, v156
    v_exp_f32 v157, v157
    v_mfma_f32_16x16x32_bf16 v[36:39], v[200:203], v[160:163], v[36:39]
    v_exp_f32 v158, v158
    v_exp_f32 v159, v159
    ds_read_b64_tr_b16 v[228:229], v239 offset:24576
    ds_read_b64_tr_b16 v[230:231], v239 offset:28672
    s_waitcnt lgkmcnt(10)
    v_mfma_f32_16x16x32_bf16 v[8:11], v[204:207], v[144:147], v[8:11]
    v_cvt_pk_bf16_f32 v154, v156, v157
    v_cvt_pk_bf16_f32 v155, v158, v159
    v_mfma_f32_16x16x32_bf16 v[40:43], v[204:207], v[160:163], v[40:43]
    v_fma_f32 v172, v172, s56, -v233
    v_fma_f32 v173, v173, s56, -v233
    ds_read_b64_tr_b16 v[196:197], v240 offset:24576
    ds_read_b64_tr_b16 v[198:199], v240 offset:28672
    v_mfma_f32_16x16x32_bf16 v[12:15], v[208:211], v[144:147], v[12:15]
    v_fma_f32 v174, v174, s56, -v233
    v_fma_f32 v175, v175, s56, -v233
    v_mfma_f32_16x16x32_bf16 v[44:47], v[208:211], v[160:163], v[44:47]
    v_exp_f32 v172, v172
    v_exp_f32 v173, v173
    ds_read_b64_tr_b16 v[200:201], v241 offset:24576
    ds_read_b64_tr_b16 v[202:203], v241 offset:28672
    s_waitcnt lgkmcnt(10)
    v_mfma_f32_16x16x32_bf16 v[16:19], v[212:215], v[144:147], v[16:19]
    v_exp_f32 v174, v174
    v_exp_f32 v175, v175
    v_mfma_f32_16x16x32_bf16 v[48:51], v[212:215], v[160:163], v[48:51]
    v_cvt_pk_bf16_f32 v170, v172, v173
    v_cvt_pk_bf16_f32 v171, v174, v175
    ds_read_b64_tr_b16 v[204:205], v242 offset:24576
    ds_read_b64_tr_b16 v[206:207], v242 offset:28672
    v_mfma_f32_16x16x32_bf16 v[20:23], v[216:219], v[144:147], v[20:23]
    v_fma_f32 v176, v176, s56, -v234
    v_fma_f32 v177, v177, s56, -v234
    v_mfma_f32_16x16x32_bf16 v[52:55], v[216:219], v[160:163], v[52:55]
    v_fma_f32 v178, v178, s56, -v234
    v_fma_f32 v179, v179, s56, -v234
    ds_read_b64_tr_b16 v[208:209], v243 offset:24576
    ds_read_b64_tr_b16 v[210:211], v243 offset:28672
    s_waitcnt lgkmcnt(10)
    v_mfma_f32_16x16x32_bf16 v[24:27], v[220:223], v[144:147], v[24:27]
    v_exp_f32 v176, v176
    v_exp_f32 v177, v177
    v_mfma_f32_16x16x32_bf16 v[56:59], v[220:223], v[160:163], v[56:59]
    v_exp_f32 v178, v178
    v_exp_f32 v179, v179
    ds_read_b64_tr_b16 v[212:213], v244 offset:24576
    ds_read_b64_tr_b16 v[214:215], v244 offset:28672
    v_mfma_f32_16x16x32_bf16 v[28:31], v[224:227], v[144:147], v[28:31]
    v_cvt_pk_bf16_f32 v176, v176, v177
    v_cvt_pk_bf16_f32 v177, v178, v179
    v_mfma_f32_16x16x32_bf16 v[60:63], v[224:227], v[160:163], v[60:63]
    ds_read_b64_tr_b16 v[216:217], v245 offset:24576
    ds_read_b64_tr_b16 v[218:219], v245 offset:28672
    v_mfma_f32_16x16x32_bf16 v[180:183], v[192:195], v[152:155], v[180:183]
    v_mfma_f32_16x16x32_bf16 v[184:187], v[192:195], v[168:171], v[184:187]
    v_mfma_f32_16x16x16_bf16 v[188:191], v[192:193], v[176:177], v[188:191]
    s_waitcnt lgkmcnt(10)
    v_mfma_f32_16x16x32_bf16 v[0:3], v[228:231], v[152:155], v[0:3]
    v_mfma_f32_16x16x32_bf16 v[32:35], v[228:231], v[168:171], v[32:35]
    ds_read_b64_tr_b16 v[220:221], v246 offset:24576
    ds_read_b64_tr_b16 v[222:223], v246 offset:28672
    v_mfma_f32_16x16x32_bf16 v[4:7], v[196:199], v[152:155], v[4:7]
    v_mfma_f32_16x16x32_bf16 v[36:39], v[196:199], v[168:171], v[36:39]
    v_add_u32 v224, s70, v239
    ds_read_b64_tr_b16 v[224:225], v224 offset:16384
    v_add_u32 v226, s70, v240
    ds_read_b64_tr_b16 v[226:227], v226 offset:16384
    s_waitcnt lgkmcnt(10)
    v_mfma_f32_16x16x32_bf16 v[8:11], v[200:203], v[152:155], v[8:11]
    v_mfma_f32_16x16x32_bf16 v[40:43], v[200:203], v[168:171], v[40:43]
    v_add_u32 v228, s70, v241
    ds_read_b64_tr_b16 v[228:229], v228 offset:16384
    v_add_u32 v230, s70, v242
    ds_read_b64_tr_b16 v[230:231], v230 offset:16384
    v_mfma_f32_16x16x32_bf16 v[12:15], v[204:207], v[152:155], v[12:15]
    v_mfma_f32_16x16x32_bf16 v[44:47], v[204:207], v[168:171], v[44:47]
    v_add_u32 v196, s70, v243
    ds_read_b64_tr_b16 v[196:197], v196 offset:16384
    v_add_u32 v198, s70, v244
    ds_read_b64_tr_b16 v[198:199], v198 offset:16384
    s_waitcnt lgkmcnt(10)
    v_mfma_f32_16x16x32_bf16 v[16:19], v[208:211], v[152:155], v[16:19]
    v_mfma_f32_16x16x32_bf16 v[48:51], v[208:211], v[168:171], v[48:51]
    v_add_u32 v200, s70, v245
    ds_read_b64_tr_b16 v[200:201], v200 offset:16384
    v_add_u32 v202, s70, v246
    ds_read_b64_tr_b16 v[202:203], v202 offset:16384
    v_mfma_f32_16x16x32_bf16 v[20:23], v[212:215], v[152:155], v[20:23]
    v_mfma_f32_16x16x32_bf16 v[52:55], v[212:215], v[168:171], v[52:55]
    s_waitcnt lgkmcnt(8)
    v_mfma_f32_16x16x32_bf16 v[24:27], v[216:219], v[152:155], v[24:27]
    v_mfma_f32_16x16x32_bf16 v[56:59], v[216:219], v[168:171], v[56:59]
    v_mfma_f32_16x16x32_bf16 v[28:31], v[220:223], v[152:155], v[28:31]
    v_mfma_f32_16x16x32_bf16 v[60:63], v[220:223], v[168:171], v[60:63]
    s_waitcnt lgkmcnt(4)
    v_mfma_f32_16x16x16_bf16 v[64:67], v[224:225], v[176:177], v[64:67]
    v_mfma_f32_16x16x16_bf16 v[68:71], v[226:227], v[176:177], v[68:71]
    v_mfma_f32_16x16x16_bf16 v[72:75], v[228:229], v[176:177], v[72:75]
    v_mfma_f32_16x16x16_bf16 v[76:79], v[230:231], v[176:177], v[76:79]
    s_waitcnt lgkmcnt(0)
    v_mfma_f32_16x16x16_bf16 v[80:83], v[196:197], v[176:177], v[80:83]
    v_mfma_f32_16x16x16_bf16 v[84:87], v[198:199], v[176:177], v[84:87]
    v_mfma_f32_16x16x16_bf16 v[88:91], v[200:201], v[176:177], v[88:91]
    v_mfma_f32_16x16x16_bf16 v[92:95], v[202:203], v[176:177], v[92:95]
    s_waitcnt vmcnt(12)
    s_barrier
    s_add_u32 m0, s57, 65536
    s_add_u32 s59, s69, 3
    s_and_b32 s59, s59, 7
    s_lshl_b32 s59, s59, 14
    buffer_load_dwordx4 v248, s[40:43], s59 offen nt lds
    s_add_u32 m0, s57, 69632
    s_add_u32 s59, s59, 4096
    buffer_load_dwordx4 v248, s[40:43], s59 offen nt lds
    s_add_u32 m0, s57, 73728
    s_add_u32 s59, s59, 4096
    buffer_load_dwordx4 v248, s[40:43], s59 offen nt lds
    s_add_u32 m0, s57, 77824
    s_add_u32 s59, s59, 4096
    buffer_load_dwordx4 v248, s[40:43], s59 offen nt lds
L1_redo2:
    ds_read_b128 v[196:199], v235 offset:16384
    ds_read_b128 v[200:203], v236 offset:16384
    ds_read_b128 v[204:207], v237 offset:16384
    ds_read_b128 v[208:211], v238 offset:16384
    ds_read_b128 v[212:215], v235 offset:20480
    ds_read_b128 v[216:219], v236 offset:20480
    ds_read_b128 v[220:223], v237 offset:20480
    ds_read_b128 v[224:227], v238 offset:20480
    s_setprio 2
    s_waitcnt lgkmcnt(4)
    v_mfma_f32_16x16x32_bf16 v[144:147], v[196:199], v[96:99], 0
    v_mfma_f32_16x16x32_bf16 v[160:163], v[196:199], v[112:115], 0
    v_mfma_f32_16x16x32_bf16 v[144:147], v[200:203], v[100:103], v[144:147]
    v_mfma_f32_16x16x32_bf16 v[160:163], v[200:203], v[116:119], v[160:163]
    v_mfma_f32_16x16x32_bf16 v[144:147], v[204:207], v[104:107], v[144:147]
    v_mfma_f32_16x16x32_bf16 v[160:163], v[204:207], v[120:123], v[160:163]
    v_mfma_f32_16x16x32_bf16 v[144:147], v[208:211], v[108:111], v[144:147]
    v_mfma_f32_16x16x32_bf16 v[160:163], v[208:211], v[124:127], v[160:163]
    ds_read_b128 v[196:199], v235 offset:24576
    ds_read_b128 v[200:203], v236 offset:24576
    ds_read_b128 v[204:207], v237 offset:24576
    ds_read_b128 v[208:211], v238 offset:24576
    s_waitcnt lgkmcnt(4)
    v_mfma_f32_16x16x32_bf16 v[148:151], v[212:215], v[96:99], 0
    v_mfma_f32_16x16x32_bf16 v[164:167], v[212:215], v[112:115], 0
    v_mfma_f32_16x16x32_bf16 v[148:151], v[216:219], v[100:103], v[148:151]
    v_max3_f32 v252, v144, v145, v146
    v_max3_f32 v253, v160, v161, v162
    v_max_f32 v252, v252, v147
    v_max_f32 v253, v253, v163
    v_mfma_f32_16x16x32_bf16 v[164:167], v[216:219], v[116:119], v[164:167]
    v_fma_f32 v144, v144, s56, -v232
    v_fma_f32 v145, v145, s56, -v232
    v_fma_f32 v146, v146, s56, -v232
    v_fma_f32 v147, v147, s56, -v232
    v_mfma_f32_16x16x32_bf16 v[148:151], v[220:223], v[104:107], v[148:151]
    v_exp_f32 v144, v144
    v_exp_f32 v145, v145
    v_exp_f32 v146, v146
    v_exp_f32 v147, v147
    v_mfma_f32_16x16x32_bf16 v[164:167], v[220:223], v[120:123], v[164:167]
    v_cvt_pk_bf16_f32 v144, v144, v145
    v_cvt_pk_bf16_f32 v145, v146, v147
    v_fma_f32 v160, v160, s56, -v233
    v_fma_f32 v161, v161, s56, -v233
    v_mfma_f32_16x16x32_bf16 v[148:151], v[224:227], v[108:111], v[148:151]
    v_fma_f32 v162, v162, s56, -v233
    v_fma_f32 v163, v163, s56, -v233
    v_exp_f32 v160, v160
    v_exp_f32 v161, v161
    v_mfma_f32_16x16x32_bf16 v[164:167], v[224:227], v[124:127], v[164:167]
    v_exp_f32 v162, v162
    v_exp_f32 v163, v163
    v_cvt_pk_bf16_f32 v160, v160, v161
    v_cvt_pk_bf16_f32 v161, v162, v163
    ds_read_b128 v[212:215], v235 offset:28672
    ds_read_b128 v[216:219], v236 offset:28672
    ds_read_b128 v[220:223], v237 offset:28672
    ds_read_b128 v[224:227], v238 offset:28672
    s_waitcnt lgkmcnt(4)
    v_mfma_f32_16x16x32_bf16 v[152:155], v[196:199], v[96:99], 0
    v_mfma_f32_16x16x32_bf16 v[168:171], v[196:199], v[112:115], 0
    v_mfma_f32_16x16x32_bf16 v[152:155], v[200:203], v[100:103], v[152:155]
    v_max3_f32 v252, v252, v148, v149
    v_max3_f32 v253, v253, v164, v165
    v_max3_f32 v252, v252, v150, v151
    v_max3_f32 v253, v253, v166, v167
    v_mfma_f32_16x16x32_bf16 v[168:171], v[200:203], v[116:119], v[168:171]
    v_fma_f32 v148, v148, s56, -v232
    v_fma_f32 v149, v149, s56, -v232
    v_fma_f32 v150, v150, s56, -v232
    v_fma_f32 v151, v151, s56, -v232
    v_mfma_f32_16x16x32_bf16 v[152:155], v[204:207], v[104:107], v[152:155]
    v_exp_f32 v148, v148
    v_exp_f32 v149, v149
    v_exp_f32 v150, v150
    v_exp_f32 v151, v151
    v_mfma_f32_16x16x32_bf16 v[168:171], v[204:207], v[120:123], v[168:171]
    v_cvt_pk_bf16_f32 v146, v148, v149
    v_cvt_pk_bf16_f32 v147, v150, v151
    v_fma_f32 v164, v164, s56, -v233
    v_fma_f32 v165, v165, s56, -v233
    v_mfma_f32_16x16x32_bf16 v[152:155], v[208:211], v[108:111], v[152:155]
    v_fma_f32 v166, v166, s56, -v233
    v_fma_f32 v167, v167, s56, -v233
    v_exp_f32 v164, v164
    v_exp_f32 v165, v165
    v_mfma_f32_16x16x32_bf16 v[168:171], v[208:211], v[124:127], v[168:171]
    v_exp_f32 v166, v166
    v_exp_f32 v167, v167
    v_cvt_pk_bf16_f32 v162, v164, v165
    v_cvt_pk_bf16_f32 v163, v166, v167
    v_add_u32 v196, s70, v235
    ds_read_b128 v[196:199], v196 offset:16384
    v_add_u32 v200, s70, v236
    ds_read_b128 v[200:203], v200 offset:16384
    v_add_u32 v204, s70, v237
    ds_read_b128 v[204:207], v204 offset:16384
    v_add_u32 v208, s70, v238
    ds_read_b128 v[208:211], v208 offset:16384
    s_waitcnt lgkmcnt(4)
    v_mfma_f32_16x16x32_bf16 v[156:159], v[212:215], v[96:99], 0
    v_mfma_f32_16x16x32_bf16 v[172:175], v[212:215], v[112:115], 0
    v_mfma_f32_16x16x32_bf16 v[156:159], v[216:219], v[100:103], v[156:159]
    v_max3_f32 v252, v252, v152, v153
    v_max3_f32 v253, v253, v168, v169
    v_max3_f32 v252, v252, v154, v155
    v_max3_f32 v253, v253, v170, v171
    v_mfma_f32_16x16x32_bf16 v[172:175], v[216:219], v[116:119], v[172:175]
    v_fma_f32 v152, v152, s56, -v232
    v_fma_f32 v153, v153, s56, -v232
    v_fma_f32 v154, v154, s56, -v232
    v_fma_f32 v155, v155, s56, -v232
    v_mfma_f32_16x16x32_bf16 v[156:159], v[220:223], v[104:107], v[156:159]
    v_exp_f32 v152, v152
    v_exp_f32 v153, v153
    v_exp_f32 v154, v154
    v_exp_f32 v155, v155
    v_mfma_f32_16x16x32_bf16 v[172:175], v[220:223], v[120:123], v[172:175]
    v_cvt_pk_bf16_f32 v152, v152, v153
    v_cvt_pk_bf16_f32 v153, v154, v155
    v_fma_f32 v168, v168, s56, -v233
    v_fma_f32 v169, v169, s56, -v233
    v_mfma_f32_16x16x32_bf16 v[156:159], v[224:227], v[108:111], v[156:159]
    v_fma_f32 v170, v170, s56, -v233
    v_fma_f32 v171, v171, s56, -v233
    v_exp_f32 v168, v168
    v_exp_f32 v169, v169
    v_mfma_f32_16x16x32_bf16 v[172:175], v[224:227], v[124:127], v[172:175]
    v_exp_f32 v170, v170
    v_exp_f32 v171, v171
    v_cvt_pk_bf16_f32 v168, v168, v169
    v_cvt_pk_bf16_f32 v169, v170, v171
    s_waitcnt lgkmcnt(0)
    v_mfma_f32_16x16x32_bf16 v[176:179], v[196:199], v[128:131], 0
    v_mfma_f32_16x16x32_bf16 v[176:179], v[200:203], v[132:135], v[176:179]
    v_mfma_f32_16x16x32_bf16 v[176:179], v[204:207], v[136:139], v[176:179]
    v_mfma_f32_16x16x32_bf16 v[176:179], v[208:211], v[140:143], v[176:179]
    s_setprio 0
    v_max3_f32 v252, v252, v156, v157
    v_max3_f32 v253, v253, v172, v173
    v_max3_f32 v252, v252, v158, v159
    v_max3_f32 v253, v253, v174, v175
    s_nop 2
    v_max3_f32 v254, v176, v177, v178
    v_max_f32 v254, v254, v179
    v_fma_f32 v249, v252, s56, -v232
    v_fma_f32 v250, v253, s56, -v233
    v_fma_f32 v251, v254, s56, -v234
    v_max3_f32 v249, v249, v250, v251
    v_cmp_lt_f32 s[72:73], s71, v249
    s_nop 1
    s_cmp_lg_u64 s[72:73], 0
    s_cbranch_scc0 L1_nr2
    v_mov_b32 v249, v252
    v_mov_b32 v250, v253
    v_mov_b32 v251, v254
    v_permlane32_swap_b32 v252, v249
    v_permlane32_swap_b32 v253, v250
    v_permlane32_swap_b32 v254, v251
    v_max_f32 v252, v252, v249
    v_max_f32 v253, v253, v250
    v_max_f32 v254, v254, v251
    v_mov_b32 v249, v252
    v_mov_b32 v250, v253
    v_mov_b32 v251, v254
    v_permlane16_swap_b32 v252, v249
    v_permlane16_swap_b32 v253, v250
    v_permlane16_swap_b32 v254, v251
    v_max_f32 v252, v252, v249
    v_max_f32 v253, v253, v250
    v_max_f32 v254, v254, v251
    v_mul_f32 v252, s56, v252
    v_max_f32 v252, v252, v232
    v_sub_f32 v249, v232, v252
    v_exp_f32 v249, v249
    v_mov_b32 v232, v252
    v_mul_f32 v0, v0, v249
    v_mul_f32 v1, v1, v249
    v_mul_f32 v2, v2, v249
    v_mul_f32 v3, v3, v249
    v_mul_f32 v4, v4, v249
    v_mul_f32 v5, v5, v249
    v_mul_f32 v6, v6, v249
    v_mul_f32 v7, v7, v249
    v_mul_f32 v8, v8, v249
    v_mul_f32 v9, v9, v249
    v_mul_f32 v10, v10, v249
    v_mul_f32 v11, v11, v249
    v_mul_f32 v12, v12, v249
    v_mul_f32 v13, v13, v249
    v_mul_f32 v14, v14, v249
    v_mul_f32 v15, v15, v249
    v_mul_f32 v16, v16, v249
    v_mul_f32 v17, v17, v249
    v_mul_f32 v18, v18, v249
    v_mul_f32 v19, v19, v249
    v_mul_f32 v20, v20, v249
    v_mul_f32 v21, v21, v249
    v_mul_f32 v22, v22, v249
    v_mul_f32 v23, v23, v249
    v_mul_f32 v24, v24, v249
    v_mul_f32 v25, v25, v249
    v_mul_f32 v26, v26, v249
    v_mul_f32 v27, v27, v249
    v_mul_f32 v28, v28, v249
    v_mul_f32 v29, v29, v249
    v_mul_f32 v30, v30, v249
    v_mul_f32 v31, v31, v249
    v_mul_f32 v180, v180, v249
    v_mul_f32 v181, v181, v249
    v_mul_f32 v182, v182, v249
    v_mul_f32 v183, v183, v249
    v_mul_f32 v253, s56, v253
    v_max_f32 v253, v253, v233
    v_sub_f32 v249, v233, v253
    v_exp_f32 v249, v249
    v_mov_b32 v233, v253
    v_mul_f32 v32, v32, v249
    v_mul_f32 v33, v33, v249
    v_mul_f32 v34, v34, v249
    v_mul_f32 v35, v35, v249
    v_mul_f32 v36, v36, v249
    v_mul_f32 v37, v37, v249
    v_mul_f32 v38, v38, v249
    v_mul_f32 v39, v39, v249
    v_mul_f32 v40, v40, v249
    v_mul_f32 v41, v41, v249
    v_mul_f32 v42, v42, v249
    v_mul_f32 v43, v43, v249
    v_mul_f32 v44, v44, v249
    v_mul_f32 v45, v45, v249
    v_mul_f32 v46, v46, v249
    v_mul_f32 v47, v47, v249
    v_mul_f32 v48, v48, v249
    v_mul_f32 v49, v49, v249
    v_mul_f32 v50, v50, v249
    v_mul_f32 v51, v51, v249
    v_mul_f32 v52, v52, v249
    v_mul_f32 v53, v53, v249
    v_mul_f32 v54, v54, v249
    v_mul_f32 v55, v55, v249
    v_mul_f32 v56, v56, v249
    v_mul_f32 v57, v57, v249
    v_mul_f32 v58, v58, v249
    v_mul_f32 v59, v59, v249
    v_mul_f32 v60, v60, v249
    v_mul_f32 v61, v61, v249
    v_mul_f32 v62, v62, v249
    v_mul_f32 v63, v63, v249
    v_mul_f32 v184, v184, v249
    v_mul_f32 v185, v185, v249
    v_mul_f32 v186, v186, v249
    v_mul_f32 v187, v187, v249
    v_mul_f32 v254, s56, v254
    v_max_f32 v254, v254, v234
    v_sub_f32 v249, v234, v254
    v_exp_f32 v249, v249
    v_mov_b32 v234, v254
    v_mul_f32 v64, v64, v249
    v_mul_f32 v65, v65, v249
    v_mul_f32 v66, v66, v249
    v_mul_f32 v67, v67, v249
    v_mul_f32 v68, v68, v249
    v_mul_f32 v69, v69, v249
    v_mul_f32 v70, v70, v249
    v_mul_f32 v71, v71, v249
    v_mul_f32 v72, v72, v249
    v_mul_f32 v73, v73, v249
    v_mul_f32 v74, v74, v249
    v_mul_f32 v75, v75, v249
    v_mul_f32 v76, v76, v249
    v_mul_f32 v77, v77, v249
    v_mul_f32 v78, v78, v249
    v_mul_f32 v79, v79, v249
    v_mul_f32 v80, v80, v249
    v_mul_f32 v81, v81, v249
    v_mul_f32 v82, v82, v249
    v_mul_f32 v83, v83, v249
    v_mul_f32 v84, v84, v249
    v_mul_f32 v85, v85, v249
    v_mul_f32 v86, v86, v249
    v_mul_f32 v87, v87, v249
    v_mul_f32 v88, v88, v249
    v_mul_f32 v89, v89, v249
    v_mul_f32 v90, v90, v249
    v_mul_f32 v91, v91, v249
    v_mul_f32 v92, v92, v249
    v_mul_f32 v93, v93, v249
    v_mul_f32 v94, v94, v249
    v_mul_f32 v95, v95, v249
    v_mul_f32 v188, v188, v249
    v_mul_f32 v189, v189, v249
    v_mul_f32 v190, v190, v249
    v_mul_f32 v191, v191, v249
    s_nop 1
    s_branch L1_redo2
L1_nr2:
    s_waitcnt vmcnt(8)
    s_barrier
    ds_read_b64_tr_b16 v[196:197], v239 offset:0
    ds_read_b64_tr_b16 v[198:199], v239 offset:4096
    ds_read_b64_tr_b16 v[200:201], v240 offset:0
    ds_read_b64_tr_b16 v[202:203], v240 offset:4096
    ds_read_b64_tr_b16 v[204:205], v241 offset:0
    ds_read_b64_tr_b16 v[206:207], v241 offset:4096
    ds_read_b64_tr_b16 v[208:209], v242 offset:0
    ds_read_b64_tr_b16 v[210:211], v242 offset:4096
    ds_read_b64_tr_b16 v[212:213], v243 offset:0
    ds_read_b64_tr_b16 v[214:215], v243 offset:4096
    ds_read_b64_tr_b16 v[216:217], v244 offset:0
    ds_read_b64_tr_b16 v[218:219], v244 offset:4096
    ds_read_b64_tr_b16 v[220:221], v245 offset:0
    ds_read_b64_tr_b16 v[222:223], v245 offset:4096
    s_add_u32 m0, s57, 16384
    s_add_u32 s59, s69, 5
    s_and_b32 s59, s59, 7
    s_lshl_b32 s59, s59, 14
    buffer_load_dwordx4 v247, s[36:39], s59 offen nt lds
    s_add_u32 m0, s57, 20480
    s_add_u32 s59, s59, 4096
    buffer_load_dwordx4 v247, s[36:39], s59 offen nt lds
    s_add_u32 m0, s57, 24576
    s_add_u32 s59, s59, 4096
    buffer_load_dwordx4 v247, s[36:39], s59 offen nt lds
    s_add_u32 m0, s57, 28672
    s_add_u32 s59, s59, 4096
    buffer_load_dwordx4 v247, s[36:39], s59 offen nt lds
    s_setprio 2
    v_mfma_f32_16x16x32_bf16 v[180:183], v[192:195], v[144:147], v[180:183]
    v_mfma_f32_16x16x32_bf16 v[184:187], v[192:195], v[160:163], v[184:187]
    s_waitcnt lgkmcnt(10)
    v_mfma_f32_16x16x32_bf16 v[0:3], v[196:199], v[144:147], v[0:3]
    v_fma_f32 v156, v156, s56, -v232
    v_fma_f32 v157, v157, s56, -v232
    v_mfma_f32_16x16x32_bf16 v[32:35], v[196:199], v[160:163], v[32:35]
    v_fma_f32 v158, v158, s56, -v232
    v_fma_f32 v159, v159, s56, -v232
    ds_read_b64_tr_b16 v[224:225], v246 offset:0
    ds_read_b64_tr_b16 v[226:227], v246 offset:4096
    v_mfma_f32_16x16x32_bf16 v[4:7], v[200:203], v[144:147], v[4:7]
    v_exp_f32 v156, v156
    v_exp_f32 v157, v157
    v_mfma_f32_16x16x32_bf16 v[36:39], v[200:203], v[160:163], v[36:39]
    v_exp_f32 v158, v158
    v_exp_f32 v159, v159
    ds_read_b64_tr_b16 v[228:229], v239 offset:8192
    ds_read_b64_tr_b16 v[230:231], v239 offset:12288
    s_waitcnt lgkmcnt(10)
    v_mfma_f32_16x16x32_bf16 v[8:11], v[204:207], v[144:147], v[8:11]
    v_cvt_pk_bf16_f32 v154, v156, v157
    v_cvt_pk_bf16_f32 v155, v158, v159
    v_mfma_f32_16x16x32_bf16 v[40:43], v[204:207], v[160:163], v[40:43]
    v_fma_f32 v172, v172, s56, -v233
    v_fma_f32 v173, v173, s56, -v233
    ds_read_b64_tr_b16 v[196:197], v240 offset:8192
    ds_read_b64_tr_b16 v[198:199], v240 offset:12288
    v_mfma_f32_16x16x32_bf16 v[12:15], v[208:211], v[144:147], v[12:15]
    v_fma_f32 v174, v174, s56, -v233
    v_fma_f32 v175, v175, s56, -v233
    v_mfma_f32_16x16x32_bf16 v[44:47], v[208:211], v[160:163], v[44:47]
    v_exp_f32 v172, v172
    v_exp_f32 v173, v173
    ds_read_b64_tr_b16 v[200:201], v241 offset:8192
    ds_read_b64_tr_b16 v[202:203], v241 offset:12288
    s_waitcnt lgkmcnt(10)
    v_mfma_f32_16x16x32_bf16 v[16:19], v[212:215], v[144:147], v[16:19]
    v_exp_f32 v174, v174
    v_exp_f32 v175, v175
    v_mfma_f32_16x16x32_bf16 v[48:51], v[212:215], v[160:163], v[48:51]
    v_cvt_pk_bf16_f32 v170, v172, v173
    v_cvt_pk_bf16_f32 v171, v174, v175
    ds_read_b64_tr_b16 v[204:205], v242 offset:8192
    ds_read_b64_tr_b16 v[206:207], v242 offset:12288
    v_mfma_f32_16x16x32_bf16 v[20:23], v[216:219], v[144:147], v[20:23]
    v_fma_f32 v176, v176, s56, -v234
    v_fma_f32 v177, v177, s56, -v234
    v_mfma_f32_16x16x32_bf16 v[52:55], v[216:219], v[160:163], v[52:55]
    v_fma_f32 v178, v178, s56, -v234
    v_fma_f32 v179, v179, s56, -v234
    ds_read_b64_tr_b16 v[208:209], v243 offset:8192
    ds_read_b64_tr_b16 v[210:211], v243 offset:12288
    s_waitcnt lgkmcnt(10)
    v_mfma_f32_16x16x32_bf16 v[24:27], v[220:223], v[144:147], v[24:27]
    v_exp_f32 v176, v176
    v_exp_f32 v177, v177
    v_mfma_f32_16x16x32_bf16 v[56:59], v[220:223], v[160:163], v[56:59]
    v_exp_f32 v178, v178
    v_exp_f32 v179, v179
    ds_read_b64_tr_b16 v[212:213], v244 offset:8192
    ds_read_b64_tr_b16 v[214:215], v244 offset:12288
    v_mfma_f32_16x16x32_bf16 v[28:31], v[224:227], v[144:147], v[28:31]
    v_cvt_pk_bf16_f32 v176, v176, v177
    v_cvt_pk_bf16_f32 v177, v178, v179
    v_mfma_f32_16x16x32_bf16 v[60:63], v[224:227], v[160:163], v[60:63]
    ds_read_b64_tr_b16 v[216:217], v245 offset:8192
    ds_read_b64_tr_b16 v[218:219], v245 offset:12288
    v_mfma_f32_16x16x32_bf16 v[180:183], v[192:195], v[152:155], v[180:183]
    v_mfma_f32_16x16x32_bf16 v[184:187], v[192:195], v[168:171], v[184:187]
    v_mfma_f32_16x16x16_bf16 v[188:191], v[192:193], v[176:177], v[188:191]
    s_waitcnt lgkmcnt(10)
    v_mfma_f32_16x16x32_bf16 v[0:3], v[228:231], v[152:155], v[0:3]
    v_mfma_f32_16x16x32_bf16 v[32:35], v[228:231], v[168:171], v[32:35]
    ds_read_b64_tr_b16 v[220:221], v246 offset:8192
    ds_read_b64_tr_b16 v[222:223], v246 offset:12288
    v_mfma_f32_16x16x32_bf16 v[4:7], v[196:199], v[152:155], v[4:7]
    v_mfma_f32_16x16x32_bf16 v[36:39], v[196:199], v[168:171], v[36:39]
    v_add_u32 v224, s70, v239
    ds_read_b64_tr_b16 v[224:225], v224 offset:0
    v_add_u32 v226, s70, v240
    ds_read_b64_tr_b16 v[226:227], v226 offset:0
    s_waitcnt lgkmcnt(10)
    v_mfma_f32_16x16x32_bf16 v[8:11], v[200:203], v[152:155], v[8:11]
    v_mfma_f32_16x16x32_bf16 v[40:43], v[200:203], v[168:171], v[40:43]
    v_add_u32 v228, s70, v241
    ds_read_b64_tr_b16 v[228:229], v228 offset:0
    v_add_u32 v230, s70, v242
    ds_read_b64_tr_b16 v[230:231], v230 offset:0
    v_mfma_f32_16x16x32_bf16 v[12:15], v[204:207], v[152:155], v[12:15]
    v_mfma_f32_16x16x32_bf16 v[44:47], v[204:207], v[168:171], v[44:47]
    v_add_u32 v196, s70, v243
    ds_read_b64_tr_b16 v[196:197], v196 offset:0
    v_add_u32 v198, s70, v244
    ds_read_b64_tr_b16 v[198:199], v198 offset:0
    s_waitcnt lgkmcnt(10)
    v_mfma_f32_16x16x32_bf16 v[16:19], v[208:211], v[152:155], v[16:19]
    v_mfma_f32_16x16x32_bf16 v[48:51], v[208:211], v[168:171], v[48:51]
    v_add_u32 v200, s70, v245
    ds_read_b64_tr_b16 v[200:201], v200 offset:0
    v_add_u32 v202, s70, v246
    ds_read_b64_tr_b16 v[202:203], v202 offset:0
    v_mfma_f32_16x16x32_bf16 v[20:23], v[212:215], v[152:155], v[20:23]
    v_mfma_f32_16x16x32_bf16 v[52:55], v[212:215], v[168:171], v[52:55]
    s_waitcnt lgkmcnt(8)
    v_mfma_f32_16x16x32_bf16 v[24:27], v[216:219], v[152:155], v[24:27]
    v_mfma_f32_16x16x32_bf16 v[56:59], v[216:219], v[168:171], v[56:59]
    v_mfma_f32_16x16x32_bf16 v[28:31], v[220:223], v[152:155], v[28:31]
    v_mfma_f32_16x16x32_bf16 v[60:63], v[220:223], v[168:171], v[60:63]
    s_waitcnt lgkmcnt(4)
    v_mfma_f32_16x16x16_bf16 v[64:67], v[224:225], v[176:177], v[64:67]
    v_mfma_f32_16x16x16_bf16 v[68:71], v[226:227], v[176:177], v[68:71]
    v_mfma_f32_16x16x16_bf16 v[72:75], v[228:229], v[176:177], v[72:75]
    v_mfma_f32_16x16x16_bf16 v[76:79], v[230:231], v[176:177], v[76:79]
    s_waitcnt lgkmcnt(0)
    v_mfma_f32_16x16x16_bf16 v[80:83], v[196:197], v[176:177], v[80:83]
    v_mfma_f32_16x16x16_bf16 v[84:87], v[198:199], v[176:177], v[84:87]
    v_mfma_f32_16x16x16_bf16 v[88:91], v[200:201], v[176:177], v[88:91]
    v_mfma_f32_16x16x16_bf16 v[92:95], v[202:203], v[176:177], v[92:95]
    s_waitcnt vmcnt(12)
    s_barrier
    s_add_u32 m0, s57, 49152
    s_add_u32 s59, s69, 4
    s_and_b32 s59, s59, 7
    s_lshl_b32 s59, s59, 14
    buffer_load_dwordx4 v248, s[40:43], s59 offen nt lds
    s_add_u32 m0, s57, 53248
    s_add_u32 s59, s59, 4096
    buffer_load_dwordx4 v248, s[40:43], s59 offen nt lds
    s_add_u32 m0, s57, 57344
    s_add_u32 s59, s59, 4096
    buffer_load_dwordx4 v248, s[40:43], s59 offen nt lds
    s_add_u32 m0, s57, 61440
    s_add_u32 s59, s59, 4096
    buffer_load_dwordx4 v248, s[40:43], s59 offen nt lds
L1_redo3:
    ds_read_b128 v[196:199], v235 offset:32768
    ds_read_b128 v[200:203], v236 offset:32768
    ds_read_b128 v[204:207], v237 offset:32768
    ds_read_b128 v[208:211], v238 offset:32768
    ds_read_b128 v[212:215], v235 offset:36864
    ds_read_b128 v[216:219], v236 offset:36864
    ds_read_b128 v[220:223], v237 offset:36864
    ds_read_b128 v[224:227], v238 offset:36864
    s_setprio 2
    s_waitcnt lgkmcnt(4)
    v_mfma_f32_16x16x32_bf16 v[144:147], v[196:199], v[96:99], 0
    v_mfma_f32_16x16x32_bf16 v[160:163], v[196:199], v[112:115], 0
    v_mfma_f32_16x16x32_bf16 v[144:147], v[200:203], v[100:103], v[144:147]
    v_mfma_f32_16x16x32_bf16 v[160:163], v[200:203], v[116:119], v[160:163]
    v_mfma_f32_16x16x32_bf16 v[144:147], v[204:207], v[104:107], v[144:147]
    v_mfma_f32_16x16x32_bf16 v[160:163], v[204:207], v[120:123], v[160:163]
    v_mfma_f32_16x16x32_bf16 v[144:147], v[208:211], v[108:111], v[144:147]
    v_mfma_f32_16x16x32_bf16 v[160:163], v[208:211], v[124:127], v[160:163]
    ds_read_b128 v[196:199], v235 offset:40960
    ds_read_b128 v[200:203], v236 offset:40960
    ds_read_b128 v[204:207], v237 offset:40960
    ds_read_b128 v[208:211], v238 offset:40960
    s_waitcnt lgkmcnt(4)
    v_mfma_f32_16x16x32_bf16 v[148:151], v[212:215], v[96:99], 0
    v_mfma_f32_16x16x32_bf16 v[164:167], v[212:215], v[112:115], 0
    v_mfma_f32_16x16x32_bf16 v[148:151], v[216:219], v[100:103], v[148:151]
    v_max3_f32 v252, v144, v145, v146
    v_max3_f32 v253, v160, v161, v162
    v_max_f32 v252, v252, v147
    v_max_f32 v253, v253, v163
    v_mfma_f32_16x16x32_bf16 v[164:167], v[216:219], v[116:119], v[164:167]
    v_fma_f32 v144, v144, s56, -v232
    v_fma_f32 v145, v145, s56, -v232
    v_fma_f32 v146, v146, s56, -v232
    v_fma_f32 v147, v147, s56, -v232
    v_mfma_f32_16x16x32_bf16 v[148:151], v[220:223], v[104:107], v[148:151]
    v_exp_f32 v144, v144
    v_exp_f32 v145, v145
    v_exp_f32 v146, v146
    v_exp_f32 v147, v147
    v_mfma_f32_16x16x32_bf16 v[164:167], v[220:223], v[120:123], v[164:167]
    v_cvt_pk_bf16_f32 v144, v144, v145
    v_cvt_pk_bf16_f32 v145, v146, v147
    v_fma_f32 v160, v160, s56, -v233
    v_fma_f32 v161, v161, s56, -v233
    v_mfma_f32_16x16x32_bf16 v[148:151], v[224:227], v[108:111], v[148:151]
    v_fma_f32 v162, v162, s56, -v233
    v_fma_f32 v163, v163, s56, -v233
    v_exp_f32 v160, v160
    v_exp_f32 v161, v161
    v_mfma_f32_16x16x32_bf16 v[164:167], v[224:227], v[124:127], v[164:167]
    v_exp_f32 v162, v162
    v_exp_f32 v163, v163
    v_cvt_pk_bf16_f32 v160, v160, v161
    v_cvt_pk_bf16_f32 v161, v162, v163
    ds_read_b128 v[212:215], v235 offset:45056
    ds_read_b128 v[216:219], v236 offset:45056
    ds_read_b128 v[220:223], v237 offset:45056
    ds_read_b128 v[224:227], v238 offset:45056
    s_waitcnt lgkmcnt(4)
    v_mfma_f32_16x16x32_bf16 v[152:155], v[196:199], v[96:99], 0
    v_mfma_f32_16x16x32_bf16 v[168:171], v[196:199], v[112:115], 0
    v_mfma_f32_16x16x32_bf16 v[152:155], v[200:203], v[100:103], v[152:155]
    v_max3_f32 v252, v252, v148, v149
    v_max3_f32 v253, v253, v164, v165
    v_max3_f32 v252, v252, v150, v151
    v_max3_f32 v253, v253, v166, v167
    v_mfma_f32_16x16x32_bf16 v[168:171], v[200:203], v[116:119], v[168:171]
    v_fma_f32 v148, v148, s56, -v232
    v_fma_f32 v149, v149, s56, -v232
    v_fma_f32 v150, v150, s56, -v232
    v_fma_f32 v151, v151, s56, -v232
    v_mfma_f32_16x16x32_bf16 v[152:155], v[204:207], v[104:107], v[152:155]
    v_exp_f32 v148, v148
    v_exp_f32 v149, v149
    v_exp_f32 v150, v150
    v_exp_f32 v151, v151
    v_mfma_f32_16x16x32_bf16 v[168:171], v[204:207], v[120:123], v[168:171]
    v_cvt_pk_bf16_f32 v146, v148, v149
    v_cvt_pk_bf16_f32 v147, v150, v151
    v_fma_f32 v164, v164, s56, -v233
    v_fma_f32 v165, v165, s56, -v233
    v_mfma_f32_16x16x32_bf16 v[152:155], v[208:211], v[108:111], v[152:155]
    v_fma_f32 v166, v166, s56, -v233
    v_fma_f32 v167, v167, s56, -v233
    v_exp_f32 v164, v164
    v_exp_f32 v165, v165
    v_mfma_f32_16x16x32_bf16 v[168:171], v[208:211], v[124:127], v[168:171]
    v_exp_f32 v166, v166
    v_exp_f32 v167, v167
    v_cvt_pk_bf16_f32 v162, v164, v165
    v_cvt_pk_bf16_f32 v163, v166, v167
    v_add_u32 v196, s70, v235
    ds_read_b128 v[196:199], v196 offset:32768
    v_add_u32 v200, s70, v236
    ds_read_b128 v[200:203], v200 offset:32768
    v_add_u32 v204, s70, v237
    ds_read_b128 v[204:207], v204 offset:32768
    v_add_u32 v208, s70, v238
    ds_read_b128 v[208:211], v208 offset:32768
    s_waitcnt lgkmcnt(4)
    v_mfma_f32_16x16x32_bf16 v[156:159], v[212:215], v[96:99], 0
    v_mfma_f32_16x16x32_bf16 v[172:175], v[212:215], v[112:115], 0
    v_mfma_f32_16x16x32_bf16 v[156:159], v[216:219], v[100:103], v[156:159]
    v_max3_f32 v252, v252, v152, v153
    v_max3_f32 v253, v253, v168, v169
    v_max3_f32 v252, v252, v154, v155
    v_max3_f32 v253, v253, v170, v171
    v_mfma_f32_16x16x32_bf16 v[172:175], v[216:219], v[116:119], v[172:175]
    v_fma_f32 v152, v152, s56, -v232
    v_fma_f32 v153, v153, s56, -v232
    v_fma_f32 v154, v154, s56, -v232
    v_fma_f32 v155, v155, s56, -v232
    v_mfma_f32_16x16x32_bf16 v[156:159], v[220:223], v[104:107], v[156:159]
    v_exp_f32 v152, v152
    v_exp_f32 v153, v153
    v_exp_f32 v154, v154
    v_exp_f32 v155, v155
    v_mfma_f32_16x16x32_bf16 v[172:175], v[220:223], v[120:123], v[172:175]
    v_cvt_pk_bf16_f32 v152, v152, v153
    v_cvt_pk_bf16_f32 v153, v154, v155
    v_fma_f32 v168, v168, s56, -v233
    v_fma_f32 v169, v169, s56, -v233
    v_mfma_f32_16x16x32_bf16 v[156:159], v[224:227], v[108:111], v[156:159]
    v_fma_f32 v170, v170, s56, -v233
    v_fma_f32 v171, v171, s56, -v233
    v_exp_f32 v168, v168
    v_exp_f32 v169, v169
    v_mfma_f32_16x16x32_bf16 v[172:175], v[224:227], v[124:127], v[172:175]
    v_exp_f32 v170, v170
    v_exp_f32 v171, v171
    v_cvt_pk_bf16_f32 v168, v168, v169
    v_cvt_pk_bf16_f32 v169, v170, v171
    s_waitcnt lgkmcnt(0)
    v_mfma_f32_16x16x32_bf16 v[176:179], v[196:199], v[128:131], 0
    v_mfma_f32_16x16x32_bf16 v[176:179], v[200:203], v[132:135], v[176:179]
    v_mfma_f32_16x16x32_bf16 v[176:179], v[204:207], v[136:139], v[176:179]
    v_mfma_f32_16x16x32_bf16 v[176:179], v[208:211], v[140:143], v[176:179]
    s_setprio 0
    v_max3_f32 v252, v252, v156, v157
    v_max3_f32 v253, v253, v172, v173
    v_max3_f32 v252, v252, v158, v159
    v_max3_f32 v253, v253, v174, v175
    s_nop 2
    v_max3_f32 v254, v176, v177, v178
    v_max_f32 v254, v254, v179
    v_fma_f32 v249, v252, s56, -v232
    v_fma_f32 v250, v253, s56, -v233
    v_fma_f32 v251, v254, s56, -v234
    v_max3_f32 v249, v249, v250, v251
    v_cmp_lt_f32 s[72:73], s71, v249
    s_nop 1
    s_cmp_lg_u64 s[72:73], 0
    s_cbranch_scc0 L1_nr3
    v_mov_b32 v249, v252
    v_mov_b32 v250, v253
    v_mov_b32 v251, v254
    v_permlane32_swap_b32 v252, v249
    v_permlane32_swap_b32 v253, v250
    v_permlane32_swap_b32 v254, v251
    v_max_f32 v252, v252, v249
    v_max_f32 v253, v253, v250
    v_max_f32 v254, v254, v251
    v_mov_b32 v249, v252
    v_mov_b32 v250, v253
    v_mov_b32 v251, v254
    v_permlane16_swap_b32 v252, v249
    v_permlane16_swap_b32 v253, v250
    v_permlane16_swap_b32 v254, v251
    v_max_f32 v252, v252, v249
    v_max_f32 v253, v253, v250
    v_max_f32 v254, v254, v251
    v_mul_f32 v252, s56, v252
    v_max_f32 v252, v252, v232
    v_sub_f32 v249, v232, v252
    v_exp_f32 v249, v249
    v_mov_b32 v232, v252
    v_mul_f32 v0, v0, v249
    v_mul_f32 v1, v1, v249
    v_mul_f32 v2, v2, v249
    v_mul_f32 v3, v3, v249
    v_mul_f32 v4, v4, v249
    v_mul_f32 v5, v5, v249
    v_mul_f32 v6, v6, v249
    v_mul_f32 v7, v7, v249
    v_mul_f32 v8, v8, v249
    v_mul_f32 v9, v9, v249
    v_mul_f32 v10, v10, v249
    v_mul_f32 v11, v11, v249
    v_mul_f32 v12, v12, v249
    v_mul_f32 v13, v13, v249
    v_mul_f32 v14, v14, v249
    v_mul_f32 v15, v15, v249
    v_mul_f32 v16, v16, v249
    v_mul_f32 v17, v17, v249
    v_mul_f32 v18, v18, v249
    v_mul_f32 v19, v19, v249
    v_mul_f32 v20, v20, v249
    v_mul_f32 v21, v21, v249
    v_mul_f32 v22, v22, v249
    v_mul_f32 v23, v23, v249
    v_mul_f32 v24, v24, v249
    v_mul_f32 v25, v25, v249
    v_mul_f32 v26, v26, v249
    v_mul_f32 v27, v27, v249
    v_mul_f32 v28, v28, v249
    v_mul_f32 v29, v29, v249
    v_mul_f32 v30, v30, v249
    v_mul_f32 v31, v31, v249
    v_mul_f32 v180, v180, v249
    v_mul_f32 v181, v181, v249
    v_mul_f32 v182, v182, v249
    v_mul_f32 v183, v183, v249
    v_mul_f32 v253, s56, v253
    v_max_f32 v253, v253, v233
    v_sub_f32 v249, v233, v253
    v_exp_f32 v249, v249
    v_mov_b32 v233, v253
    v_mul_f32 v32, v32, v249
    v_mul_f32 v33, v33, v249
    v_mul_f32 v34, v34, v249
    v_mul_f32 v35, v35, v249
    v_mul_f32 v36, v36, v249
    v_mul_f32 v37, v37, v249
    v_mul_f32 v38, v38, v249
    v_mul_f32 v39, v39, v249
    v_mul_f32 v40, v40, v249
    v_mul_f32 v41, v41, v249
    v_mul_f32 v42, v42, v249
    v_mul_f32 v43, v43, v249
    v_mul_f32 v44, v44, v249
    v_mul_f32 v45, v45, v249
    v_mul_f32 v46, v46, v249
    v_mul_f32 v47, v47, v249
    v_mul_f32 v48, v48, v249
    v_mul_f32 v49, v49, v249
    v_mul_f32 v50, v50, v249
    v_mul_f32 v51, v51, v249
    v_mul_f32 v52, v52, v249
    v_mul_f32 v53, v53, v249
    v_mul_f32 v54, v54, v249
    v_mul_f32 v55, v55, v249
    v_mul_f32 v56, v56, v249
    v_mul_f32 v57, v57, v249
    v_mul_f32 v58, v58, v249
    v_mul_f32 v59, v59, v249
    v_mul_f32 v60, v60, v249
    v_mul_f32 v61, v61, v249
    v_mul_f32 v62, v62, v249
    v_mul_f32 v63, v63, v249
    v_mul_f32 v184, v184, v249
    v_mul_f32 v185, v185, v249
    v_mul_f32 v186, v186, v249
    v_mul_f32 v187, v187, v249
    v_mul_f32 v254, s56, v254
    v_max_f32 v254, v254, v234
    v_sub_f32 v249, v234, v254
    v_exp_f32 v249, v249
    v_mov_b32 v234, v254
    v_mul_f32 v64, v64, v249
    v_mul_f32 v65, v65, v249
    v_mul_f32 v66, v66, v249
    v_mul_f32 v67, v67, v249
    v_mul_f32 v68, v68, v249
    v_mul_f32 v69, v69, v249
    v_mul_f32 v70, v70, v249
    v_mul_f32 v71, v71, v249
    v_mul_f32 v72, v72, v249
    v_mul_f32 v73, v73, v249
    v_mul_f32 v74, v74, v249
    v_mul_f32 v75, v75, v249
    v_mul_f32 v76, v76, v249
    v_mul_f32 v77, v77, v249
    v_mul_f32 v78, v78, v249
    v_mul_f32 v79, v79, v249
    v_mul_f32 v80, v80, v249
    v_mul_f32 v81, v81, v249
    v_mul_f32 v82, v82, v249
    v_mul_f32 v83, v83, v249
    v_mul_f32 v84, v84, v249
    v_mul_f32 v85, v85, v249
    v_mul_f32 v86, v86, v249
    v_mul_f32 v87, v87, v249
    v_mul_f32 v88, v88, v249
    v_mul_f32 v89, v89, v249
    v_mul_f32 v90, v90, v249
    v_mul_f32 v91, v91, v249
    v_mul_f32 v92, v92, v249
    v_mul_f32 v93, v93, v249
    v_mul_f32 v94, v94, v249
    v_mul_f32 v95, v95, v249
    v_mul_f32 v188, v188, v249
    v_mul_f32 v189, v189, v249
    v_mul_f32 v190, v190, v249
    v_mul_f32 v191, v191, v249
    s_nop 1
    s_branch L1_redo3
L1_nr3:
    s_waitcnt vmcnt(8)
    s_barrier
    ds_read_b64_tr_b16 v[196:197], v239 offset:16384
    ds_read_b64_tr_b16 v[198:199], v239 offset:20480
    ds_read_b64_tr_b16 v[200:201], v240 offset:16384
    ds_read_b64_tr_b16 v[202:203], v240 offset:20480
    ds_read_b64_tr_b16 v[204:205], v241 offset:16384
    ds_read_b64_tr_b16 v[206:207], v241 offset:20480
    ds_read_b64_tr_b16 v[208:209], v242 offset:16384
    ds_read_b64_tr_b16 v[210:211], v242 offset:20480
    ds_read_b64_tr_b16 v[212:213], v243 offset:16384
    ds_read_b64_tr_b16 v[214:215], v243 offset:20480
    ds_read_b64_tr_b16 v[216:217], v244 offset:16384
    ds_read_b64_tr_b16 v[218:219], v244 offset:20480
    ds_read_b64_tr_b16 v[220:221], v245 offset:16384
    ds_read_b64_tr_b16 v[222:223], v245 offset:20480
    s_add_u32 m0, s57, 32768
    s_add_u32 s59, s69, 6
    s_and_b32 s59, s59, 7
    s_lshl_b32 s59, s59, 14
    buffer_load_dwordx4 v247, s[36:39], s59 offen nt lds
    s_add_u32 m0, s57, 36864
    s_add_u32 s59, s59, 4096
    buffer_load_dwordx4 v247, s[36:39], s59 offen nt lds
    s_add_u32 m0, s57, 40960
    s_add_u32 s59, s59, 4096
    buffer_load_dwordx4 v247, s[36:39], s59 offen nt lds
    s_add_u32 m0, s57, 45056
    s_add_u32 s59, s59, 4096
    buffer_load_dwordx4 v247, s[36:39], s59 offen nt lds
    s_setprio 2
    v_mfma_f32_16x16x32_bf16 v[180:183], v[192:195], v[144:147], v[180:183]
    v_mfma_f32_16x16x32_bf16 v[184:187], v[192:195], v[160:163], v[184:187]
    s_waitcnt lgkmcnt(10)
    v_mfma_f32_16x16x32_bf16 v[0:3], v[196:199], v[144:147], v[0:3]
    v_fma_f32 v156, v156, s56, -v232
    v_fma_f32 v157, v157, s56, -v232
    v_mfma_f32_16x16x32_bf16 v[32:35], v[196:199], v[160:163], v[32:35]
    v_fma_f32 v158, v158, s56, -v232
    v_fma_f32 v159, v159, s56, -v232
    ds_read_b64_tr_b16 v[224:225], v246 offset:16384
    ds_read_b64_tr_b16 v[226:227], v246 offset:20480
    v_mfma_f32_16x16x32_bf16 v[4:7], v[200:203], v[144:147], v[4:7]
    v_exp_f32 v156, v156
    v_exp_f32 v157, v157
    v_mfma_f32_16x16x32_bf16 v[36:39], v[200:203], v[160:163], v[36:39]
    v_exp_f32 v158, v158
    v_exp_f32 v159, v159
    ds_read_b64_tr_b16 v[228:229], v239 offset:24576
    ds_read_b64_tr_b16 v[230:231], v239 offset:28672
    s_waitcnt lgkmcnt(10)
    v_mfma_f32_16x16x32_bf16 v[8:11], v[204:207], v[144:147], v[8:11]
    v_cvt_pk_bf16_f32 v154, v156, v157
    v_cvt_pk_bf16_f32 v155, v158, v159
    v_mfma_f32_16x16x32_bf16 v[40:43], v[204:207], v[160:163], v[40:43]
    v_fma_f32 v172, v172, s56, -v233
    v_fma_f32 v173, v173, s56, -v233
    ds_read_b64_tr_b16 v[196:197], v240 offset:24576
    ds_read_b64_tr_b16 v[198:199], v240 offset:28672
    v_mfma_f32_16x16x32_bf16 v[12:15], v[208:211], v[144:147], v[12:15]
    v_fma_f32 v174, v174, s56, -v233
    v_fma_f32 v175, v175, s56, -v233
    v_mfma_f32_16x16x32_bf16 v[44:47], v[208:211], v[160:163], v[44:47]
    v_exp_f32 v172, v172
    v_exp_f32 v173, v173
    ds_read_b64_tr_b16 v[200:201], v241 offset:24576
    ds_read_b64_tr_b16 v[202:203], v241 offset:28672
    s_waitcnt lgkmcnt(10)
    v_mfma_f32_16x16x32_bf16 v[16:19], v[212:215], v[144:147], v[16:19]
    v_exp_f32 v174, v174
    v_exp_f32 v175, v175
    v_mfma_f32_16x16x32_bf16 v[48:51], v[212:215], v[160:163], v[48:51]
    v_cvt_pk_bf16_f32 v170, v172, v173
    v_cvt_pk_bf16_f32 v171, v174, v175
    ds_read_b64_tr_b16 v[204:205], v242 offset:24576
    ds_read_b64_tr_b16 v[206:207], v242 offset:28672
    v_mfma_f32_16x16x32_bf16 v[20:23], v[216:219], v[144:147], v[20:23]
    v_fma_f32 v176, v176, s56, -v234
    v_fma_f32 v177, v177, s56, -v234
    v_mfma_f32_16x16x32_bf16 v[52:55], v[216:219], v[160:163], v[52:55]
    v_fma_f32 v178, v178, s56, -v234
    v_fma_f32 v179, v179, s56, -v234
    ds_read_b64_tr_b16 v[208:209], v243 offset:24576
    ds_read_b64_tr_b16 v[210:211], v243 offset:28672
    s_waitcnt lgkmcnt(10)
    v_mfma_f32_16x16x32_bf16 v[24:27], v[220:223], v[144:147], v[24:27]
    v_exp_f32 v176, v176
    v_exp_f32 v177, v177
    v_mfma_f32_16x16x32_bf16 v[56:59], v[220:223], v[160:163], v[56:59]
    v_exp_f32 v178, v178
    v_exp_f32 v179, v179
    ds_read_b64_tr_b16 v[212:213], v244 offset:24576
    ds_read_b64_tr_b16 v[214:215], v244 offset:28672
    v_mfma_f32_16x16x32_bf16 v[28:31], v[224:227], v[144:147], v[28:31]
    v_cvt_pk_bf16_f32 v176, v176, v177
    v_cvt_pk_bf16_f32 v177, v178, v179
    v_mfma_f32_16x16x32_bf16 v[60:63], v[224:227], v[160:163], v[60:63]
    ds_read_b64_tr_b16 v[216:217], v245 offset:24576
    ds_read_b64_tr_b16 v[218:219], v245 offset:28672
    v_mfma_f32_16x16x32_bf16 v[180:183], v[192:195], v[152:155], v[180:183]
    v_mfma_f32_16x16x32_bf16 v[184:187], v[192:195], v[168:171], v[184:187]
    v_mfma_f32_16x16x16_bf16 v[188:191], v[192:193], v[176:177], v[188:191]
    s_waitcnt lgkmcnt(10)
    v_mfma_f32_16x16x32_bf16 v[0:3], v[228:231], v[152:155], v[0:3]
    v_mfma_f32_16x16x32_bf16 v[32:35], v[228:231], v[168:171], v[32:35]
    ds_read_b64_tr_b16 v[220:221], v246 offset:24576
    ds_read_b64_tr_b16 v[222:223], v246 offset:28672
    v_mfma_f32_16x16x32_bf16 v[4:7], v[196:199], v[152:155], v[4:7]
    v_mfma_f32_16x16x32_bf16 v[36:39], v[196:199], v[168:171], v[36:39]
    v_add_u32 v224, s70, v239
    ds_read_b64_tr_b16 v[224:225], v224 offset:16384
    v_add_u32 v226, s70, v240
    ds_read_b64_tr_b16 v[226:227], v226 offset:16384
    s_waitcnt lgkmcnt(10)
    v_mfma_f32_16x16x32_bf16 v[8:11], v[200:203], v[152:155], v[8:11]
    v_mfma_f32_16x16x32_bf16 v[40:43], v[200:203], v[168:171], v[40:43]
    v_add_u32 v228, s70, v241
    ds_read_b64_tr_b16 v[228:229], v228 offset:16384
    v_add_u32 v230, s70, v242
    ds_read_b64_tr_b16 v[230:231], v230 offset:16384
    v_mfma_f32_16x16x32_bf16 v[12:15], v[204:207], v[152:155], v[12:15]
    v_mfma_f32_16x16x32_bf16 v[44:47], v[204:207], v[168:171], v[44:47]
    v_add_u32 v196, s70, v243
    ds_read_b64_tr_b16 v[196:197], v196 offset:16384
    v_add_u32 v198, s70, v244
    ds_read_b64_tr_b16 v[198:199], v198 offset:16384
    s_waitcnt lgkmcnt(10)
    v_mfma_f32_16x16x32_bf16 v[16:19], v[208:211], v[152:155], v[16:19]
    v_mfma_f32_16x16x32_bf16 v[48:51], v[208:211], v[168:171], v[48:51]
    v_add_u32 v200, s70, v245
    ds_read_b64_tr_b16 v[200:201], v200 offset:16384
    v_add_u32 v202, s70, v246
    ds_read_b64_tr_b16 v[202:203], v202 offset:16384
    v_mfma_f32_16x16x32_bf16 v[20:23], v[212:215], v[152:155], v[20:23]
    v_mfma_f32_16x16x32_bf16 v[52:55], v[212:215], v[168:171], v[52:55]
    s_waitcnt lgkmcnt(8)
    v_mfma_f32_16x16x32_bf16 v[24:27], v[216:219], v[152:155], v[24:27]
    v_mfma_f32_16x16x32_bf16 v[56:59], v[216:219], v[168:171], v[56:59]
    v_mfma_f32_16x16x32_bf16 v[28:31], v[220:223], v[152:155], v[28:31]
    v_mfma_f32_16x16x32_bf16 v[60:63], v[220:223], v[168:171], v[60:63]
    s_waitcnt lgkmcnt(4)
    v_mfma_f32_16x16x16_bf16 v[64:67], v[224:225], v[176:177], v[64:67]
    v_mfma_f32_16x16x16_bf16 v[68:71], v[226:227], v[176:177], v[68:71]
    v_mfma_f32_16x16x16_bf16 v[72:75], v[228:229], v[176:177], v[72:75]
    v_mfma_f32_16x16x16_bf16 v[76:79], v[230:231], v[176:177], v[76:79]
    s_waitcnt lgkmcnt(0)
    v_mfma_f32_16x16x16_bf16 v[80:83], v[196:197], v[176:177], v[80:83]
    v_mfma_f32_16x16x16_bf16 v[84:87], v[198:199], v[176:177], v[84:87]
    v_mfma_f32_16x16x16_bf16 v[88:91], v[200:201], v[176:177], v[88:91]
    v_mfma_f32_16x16x16_bf16 v[92:95], v[202:203], v[176:177], v[92:95]
    s_waitcnt vmcnt(12)
    s_barrier
    s_add_u32 m0, s57, 65536
    s_add_u32 s59, s69, 5
    s_and_b32 s59, s59, 7
    s_lshl_b32 s59, s59, 14
    buffer_load_dwordx4 v248, s[40:43], s59 offen nt lds
    s_add_u32 m0, s57, 69632
    s_add_u32 s59, s59, 4096
    buffer_load_dwordx4 v248, s[40:43], s59 offen nt lds
    s_add_u32 m0, s57, 73728
    s_add_u32 s59, s59, 4096
    buffer_load_dwordx4 v248, s[40:43], s59 offen nt lds
    s_add_u32 m0, s57, 77824
    s_add_u32 s59, s59, 4096
    buffer_load_dwordx4 v248, s[40:43], s59 offen nt lds
L1_redo4:
    ds_read_b128 v[196:199], v235 offset:0
    ds_read_b128 v[200:203], v236 offset:0
    ds_read_b128 v[204:207], v237 offset:0
    ds_read_b128 v[208:211], v238 offset:0
    ds_read_b128 v[212:215], v235 offset:4096
    ds_read_b128 v[216:219], v236 offset:4096
    ds_read_b128 v[220:223], v237 offset:4096
    ds_read_b128 v[224:227], v238 offset:4096
    s_setprio 2
    s_waitcnt lgkmcnt(4)
    v_mfma_f32_16x16x32_bf16 v[144:147], v[196:199], v[96:99], 0
    v_mfma_f32_16x16x32_bf16 v[160:163], v[196:199], v[112:115], 0
    v_mfma_f32_16x16x32_bf16 v[144:147], v[200:203], v[100:103], v[144:147]
    v_mfma_f32_16x16x32_bf16 v[160:163], v[200:203], v[116:119], v[160:163]
    v_mfma_f32_16x16x32_bf16 v[144:147], v[204:207], v[104:107], v[144:147]
    v_mfma_f32_16x16x32_bf16 v[160:163], v[204:207], v[120:123], v[160:163]
    v_mfma_f32_16x16x32_bf16 v[144:147], v[208:211], v[108:111], v[144:147]
    v_mfma_f32_16x16x32_bf16 v[160:163], v[208:211], v[124:127], v[160:163]
    ds_read_b128 v[196:199], v235 offset:8192
    ds_read_b128 v[200:203], v236 offset:8192
    ds_read_b128 v[204:207], v237 offset:8192
    ds_read_b128 v[208:211], v238 offset:8192
    s_waitcnt lgkmcnt(4)
    v_mfma_f32_16x16x32_bf16 v[148:151], v[212:215], v[96:99], 0
    v_mfma_f32_16x16x32_bf16 v[164:167], v[212:215], v[112:115], 0
    v_mfma_f32_16x16x32_bf16 v[148:151], v[216:219], v[100:103], v[148:151]
    v_max3_f32 v252, v144, v145, v146
    v_max3_f32 v253, v160, v161, v162
    v_max_f32 v252, v252, v147
    v_max_f32 v253, v253, v163
    v_mfma_f32_16x16x32_bf16 v[164:167], v[216:219], v[116:119], v[164:167]
    v_fma_f32 v144, v144, s56, -v232
    v_fma_f32 v145, v145, s56, -v232
    v_fma_f32 v146, v146, s56, -v232
    v_fma_f32 v147, v147, s56, -v232
    v_mfma_f32_16x16x32_bf16 v[148:151], v[220:223], v[104:107], v[148:151]
    v_exp_f32 v144, v144
    v_exp_f32 v145, v145
    v_exp_f32 v146, v146
    v_exp_f32 v147, v147
    v_mfma_f32_16x16x32_bf16 v[164:167], v[220:223], v[120:123], v[164:167]
    v_cvt_pk_bf16_f32 v144, v144, v145
    v_cvt_pk_bf16_f32 v145, v146, v147
    v_fma_f32 v160, v160, s56, -v233
    v_fma_f32 v161, v161, s56, -v233
    v_mfma_f32_16x16x32_bf16 v[148:151], v[224:227], v[108:111], v[148:151]
    v_fma_f32 v162, v162, s56, -v233
    v_fma_f32 v163, v163, s56, -v233
    v_exp_f32 v160, v160
    v_exp_f32 v161, v161
    v_mfma_f32_16x16x32_bf16 v[164:167], v[224:227], v[124:127], v[164:167]
    v_exp_f32 v162, v162
    v_exp_f32 v163, v163
    v_cvt_pk_bf16_f32 v160, v160, v161
    v_cvt_pk_bf16_f32 v161, v162, v163
    ds_read_b128 v[212:215], v235 offset:12288
    ds_read_b128 v[216:219], v236 offset:12288
    ds_read_b128 v[220:223], v237 offset:12288
    ds_read_b128 v[224:227], v238 offset:12288
    s_waitcnt lgkmcnt(4)
    v_mfma_f32_16x16x32_bf16 v[152:155], v[196:199], v[96:99], 0
    v_mfma_f32_16x16x32_bf16 v[168:171], v[196:199], v[112:115], 0
    v_mfma_f32_16x16x32_bf16 v[152:155], v[200:203], v[100:103], v[152:155]
    v_max3_f32 v252, v252, v148, v149
    v_max3_f32 v253, v253, v164, v165
    v_max3_f32 v252, v252, v150, v151
    v_max3_f32 v253, v253, v166, v167
    v_mfma_f32_16x16x32_bf16 v[168:171], v[200:203], v[116:119], v[168:171]
    v_fma_f32 v148, v148, s56, -v232
    v_fma_f32 v149, v149, s56, -v232
    v_fma_f32 v150, v150, s56, -v232
    v_fma_f32 v151, v151, s56, -v232
    v_mfma_f32_16x16x32_bf16 v[152:155], v[204:207], v[104:107], v[152:155]
    v_exp_f32 v148, v148
    v_exp_f32 v149, v149
    v_exp_f32 v150, v150
    v_exp_f32 v151, v151
    v_mfma_f32_16x16x32_bf16 v[168:171], v[204:207], v[120:123], v[168:171]
    v_cvt_pk_bf16_f32 v146, v148, v149
    v_cvt_pk_bf16_f32 v147, v150, v151
    v_fma_f32 v164, v164, s56, -v233
    v_fma_f32 v165, v165, s56, -v233
    v_mfma_f32_16x16x32_bf16 v[152:155], v[208:211], v[108:111], v[152:155]
    v_fma_f32 v166, v166, s56, -v233
    v_fma_f32 v167, v167, s56, -v233
    v_exp_f32 v164, v164
    v_exp_f32 v165, v165
    v_mfma_f32_16x16x32_bf16 v[168:171], v[208:211], v[124:127], v[168:171]
    v_exp_f32 v166, v166
    v_exp_f32 v167, v167
    v_cvt_pk_bf16_f32 v162, v164, v165
    v_cvt_pk_bf16_f32 v163, v166, v167
    v_add_u32 v196, s70, v235
    ds_read_b128 v[196:199], v196 offset:0
    v_add_u32 v200, s70, v236
    ds_read_b128 v[200:203], v200 offset:0
    v_add_u32 v204, s70, v237
    ds_read_b128 v[204:207], v204 offset:0
    v_add_u32 v208, s70, v238
    ds_read_b128 v[208:211], v208 offset:0
    s_waitcnt lgkmcnt(4)
    v_mfma_f32_16x16x32_bf16 v[156:159], v[212:215], v[96:99], 0
    v_mfma_f32_16x16x32_bf16 v[172:175], v[212:215], v[112:115], 0
    v_mfma_f32_16x16x32_bf16 v[156:159], v[216:219], v[100:103], v[156:159]
    v_max3_f32 v252, v252, v152, v153
    v_max3_f32 v253, v253, v168, v169
    v_max3_f32 v252, v252, v154, v155
    v_max3_f32 v253, v253, v170, v171
    v_mfma_f32_16x16x32_bf16 v[172:175], v[216:219], v[116:119], v[172:175]
    v_fma_f32 v152, v152, s56, -v232
    v_fma_f32 v153, v153, s56, -v232
    v_fma_f32 v154, v154, s56, -v232
    v_fma_f32 v155, v155, s56, -v232
    v_mfma_f32_16x16x32_bf16 v[156:159], v[220:223], v[104:107], v[156:159]
    v_exp_f32 v152, v152
    v_exp_f32 v153, v153
    v_exp_f32 v154, v154
    v_exp_f32 v155, v155
    v_mfma_f32_16x16x32_bf16 v[172:175], v[220:223], v[120:123], v[172:175]
    v_cvt_pk_bf16_f32 v152, v152, v153
    v_cvt_pk_bf16_f32 v153, v154, v155
    v_fma_f32 v168, v168, s56, -v233
    v_fma_f32 v169, v169, s56, -v233
    v_mfma_f32_16x16x32_bf16 v[156:159], v[224:227], v[108:111], v[156:159]
    v_fma_f32 v170, v170, s56, -v233
    v_fma_f32 v171, v171, s56, -v233
    v_exp_f32 v168, v168
    v_exp_f32 v169, v169
    v_mfma_f32_16x16x32_bf16 v[172:175], v[224:227], v[124:127], v[172:175]
    v_exp_f32 v170, v170
    v_exp_f32 v171, v171
    v_cvt_pk_bf16_f32 v168, v168, v169
    v_cvt_pk_bf16_f32 v169, v170, v171
    s_waitcnt lgkmcnt(0)
    v_mfma_f32_16x16x32_bf16 v[176:179], v[196:199], v[128:131], 0
    v_mfma_f32_16x16x32_bf16 v[176:179], v[200:203], v[132:135], v[176:179]
    v_mfma_f32_16x16x32_bf16 v[176:179], v[204:207], v[136:139], v[176:179]
    v_mfma_f32_16x16x32_bf16 v[176:179], v[208:211], v[140:143], v[176:179]
    s_setprio 0
    v_max3_f32 v252, v252, v156, v157
    v_max3_f32 v253, v253, v172, v173
    v_max3_f32 v252, v252, v158, v159
    v_max3_f32 v253, v253, v174, v175
    s_nop 2
    v_max3_f32 v254, v176, v177, v178
    v_max_f32 v254, v254, v179
    v_fma_f32 v249, v252, s56, -v232
    v_fma_f32 v250, v253, s56, -v233
    v_fma_f32 v251, v254, s56, -v234
    v_max3_f32 v249, v249, v250, v251
    v_cmp_lt_f32 s[72:73], s71, v249
    s_nop 1
    s_cmp_lg_u64 s[72:73], 0
    s_cbranch_scc0 L1_nr4
    v_mov_b32 v249, v252
    v_mov_b32 v250, v253
    v_mov_b32 v251, v254
    v_permlane32_swap_b32 v252, v249
    v_permlane32_swap_b32 v253, v250
    v_permlane32_swap_b32 v254, v251
    v_max_f32 v252, v252, v249
    v_max_f32 v253, v253, v250
    v_max_f32 v254, v254, v251
    v_mov_b32 v249, v252
    v_mov_b32 v250, v253
    v_mov_b32 v251, v254
    v_permlane16_swap_b32 v252, v249
    v_permlane16_swap_b32 v253, v250
    v_permlane16_swap_b32 v254, v251
    v_max_f32 v252, v252, v249
    v_max_f32 v253, v253, v250
    v_max_f32 v254, v254, v251
    v_mul_f32 v252, s56, v252
    v_max_f32 v252, v252, v232
    v_sub_f32 v249, v232, v252
    v_exp_f32 v249, v249
    v_mov_b32 v232, v252
    v_mul_f32 v0, v0, v249
    v_mul_f32 v1, v1, v249
    v_mul_f32 v2, v2, v249
    v_mul_f32 v3, v3, v249
    v_mul_f32 v4, v4, v249
    v_mul_f32 v5, v5, v249
    v_mul_f32 v6, v6, v249
    v_mul_f32 v7, v7, v249
    v_mul_f32 v8, v8, v249
    v_mul_f32 v9, v9, v249
    v_mul_f32 v10, v10, v249
    v_mul_f32 v11, v11, v249
    v_mul_f32 v12, v12, v249
    v_mul_f32 v13, v13, v249
    v_mul_f32 v14, v14, v249
    v_mul_f32 v15, v15, v249
    v_mul_f32 v16, v16, v249
    v_mul_f32 v17, v17, v249
    v_mul_f32 v18, v18, v249
    v_mul_f32 v19, v19, v249
    v_mul_f32 v20, v20, v249
    v_mul_f32 v21, v21, v249
    v_mul_f32 v22, v22, v249
    v_mul_f32 v23, v23, v249
    v_mul_f32 v24, v24, v249
    v_mul_f32 v25, v25, v249
    v_mul_f32 v26, v26, v249
    v_mul_f32 v27, v27, v249
    v_mul_f32 v28, v28, v249
    v_mul_f32 v29, v29, v249
    v_mul_f32 v30, v30, v249
    v_mul_f32 v31, v31, v249
    v_mul_f32 v180, v180, v249
    v_mul_f32 v181, v181, v249
    v_mul_f32 v182, v182, v249
    v_mul_f32 v183, v183, v249
    v_mul_f32 v253, s56, v253
    v_max_f32 v253, v253, v233
    v_sub_f32 v249, v233, v253
    v_exp_f32 v249, v249
    v_mov_b32 v233, v253
    v_mul_f32 v32, v32, v249
    v_mul_f32 v33, v33, v249
    v_mul_f32 v34, v34, v249
    v_mul_f32 v35, v35, v249
    v_mul_f32 v36, v36, v249
    v_mul_f32 v37, v37, v249
    v_mul_f32 v38, v38, v249
    v_mul_f32 v39, v39, v249
    v_mul_f32 v40, v40, v249
    v_mul_f32 v41, v41, v249
    v_mul_f32 v42, v42, v249
    v_mul_f32 v43, v43, v249
    v_mul_f32 v44, v44, v249
    v_mul_f32 v45, v45, v249
    v_mul_f32 v46, v46, v249
    v_mul_f32 v47, v47, v249
    v_mul_f32 v48, v48, v249
    v_mul_f32 v49, v49, v249
    v_mul_f32 v50, v50, v249
    v_mul_f32 v51, v51, v249
    v_mul_f32 v52, v52, v249
    v_mul_f32 v53, v53, v249
    v_mul_f32 v54, v54, v249
    v_mul_f32 v55, v55, v249
    v_mul_f32 v56, v56, v249
    v_mul_f32 v57, v57, v249
    v_mul_f32 v58, v58, v249
    v_mul_f32 v59, v59, v249
    v_mul_f32 v60, v60, v249
    v_mul_f32 v61, v61, v249
    v_mul_f32 v62, v62, v249
    v_mul_f32 v63, v63, v249
    v_mul_f32 v184, v184, v249
    v_mul_f32 v185, v185, v249
    v_mul_f32 v186, v186, v249
    v_mul_f32 v187, v187, v249
    v_mul_f32 v254, s56, v254
    v_max_f32 v254, v254, v234
    v_sub_f32 v249, v234, v254
    v_exp_f32 v249, v249
    v_mov_b32 v234, v254
    v_mul_f32 v64, v64, v249
    v_mul_f32 v65, v65, v249
    v_mul_f32 v66, v66, v249
    v_mul_f32 v67, v67, v249
    v_mul_f32 v68, v68, v249
    v_mul_f32 v69, v69, v249
    v_mul_f32 v70, v70, v249
    v_mul_f32 v71, v71, v249
    v_mul_f32 v72, v72, v249
    v_mul_f32 v73, v73, v249
    v_mul_f32 v74, v74, v249
    v_mul_f32 v75, v75, v249
    v_mul_f32 v76, v76, v249
    v_mul_f32 v77, v77, v249
    v_mul_f32 v78, v78, v249
    v_mul_f32 v79, v79, v249
    v_mul_f32 v80, v80, v249
    v_mul_f32 v81, v81, v249
    v_mul_f32 v82, v82, v249
    v_mul_f32 v83, v83, v249
    v_mul_f32 v84, v84, v249
    v_mul_f32 v85, v85, v249
    v_mul_f32 v86, v86, v249
    v_mul_f32 v87, v87, v249
    v_mul_f32 v88, v88, v249
    v_mul_f32 v89, v89, v249
    v_mul_f32 v90, v90, v249
    v_mul_f32 v91, v91, v249
    v_mul_f32 v92, v92, v249
    v_mul_f32 v93, v93, v249
    v_mul_f32 v94, v94, v249
    v_mul_f32 v95, v95, v249
    v_mul_f32 v188, v188, v249
    v_mul_f32 v189, v189, v249
    v_mul_f32 v190, v190, v249
    v_mul_f32 v191, v191, v249
    s_nop 1
    s_branch L1_redo4
L1_nr4:
    s_waitcnt vmcnt(8)
    s_barrier
    ds_read_b64_tr_b16 v[196:197], v239 offset:0
    ds_read_b64_tr_b16 v[198:199], v239 offset:4096
    ds_read_b64_tr_b16 v[200:201], v240 offset:0
    ds_read_b64_tr_b16 v[202:203], v240 offset:4096
    ds_read_b64_tr_b16 v[204:205], v241 offset:0
    ds_read_b64_tr_b16 v[206:207], v241 offset:4096
    ds_read_b64_tr_b16 v[208:209], v242 offset:0
    ds_read_b64_tr_b16 v[210:211], v242 offset:4096
    ds_read_b64_tr_b16 v[212:213], v243 offset:0
    ds_read_b64_tr_b16 v[214:215], v243 offset:4096
    ds_read_b64_tr_b16 v[216:217], v244 offset:0
    ds_read_b64_tr_b16 v[218:219], v244 offset:4096
    ds_read_b64_tr_b16 v[220:221], v245 offset:0
    ds_read_b64_tr_b16 v[222:223], v245 offset:4096
    s_add_u32 m0, s57, 0
    s_add_u32 s59, s69, 7
    s_and_b32 s59, s59, 7
    s_lshl_b32 s59, s59, 14
    buffer_load_dwordx4 v247, s[36:39], s59 offen nt lds
    s_add_u32 m0, s57, 4096
    s_add_u32 s59, s59, 4096
    buffer_load_dwordx4 v247, s[36:39], s59 offen nt lds
    s_add_u32 m0, s57, 8192
    s_add_u32 s59, s59, 4096
    buffer_load_dwordx4 v247, s[36:39], s59 offen nt lds
    s_add_u32 m0, s57, 12288
    s_add_u32 s59, s59, 4096
    buffer_load_dwordx4 v247, s[36:39], s59 offen nt lds
    s_setprio 2
    v_mfma_f32_16x16x32_bf16 v[180:183], v[192:195], v[144:147], v[180:183]
    v_mfma_f32_16x16x32_bf16 v[184:187], v[192:195], v[160:163], v[184:187]
    s_waitcnt lgkmcnt(10)
    v_mfma_f32_16x16x32_bf16 v[0:3], v[196:199], v[144:147], v[0:3]
    v_fma_f32 v156, v156, s56, -v232
    v_fma_f32 v157, v157, s56, -v232
    v_mfma_f32_16x16x32_bf16 v[32:35], v[196:199], v[160:163], v[32:35]
    v_fma_f32 v158, v158, s56, -v232
    v_fma_f32 v159, v159, s56, -v232
    ds_read_b64_tr_b16 v[224:225], v246 offset:0
    ds_read_b64_tr_b16 v[226:227], v246 offset:4096
    v_mfma_f32_16x16x32_bf16 v[4:7], v[200:203], v[144:147], v[4:7]
    v_exp_f32 v156, v156
    v_exp_f32 v157, v157
    v_mfma_f32_16x16x32_bf16 v[36:39], v[200:203], v[160:163], v[36:39]
    v_exp_f32 v158, v158
    v_exp_f32 v159, v159
    ds_read_b64_tr_b16 v[228:229], v239 offset:8192
    ds_read_b64_tr_b16 v[230:231], v239 offset:12288
    s_waitcnt lgkmcnt(10)
    v_mfma_f32_16x16x32_bf16 v[8:11], v[204:207], v[144:147], v[8:11]
    v_cvt_pk_bf16_f32 v154, v156, v157
    v_cvt_pk_bf16_f32 v155, v158, v159
    v_mfma_f32_16x16x32_bf16 v[40:43], v[204:207], v[160:163], v[40:43]
    v_fma_f32 v172, v172, s56, -v233
    v_fma_f32 v173, v173, s56, -v233
    ds_read_b64_tr_b16 v[196:197], v240 offset:8192
    ds_read_b64_tr_b16 v[198:199], v240 offset:12288
    v_mfma_f32_16x16x32_bf16 v[12:15], v[208:211], v[144:147], v[12:15]
    v_fma_f32 v174, v174, s56, -v233
    v_fma_f32 v175, v175, s56, -v233
    v_mfma_f32_16x16x32_bf16 v[44:47], v[208:211], v[160:163], v[44:47]
    v_exp_f32 v172, v172
    v_exp_f32 v173, v173
    ds_read_b64_tr_b16 v[200:201], v241 offset:8192
    ds_read_b64_tr_b16 v[202:203], v241 offset:12288
    s_waitcnt lgkmcnt(10)
    v_mfma_f32_16x16x32_bf16 v[16:19], v[212:215], v[144:147], v[16:19]
    v_exp_f32 v174, v174
    v_exp_f32 v175, v175
    v_mfma_f32_16x16x32_bf16 v[48:51], v[212:215], v[160:163], v[48:51]
    v_cvt_pk_bf16_f32 v170, v172, v173
    v_cvt_pk_bf16_f32 v171, v174, v175
    ds_read_b64_tr_b16 v[204:205], v242 offset:8192
    ds_read_b64_tr_b16 v[206:207], v242 offset:12288
    v_mfma_f32_16x16x32_bf16 v[20:23], v[216:219], v[144:147], v[20:23]
    v_fma_f32 v176, v176, s56, -v234
    v_fma_f32 v177, v177, s56, -v234
    v_mfma_f32_16x16x32_bf16 v[52:55], v[216:219], v[160:163], v[52:55]
    v_fma_f32 v178, v178, s56, -v234
    v_fma_f32 v179, v179, s56, -v234
    ds_read_b64_tr_b16 v[208:209], v243 offset:8192
    ds_read_b64_tr_b16 v[210:211], v243 offset:12288
    s_waitcnt lgkmcnt(10)
    v_mfma_f32_16x16x32_bf16 v[24:27], v[220:223], v[144:147], v[24:27]
    v_exp_f32 v176, v176
    v_exp_f32 v177, v177
    v_mfma_f32_16x16x32_bf16 v[56:59], v[220:223], v[160:163], v[56:59]
    v_exp_f32 v178, v178
    v_exp_f32 v179, v179
    ds_read_b64_tr_b16 v[212:213], v244 offset:8192
    ds_read_b64_tr_b16 v[214:215], v244 offset:12288
    v_mfma_f32_16x16x32_bf16 v[28:31], v[224:227], v[144:147], v[28:31]
    v_cvt_pk_bf16_f32 v176, v176, v177
    v_cvt_pk_bf16_f32 v177, v178, v179
    v_mfma_f32_16x16x32_bf16 v[60:63], v[224:227], v[160:163], v[60:63]
    ds_read_b64_tr_b16 v[216:217], v245 offset:8192
    ds_read_b64_tr_b16 v[218:219], v245 offset:12288
    v_mfma_f32_16x16x32_bf16 v[180:183], v[192:195], v[152:155], v[180:183]
    v_mfma_f32_16x16x32_bf16 v[184:187], v[192:195], v[168:171], v[184:187]
    v_mfma_f32_16x16x16_bf16 v[188:191], v[192:193], v[176:177], v[188:191]
    s_waitcnt lgkmcnt(10)
    v_mfma_f32_16x16x32_bf16 v[0:3], v[228:231], v[152:155], v[0:3]
    v_mfma_f32_16x16x32_bf16 v[32:35], v[228:231], v[168:171], v[32:35]
    ds_read_b64_tr_b16 v[220:221], v246 offset:8192
    ds_read_b64_tr_b16 v[222:223], v246 offset:12288
    v_mfma_f32_16x16x32_bf16 v[4:7], v[196:199], v[152:155], v[4:7]
    v_mfma_f32_16x16x32_bf16 v[36:39], v[196:199], v[168:171], v[36:39]
    v_add_u32 v224, s70, v239
    ds_read_b64_tr_b16 v[224:225], v224 offset:0
    v_add_u32 v226, s70, v240
    ds_read_b64_tr_b16 v[226:227], v226 offset:0
    s_waitcnt lgkmcnt(10)
    v_mfma_f32_16x16x32_bf16 v[8:11], v[200:203], v[152:155], v[8:11]
    v_mfma_f32_16x16x32_bf16 v[40:43], v[200:203], v[168:171], v[40:43]
    v_add_u32 v228, s70, v241
    ds_read_b64_tr_b16 v[228:229], v228 offset:0
    v_add_u32 v230, s70, v242
    ds_read_b64_tr_b16 v[230:231], v230 offset:0
    v_mfma_f32_16x16x32_bf16 v[12:15], v[204:207], v[152:155], v[12:15]
    v_mfma_f32_16x16x32_bf16 v[44:47], v[204:207], v[168:171], v[44:47]
    v_add_u32 v196, s70, v243
    ds_read_b64_tr_b16 v[196:197], v196 offset:0
    v_add_u32 v198, s70, v244
    ds_read_b64_tr_b16 v[198:199], v198 offset:0
    s_waitcnt lgkmcnt(10)
    v_mfma_f32_16x16x32_bf16 v[16:19], v[208:211], v[152:155], v[16:19]
    v_mfma_f32_16x16x32_bf16 v[48:51], v[208:211], v[168:171], v[48:51]
    v_add_u32 v200, s70, v245
    ds_read_b64_tr_b16 v[200:201], v200 offset:0
    v_add_u32 v202, s70, v246
    ds_read_b64_tr_b16 v[202:203], v202 offset:0
    v_mfma_f32_16x16x32_bf16 v[20:23], v[212:215], v[152:155], v[20:23]
    v_mfma_f32_16x16x32_bf16 v[52:55], v[212:215], v[168:171], v[52:55]
    s_waitcnt lgkmcnt(8)
    v_mfma_f32_16x16x32_bf16 v[24:27], v[216:219], v[152:155], v[24:27]
    v_mfma_f32_16x16x32_bf16 v[56:59], v[216:219], v[168:171], v[56:59]
    v_mfma_f32_16x16x32_bf16 v[28:31], v[220:223], v[152:155], v[28:31]
    v_mfma_f32_16x16x32_bf16 v[60:63], v[220:223], v[168:171], v[60:63]
    s_waitcnt lgkmcnt(4)
    v_mfma_f32_16x16x16_bf16 v[64:67], v[224:225], v[176:177], v[64:67]
    v_mfma_f32_16x16x16_bf16 v[68:71], v[226:227], v[176:177], v[68:71]
    v_mfma_f32_16x16x16_bf16 v[72:75], v[228:229], v[176:177], v[72:75]
    v_mfma_f32_16x16x16_bf16 v[76:79], v[230:231], v[176:177], v[76:79]
    s_waitcnt lgkmcnt(0)
    v_mfma_f32_16x16x16_bf16 v[80:83], v[196:197], v[176:177], v[80:83]
    v_mfma_f32_16x16x16_bf16 v[84:87], v[198:199], v[176:177], v[84:87]
    v_mfma_f32_16x16x16_bf16 v[88:91], v[200:201], v[176:177], v[88:91]
    v_mfma_f32_16x16x16_bf16 v[92:95], v[202:203], v[176:177], v[92:95]
    s_waitcnt vmcnt(12)
    s_barrier
    s_add_u32 m0, s57, 49152
    s_add_u32 s59, s69, 6
    s_and_b32 s59, s59, 7
    s_lshl_b32 s59, s59, 14
    buffer_load_dwordx4 v248, s[40:43], s59 offen nt lds
    s_add_u32 m0, s57, 53248
    s_add_u32 s59, s59, 4096
    buffer_load_dwordx4 v248, s[40:43], s59 offen nt lds
    s_add_u32 m0, s57, 57344
    s_add_u32 s59, s59, 4096
    buffer_load_dwordx4 v248, s[40:43], s59 offen nt lds
    s_add_u32 m0, s57, 61440
    s_add_u32 s59, s59, 4096
    buffer_load_dwordx4 v248, s[40:43], s59 offen nt lds
L1_redo5:
    ds_read_b128 v[196:199], v235 offset:16384
    ds_read_b128 v[200:203], v236 offset:16384
    ds_read_b128 v[204:207], v237 offset:16384
    ds_read_b128 v[208:211], v238 offset:16384
    ds_read_b128 v[212:215], v235 offset:20480
    ds_read_b128 v[216:219], v236 offset:20480
    ds_read_b128 v[220:223], v237 offset:20480
    ds_read_b128 v[224:227], v238 offset:20480
    s_setprio 2
    s_waitcnt lgkmcnt(4)
    v_mfma_f32_16x16x32_bf16 v[144:147], v[196:199], v[96:99], 0
    v_mfma_f32_16x16x32_bf16 v[160:163], v[196:199], v[112:115], 0
    v_mfma_f32_16x16x32_bf16 v[144:147], v[200:203], v[100:103], v[144:147]
    v_mfma_f32_16x16x32_bf16 v[160:163], v[200:203], v[116:119], v[160:163]
    v_mfma_f32_16x16x32_bf16 v[144:147], v[204:207], v[104:107], v[144:147]
    v_mfma_f32_16x16x32_bf16 v[160:163], v[204:207], v[120:123], v[160:163]
    v_mfma_f32_16x16x32_bf16 v[144:147], v[208:211], v[108:111], v[144:147]
    v_mfma_f32_16x16x32_bf16 v[160:163], v[208:211], v[124:127], v[160:163]
    ds_read_b128 v[196:199], v235 offset:24576
    ds_read_b128 v[200:203], v236 offset:24576
    ds_read_b128 v[204:207], v237 offset:24576
    ds_read_b128 v[208:211], v238 offset:24576
    s_waitcnt lgkmcnt(4)
    v_mfma_f32_16x16x32_bf16 v[148:151], v[212:215], v[96:99], 0
    v_mfma_f32_16x16x32_bf16 v[164:167], v[212:215], v[112:115], 0
    v_mfma_f32_16x16x32_bf16 v[148:151], v[216:219], v[100:103], v[148:151]
    v_max3_f32 v252, v144, v145, v146
    v_max3_f32 v253, v160, v161, v162
    v_max_f32 v252, v252, v147
    v_max_f32 v253, v253, v163
    v_mfma_f32_16x16x32_bf16 v[164:167], v[216:219], v[116:119], v[164:167]
    v_fma_f32 v144, v144, s56, -v232
    v_fma_f32 v145, v145, s56, -v232
    v_fma_f32 v146, v146, s56, -v232
    v_fma_f32 v147, v147, s56, -v232
    v_mfma_f32_16x16x32_bf16 v[148:151], v[220:223], v[104:107], v[148:151]
    v_exp_f32 v144, v144
    v_exp_f32 v145, v145
    v_exp_f32 v146, v146
    v_exp_f32 v147, v147
    v_mfma_f32_16x16x32_bf16 v[164:167], v[220:223], v[120:123], v[164:167]
    v_cvt_pk_bf16_f32 v144, v144, v145
    v_cvt_pk_bf16_f32 v145, v146, v147
    v_fma_f32 v160, v160, s56, -v233
    v_fma_f32 v161, v161, s56, -v233
    v_mfma_f32_16x16x32_bf16 v[148:151], v[224:227], v[108:111], v[148:151]
    v_fma_f32 v162, v162, s56, -v233
    v_fma_f32 v163, v163, s56, -v233
    v_exp_f32 v160, v160
    v_exp_f32 v161, v161
    v_mfma_f32_16x16x32_bf16 v[164:167], v[224:227], v[124:127], v[164:167]
    v_exp_f32 v162, v162
    v_exp_f32 v163, v163
    v_cvt_pk_bf16_f32 v160, v160, v161
    v_cvt_pk_bf16_f32 v161, v162, v163
    ds_read_b128 v[212:215], v235 offset:28672
    ds_read_b128 v[216:219], v236 offset:28672
    ds_read_b128 v[220:223], v237 offset:28672
    ds_read_b128 v[224:227], v238 offset:28672
    s_waitcnt lgkmcnt(4)
    v_mfma_f32_16x16x32_bf16 v[152:155], v[196:199], v[96:99], 0
    v_mfma_f32_16x16x32_bf16 v[168:171], v[196:199], v[112:115], 0
    v_mfma_f32_16x16x32_bf16 v[152:155], v[200:203], v[100:103], v[152:155]
    v_max3_f32 v252, v252, v148, v149
    v_max3_f32 v253, v253, v164, v165
    v_max3_f32 v252, v252, v150, v151
    v_max3_f32 v253, v253, v166, v167
    v_mfma_f32_16x16x32_bf16 v[168:171], v[200:203], v[116:119], v[168:171]
    v_fma_f32 v148, v148, s56, -v232
    v_fma_f32 v149, v149, s56, -v232
    v_fma_f32 v150, v150, s56, -v232
    v_fma_f32 v151, v151, s56, -v232
    v_mfma_f32_16x16x32_bf16 v[152:155], v[204:207], v[104:107], v[152:155]
    v_exp_f32 v148, v148
    v_exp_f32 v149, v149
    v_exp_f32 v150, v150
    v_exp_f32 v151, v151
    v_mfma_f32_16x16x32_bf16 v[168:171], v[204:207], v[120:123], v[168:171]
    v_cvt_pk_bf16_f32 v146, v148, v149
    v_cvt_pk_bf16_f32 v147, v150, v151
    v_fma_f32 v164, v164, s56, -v233
    v_fma_f32 v165, v165, s56, -v233
    v_mfma_f32_16x16x32_bf16 v[152:155], v[208:211], v[108:111], v[152:155]
    v_fma_f32 v166, v166, s56, -v233
    v_fma_f32 v167, v167, s56, -v233
    v_exp_f32 v164, v164
    v_exp_f32 v165, v165
    v_mfma_f32_16x16x32_bf16 v[168:171], v[208:211], v[124:127], v[168:171]
    v_exp_f32 v166, v166
    v_exp_f32 v167, v167
    v_cvt_pk_bf16_f32 v162, v164, v165
    v_cvt_pk_bf16_f32 v163, v166, v167
    v_add_u32 v196, s70, v235
    ds_read_b128 v[196:199], v196 offset:16384
    v_add_u32 v200, s70, v236
    ds_read_b128 v[200:203], v200 offset:16384
    v_add_u32 v204, s70, v237
    ds_read_b128 v[204:207], v204 offset:16384
    v_add_u32 v208, s70, v238
    ds_read_b128 v[208:211], v208 offset:16384
    s_waitcnt lgkmcnt(4)
    v_mfma_f32_16x16x32_bf16 v[156:159], v[212:215], v[96:99], 0
    v_mfma_f32_16x16x32_bf16 v[172:175], v[212:215], v[112:115], 0
    v_mfma_f32_16x16x32_bf16 v[156:159], v[216:219], v[100:103], v[156:159]
    v_max3_f32 v252, v252, v152, v153
    v_max3_f32 v253, v253, v168, v169
    v_max3_f32 v252, v252, v154, v155
    v_max3_f32 v253, v253, v170, v171
    v_mfma_f32_16x16x32_bf16 v[172:175], v[216:219], v[116:119], v[172:175]
    v_fma_f32 v152, v152, s56, -v232
    v_fma_f32 v153, v153, s56, -v232
    v_fma_f32 v154, v154, s56, -v232
    v_fma_f32 v155, v155, s56, -v232
    v_mfma_f32_16x16x32_bf16 v[156:159], v[220:223], v[104:107], v[156:159]
    v_exp_f32 v152, v152
    v_exp_f32 v153, v153
    v_exp_f32 v154, v154
    v_exp_f32 v155, v155
    v_mfma_f32_16x16x32_bf16 v[172:175], v[220:223], v[120:123], v[172:175]
    v_cvt_pk_bf16_f32 v152, v152, v153
    v_cvt_pk_bf16_f32 v153, v154, v155
    v_fma_f32 v168, v168, s56, -v233
    v_fma_f32 v169, v169, s56, -v233
    v_mfma_f32_16x16x32_bf16 v[156:159], v[224:227], v[108:111], v[156:159]
    v_fma_f32 v170, v170, s56, -v233
    v_fma_f32 v171, v171, s56, -v233
    v_exp_f32 v168, v168
    v_exp_f32 v169, v169
    v_mfma_f32_16x16x32_bf16 v[172:175], v[224:227], v[124:127], v[172:175]
    v_exp_f32 v170, v170
    v_exp_f32 v171, v171
    v_cvt_pk_bf16_f32 v168, v168, v169
    v_cvt_pk_bf16_f32 v169, v170, v171
    s_waitcnt lgkmcnt(0)
    v_mfma_f32_16x16x32_bf16 v[176:179], v[196:199], v[128:131], 0
    v_mfma_f32_16x16x32_bf16 v[176:179], v[200:203], v[132:135], v[176:179]
    v_mfma_f32_16x16x32_bf16 v[176:179], v[204:207], v[136:139], v[176:179]
    v_mfma_f32_16x16x32_bf16 v[176:179], v[208:211], v[140:143], v[176:179]
    s_setprio 0
    v_max3_f32 v252, v252, v156, v157
    v_max3_f32 v253, v253, v172, v173
    v_max3_f32 v252, v252, v158, v159
    v_max3_f32 v253, v253, v174, v175
    s_nop 2
    v_max3_f32 v254, v176, v177, v178
    v_max_f32 v254, v254, v179
    v_fma_f32 v249, v252, s56, -v232
    v_fma_f32 v250, v253, s56, -v233
    v_fma_f32 v251, v254, s56, -v234
    v_max3_f32 v249, v249, v250, v251
    v_cmp_lt_f32 s[72:73], s71, v249
    s_nop 1
    s_cmp_lg_u64 s[72:73], 0
    s_cbranch_scc0 L1_nr5
    v_mov_b32 v249, v252
    v_mov_b32 v250, v253
    v_mov_b32 v251, v254
    v_permlane32_swap_b32 v252, v249
    v_permlane32_swap_b32 v253, v250
    v_permlane32_swap_b32 v254, v251
    v_max_f32 v252, v252, v249
    v_max_f32 v253, v253, v250
    v_max_f32 v254, v254, v251
    v_mov_b32 v249, v252
    v_mov_b32 v250, v253
    v_mov_b32 v251, v254
    v_permlane16_swap_b32 v252, v249
    v_permlane16_swap_b32 v253, v250
    v_permlane16_swap_b32 v254, v251
    v_max_f32 v252, v252, v249
    v_max_f32 v253, v253, v250
    v_max_f32 v254, v254, v251
    v_mul_f32 v252, s56, v252
    v_max_f32 v252, v252, v232
    v_sub_f32 v249, v232, v252
    v_exp_f32 v249, v249
    v_mov_b32 v232, v252
    v_mul_f32 v0, v0, v249
    v_mul_f32 v1, v1, v249
    v_mul_f32 v2, v2, v249
    v_mul_f32 v3, v3, v249
    v_mul_f32 v4, v4, v249
    v_mul_f32 v5, v5, v249
    v_mul_f32 v6, v6, v249
    v_mul_f32 v7, v7, v249
    v_mul_f32 v8, v8, v249
    v_mul_f32 v9, v9, v249
    v_mul_f32 v10, v10, v249
    v_mul_f32 v11, v11, v249
    v_mul_f32 v12, v12, v249
    v_mul_f32 v13, v13, v249
    v_mul_f32 v14, v14, v249
    v_mul_f32 v15, v15, v249
    v_mul_f32 v16, v16, v249
    v_mul_f32 v17, v17, v249
    v_mul_f32 v18, v18, v249
    v_mul_f32 v19, v19, v249
    v_mul_f32 v20, v20, v249
    v_mul_f32 v21, v21, v249
    v_mul_f32 v22, v22, v249
    v_mul_f32 v23, v23, v249
    v_mul_f32 v24, v24, v249
    v_mul_f32 v25, v25, v249
    v_mul_f32 v26, v26, v249
    v_mul_f32 v27, v27, v249
    v_mul_f32 v28, v28, v249
    v_mul_f32 v29, v29, v249
    v_mul_f32 v30, v30, v249
    v_mul_f32 v31, v31, v249
    v_mul_f32 v180, v180, v249
    v_mul_f32 v181, v181, v249
    v_mul_f32 v182, v182, v249
    v_mul_f32 v183, v183, v249
    v_mul_f32 v253, s56, v253
    v_max_f32 v253, v253, v233
    v_sub_f32 v249, v233, v253
    v_exp_f32 v249, v249
    v_mov_b32 v233, v253
    v_mul_f32 v32, v32, v249
    v_mul_f32 v33, v33, v249
    v_mul_f32 v34, v34, v249
    v_mul_f32 v35, v35, v249
    v_mul_f32 v36, v36, v249
    v_mul_f32 v37, v37, v249
    v_mul_f32 v38, v38, v249
    v_mul_f32 v39, v39, v249
    v_mul_f32 v40, v40, v249
    v_mul_f32 v41, v41, v249
    v_mul_f32 v42, v42, v249
    v_mul_f32 v43, v43, v249
    v_mul_f32 v44, v44, v249
    v_mul_f32 v45, v45, v249
    v_mul_f32 v46, v46, v249
    v_mul_f32 v47, v47, v249
    v_mul_f32 v48, v48, v249
    v_mul_f32 v49, v49, v249
    v_mul_f32 v50, v50, v249
    v_mul_f32 v51, v51, v249
    v_mul_f32 v52, v52, v249
    v_mul_f32 v53, v53, v249
    v_mul_f32 v54, v54, v249
    v_mul_f32 v55, v55, v249
    v_mul_f32 v56, v56, v249
    v_mul_f32 v57, v57, v249
    v_mul_f32 v58, v58, v249
    v_mul_f32 v59, v59, v249
    v_mul_f32 v60, v60, v249
    v_mul_f32 v61, v61, v249
    v_mul_f32 v62, v62, v249
    v_mul_f32 v63, v63, v249
    v_mul_f32 v184, v184, v249
    v_mul_f32 v185, v185, v249
    v_mul_f32 v186, v186, v249
    v_mul_f32 v187, v187, v249
    v_mul_f32 v254, s56, v254
    v_max_f32 v254, v254, v234
    v_sub_f32 v249, v234, v254
    v_exp_f32 v249, v249
    v_mov_b32 v234, v254
    v_mul_f32 v64, v64, v249
    v_mul_f32 v65, v65, v249
    v_mul_f32 v66, v66, v249
    v_mul_f32 v67, v67, v249
    v_mul_f32 v68, v68, v249
    v_mul_f32 v69, v69, v249
    v_mul_f32 v70, v70, v249
    v_mul_f32 v71, v71, v249
    v_mul_f32 v72, v72, v249
    v_mul_f32 v73, v73, v249
    v_mul_f32 v74, v74, v249
    v_mul_f32 v75, v75, v249
    v_mul_f32 v76, v76, v249
    v_mul_f32 v77, v77, v249
    v_mul_f32 v78, v78, v249
    v_mul_f32 v79, v79, v249
    v_mul_f32 v80, v80, v249
    v_mul_f32 v81, v81, v249
    v_mul_f32 v82, v82, v249
    v_mul_f32 v83, v83, v249
    v_mul_f32 v84, v84, v249
    v_mul_f32 v85, v85, v249
    v_mul_f32 v86, v86, v249
    v_mul_f32 v87, v87, v249
    v_mul_f32 v88, v88, v249
    v_mul_f32 v89, v89, v249
    v_mul_f32 v90, v90, v249
    v_mul_f32 v91, v91, v249
    v_mul_f32 v92, v92, v249
    v_mul_f32 v93, v93, v249
    v_mul_f32 v94, v94, v249
    v_mul_f32 v95, v95, v249
    v_mul_f32 v188, v188, v249
    v_mul_f32 v189, v189, v249
    v_mul_f32 v190, v190, v249
    v_mul_f32 v191, v191, v249
    s_nop 1
    s_branch L1_redo5
L1_nr5:
    s_waitcnt vmcnt(8)
    s_barrier
    ds_read_b64_tr_b16 v[196:197], v239 offset:16384
    ds_read_b64_tr_b16 v[198:199], v239 offset:20480
    ds_read_b64_tr_b16 v[200:201], v240 offset:16384
    ds_read_b64_tr_b16 v[202:203], v240 offset:20480
    ds_read_b64_tr_b16 v[204:205], v241 offset:16384
    ds_read_b64_tr_b16 v[206:207], v241 offset:20480
    ds_read_b64_tr_b16 v[208:209], v242 offset:16384
    ds_read_b64_tr_b16 v[210:211], v242 offset:20480
    ds_read_b64_tr_b16 v[212:213], v243 offset:16384
    ds_read_b64_tr_b16 v[214:215], v243 offset:20480
    ds_read_b64_tr_b16 v[216:217], v244 offset:16384
    ds_read_b64_tr_b16 v[218:219], v244 offset:20480
    ds_read_b64_tr_b16 v[220:221], v245 offset:16384
    ds_read_b64_tr_b16 v[222:223], v245 offset:20480
    s_setprio 2
    v_mfma_f32_16x16x32_bf16 v[180:183], v[192:195], v[144:147], v[180:183]
    v_mfma_f32_16x16x32_bf16 v[184:187], v[192:195], v[160:163], v[184:187]
    s_waitcnt lgkmcnt(10)
    v_mfma_f32_16x16x32_bf16 v[0:3], v[196:199], v[144:147], v[0:3]
    v_fma_f32 v156, v156, s56, -v232
    v_fma_f32 v157, v157, s56, -v232
    v_mfma_f32_16x16x32_bf16 v[32:35], v[196:199], v[160:163], v[32:35]
    v_fma_f32 v158, v158, s56, -v232
    v_fma_f32 v159, v159, s56, -v232
    ds_read_b64_tr_b16 v[224:225], v246 offset:16384
    ds_read_b64_tr_b16 v[226:227], v246 offset:20480
    v_mfma_f32_16x16x32_bf16 v[4:7], v[200:203], v[144:147], v[4:7]
    v_exp_f32 v156, v156
    v_exp_f32 v157, v157
    v_mfma_f32_16x16x32_bf16 v[36:39], v[200:203], v[160:163], v[36:39]
    v_exp_f32 v158, v158
    v_exp_f32 v159, v159
    ds_read_b64_tr_b16 v[228:229], v239 offset:24576
    ds_read_b64_tr_b16 v[230:231], v239 offset:28672
    s_waitcnt lgkmcnt(10)
    v_mfma_f32_16x16x32_bf16 v[8:11], v[204:207], v[144:147], v[8:11]
    v_cvt_pk_bf16_f32 v154, v156, v157
    v_cvt_pk_bf16_f32 v155, v158, v159
    v_mfma_f32_16x16x32_bf16 v[40:43], v[204:207], v[160:163], v[40:43]
    v_fma_f32 v172, v172, s56, -v233
    v_fma_f32 v173, v173, s56, -v233
    ds_read_b64_tr_b16 v[196:197], v240 offset:24576
    ds_read_b64_tr_b16 v[198:199], v240 offset:28672
    v_mfma_f32_16x16x32_bf16 v[12:15], v[208:211], v[144:147], v[12:15]
    v_fma_f32 v174, v174, s56, -v233
    v_fma_f32 v175, v175, s56, -v233
    v_mfma_f32_16x16x32_bf16 v[44:47], v[208:211], v[160:163], v[44:47]
    v_exp_f32 v172, v172
    v_exp_f32 v173, v173
    ds_read_b64_tr_b16 v[200:201], v241 offset:24576
    ds_read_b64_tr_b16 v[202:203], v241 offset:28672
    s_waitcnt lgkmcnt(10)
    v_mfma_f32_16x16x32_bf16 v[16:19], v[212:215], v[144:147], v[16:19]
    v_exp_f32 v174, v174
    v_exp_f32 v175, v175
    v_mfma_f32_16x16x32_bf16 v[48:51], v[212:215], v[160:163], v[48:51]
    v_cvt_pk_bf16_f32 v170, v172, v173
    v_cvt_pk_bf16_f32 v171, v174, v175
    ds_read_b64_tr_b16 v[204:205], v242 offset:24576
    ds_read_b64_tr_b16 v[206:207], v242 offset:28672
    v_mfma_f32_16x16x32_bf16 v[20:23], v[216:219], v[144:147], v[20:23]
    v_fma_f32 v176, v176, s56, -v234
    v_fma_f32 v177, v177, s56, -v234
    v_mfma_f32_16x16x32_bf16 v[52:55], v[216:219], v[160:163], v[52:55]
    v_fma_f32 v178, v178, s56, -v234
    v_fma_f32 v179, v179, s56, -v234
    ds_read_b64_tr_b16 v[208:209], v243 offset:24576
    ds_read_b64_tr_b16 v[210:211], v243 offset:28672
    s_waitcnt lgkmcnt(10)
    v_mfma_f32_16x16x32_bf16 v[24:27], v[220:223], v[144:147], v[24:27]
    v_exp_f32 v176, v176
    v_exp_f32 v177, v177
    v_mfma_f32_16x16x32_bf16 v[56:59], v[220:223], v[160:163], v[56:59]
    v_exp_f32 v178, v178
    v_exp_f32 v179, v179
    ds_read_b64_tr_b16 v[212:213], v244 offset:24576
    ds_read_b64_tr_b16 v[214:215], v244 offset:28672
    v_mfma_f32_16x16x32_bf16 v[28:31], v[224:227], v[144:147], v[28:31]
    v_cvt_pk_bf16_f32 v176, v176, v177
    v_cvt_pk_bf16_f32 v177, v178, v179
    v_mfma_f32_16x16x32_bf16 v[60:63], v[224:227], v[160:163], v[60:63]
    ds_read_b64_tr_b16 v[216:217], v245 offset:24576
    ds_read_b64_tr_b16 v[218:219], v245 offset:28672
    v_mfma_f32_16x16x32_bf16 v[180:183], v[192:195], v[152:155], v[180:183]
    v_mfma_f32_16x16x32_bf16 v[184:187], v[192:195], v[168:171], v[184:187]
    v_mfma_f32_16x16x16_bf16 v[188:191], v[192:193], v[176:177], v[188:191]
    s_waitcnt lgkmcnt(10)
    v_mfma_f32_16x16x32_bf16 v[0:3], v[228:231], v[152:155], v[0:3]
    v_mfma_f32_16x16x32_bf16 v[32:35], v[228:231], v[168:171], v[32:35]
    ds_read_b64_tr_b16 v[220:221], v246 offset:24576
    ds_read_b64_tr_b16 v[222:223], v246 offset:28672
    v_mfma_f32_16x16x32_bf16 v[4:7], v[196:199], v[152:155], v[4:7]
    v_mfma_f32_16x16x32_bf16 v[36:39], v[196:199], v[168:171], v[36:39]
    v_add_u32 v224, s70, v239
    ds_read_b64_tr_b16 v[224:225], v224 offset:16384
    v_add_u32 v226, s70, v240
    ds_read_b64_tr_b16 v[226:227], v226 offset:16384
    s_waitcnt lgkmcnt(10)
    v_mfma_f32_16x16x32_bf16 v[8:11], v[200:203], v[152:155], v[8:11]
    v_mfma_f32_16x16x32_bf16 v[40:43], v[200:203], v[168:171], v[40:43]
    v_add_u32 v228, s70, v241
    ds_read_b64_tr_b16 v[228:229], v228 offset:16384
    v_add_u32 v230, s70, v242
    ds_read_b64_tr_b16 v[230:231], v230 offset:16384
    v_mfma_f32_16x16x32_bf16 v[12:15], v[204:207], v[152:155], v[12:15]
    v_mfma_f32_16x16x32_bf16 v[44:47], v[204:207], v[168:171], v[44:47]
    v_add_u32 v196, s70, v243
    ds_read_b64_tr_b16 v[196:197], v196 offset:16384
    v_add_u32 v198, s70, v244
    ds_read_b64_tr_b16 v[198:199], v198 offset:16384
    s_waitcnt lgkmcnt(10)
    v_mfma_f32_16x16x32_bf16 v[16:19], v[208:211], v[152:155], v[16:19]
    v_mfma_f32_16x16x32_bf16 v[48:51], v[208:211], v[168:171], v[48:51]
    v_add_u32 v200, s70, v245
    ds_read_b64_tr_b16 v[200:201], v200 offset:16384
    v_add_u32 v202, s70, v246
    ds_read_b64_tr_b16 v[202:203], v202 offset:16384
    v_mfma_f32_16x16x32_bf16 v[20:23], v[212:215], v[152:155], v[20:23]
    v_mfma_f32_16x16x32_bf16 v[52:55], v[212:215], v[168:171], v[52:55]
    s_waitcnt lgkmcnt(8)
    v_mfma_f32_16x16x32_bf16 v[24:27], v[216:219], v[152:155], v[24:27]
    v_mfma_f32_16x16x32_bf16 v[56:59], v[216:219], v[168:171], v[56:59]
    v_mfma_f32_16x16x32_bf16 v[28:31], v[220:223], v[152:155], v[28:31]
    v_mfma_f32_16x16x32_bf16 v[60:63], v[220:223], v[168:171], v[60:63]
    s_waitcnt lgkmcnt(4)
    v_mfma_f32_16x16x16_bf16 v[64:67], v[224:225], v[176:177], v[64:67]
    v_mfma_f32_16x16x16_bf16 v[68:71], v[226:227], v[176:177], v[68:71]
    v_mfma_f32_16x16x16_bf16 v[72:75], v[228:229], v[176:177], v[72:75]
    v_mfma_f32_16x16x16_bf16 v[76:79], v[230:231], v[176:177], v[76:79]
    s_waitcnt lgkmcnt(0)
    v_mfma_f32_16x16x16_bf16 v[80:83], v[196:197], v[176:177], v[80:83]
    v_mfma_f32_16x16x16_bf16 v[84:87], v[198:199], v[176:177], v[84:87]
    v_mfma_f32_16x16x16_bf16 v[88:91], v[200:201], v[176:177], v[88:91]
    v_mfma_f32_16x16x16_bf16 v[92:95], v[202:203], v[176:177], v[92:95]
    s_waitcnt vmcnt(8)
    s_barrier
    s_add_u32 m0, s57, 65536
    s_add_u32 s59, s69, 7
    s_and_b32 s59, s59, 7
    s_lshl_b32 s59, s59, 14
    buffer_load_dwordx4 v248, s[40:43], s59 offen nt lds
    s_add_u32 m0, s57, 69632
    s_add_u32 s59, s59, 4096
    buffer_load_dwordx4 v248, s[40:43], s59 offen nt lds
    s_add_u32 m0, s57, 73728
    s_add_u32 s59, s59, 4096
    buffer_load_dwordx4 v248, s[40:43], s59 offen nt lds
    s_add_u32 m0, s57, 77824
    s_add_u32 s59, s59, 4096
    buffer_load_dwordx4 v248, s[40:43], s59 offen nt lds
L1_redo6:
    ds_read_b128 v[196:199], v235 offset:32768
    ds_read_b128 v[200:203], v236 offset:32768
    ds_read_b128 v[204:207], v237 offset:32768
    ds_read_b128 v[208:211], v238 offset:32768
    ds_read_b128 v[212:215], v235 offset:36864
    ds_read_b128 v[216:219], v236 offset:36864
    ds_read_b128 v[220:223], v237 offset:36864
    ds_read_b128 v[224:227], v238 offset:36864
    s_setprio 2
    s_waitcnt lgkmcnt(4)
    v_mfma_f32_16x16x32_bf16 v[144:147], v[196:199], v[96:99], 0
    v_mfma_f32_16x16x32_bf16 v[160:163], v[196:199], v[112:115], 0
    v_mfma_f32_16x16x32_bf16 v[144:147], v[200:203], v[100:103], v[144:147]
    v_mfma_f32_16x16x32_bf16 v[160:163], v[200:203], v[116:119], v[160:163]
    v_mfma_f32_16x16x32_bf16 v[144:147], v[204:207], v[104:107], v[144:147]
    v_mfma_f32_16x16x32_bf16 v[160:163], v[204:207], v[120:123], v[160:163]
    v_mfma_f32_16x16x32_bf16 v[144:147], v[208:211], v[108:111], v[144:147]
    v_mfma_f32_16x16x32_bf16 v[160:163], v[208:211], v[124:127], v[160:163]
    ds_read_b128 v[196:199], v235 offset:40960
    ds_read_b128 v[200:203], v236 offset:40960
    ds_read_b128 v[204:207], v237 offset:40960
    ds_read_b128 v[208:211], v238 offset:40960
    s_waitcnt lgkmcnt(4)
    v_mfma_f32_16x16x32_bf16 v[148:151], v[212:215], v[96:99], 0
    v_mfma_f32_16x16x32_bf16 v[164:167], v[212:215], v[112:115], 0
    v_mfma_f32_16x16x32_bf16 v[148:151], v[216:219], v[100:103], v[148:151]
    v_max3_f32 v252, v144, v145, v146
    v_max3_f32 v253, v160, v161, v162
    v_max_f32 v252, v252, v147
    v_max_f32 v253, v253, v163
    v_mfma_f32_16x16x32_bf16 v[164:167], v[216:219], v[116:119], v[164:167]
    v_fma_f32 v144, v144, s56, -v232
    v_fma_f32 v145, v145, s56, -v232
    v_fma_f32 v146, v146, s56, -v232
    v_fma_f32 v147, v147, s56, -v232
    v_mfma_f32_16x16x32_bf16 v[148:151], v[220:223], v[104:107], v[148:151]
    v_exp_f32 v144, v144
    v_exp_f32 v145, v145
    v_exp_f32 v146, v146
    v_exp_f32 v147, v147
    v_mfma_f32_16x16x32_bf16 v[164:167], v[220:223], v[120:123], v[164:167]
    v_cvt_pk_bf16_f32 v144, v144, v145
    v_cvt_pk_bf16_f32 v145, v146, v147
    v_fma_f32 v160, v160, s56, -v233
    v_fma_f32 v161, v161, s56, -v233
    v_mfma_f32_16x16x32_bf16 v[148:151], v[224:227], v[108:111], v[148:151]
    v_fma_f32 v162, v162, s56, -v233
    v_fma_f32 v163, v163, s56, -v233
    v_exp_f32 v160, v160
    v_exp_f32 v161, v161
    v_mfma_f32_16x16x32_bf16 v[164:167], v[224:227], v[124:127], v[164:167]
    v_exp_f32 v162, v162
    v_exp_f32 v163, v163
    v_cvt_pk_bf16_f32 v160, v160, v161
    v_cvt_pk_bf16_f32 v161, v162, v163
    ds_read_b128 v[212:215], v235 offset:45056
    ds_read_b128 v[216:219], v236 offset:45056
    ds_read_b128 v[220:223], v237 offset:45056
    ds_read_b128 v[224:227], v238 offset:45056
    s_waitcnt lgkmcnt(4)
    v_mfma_f32_16x16x32_bf16 v[152:155], v[196:199], v[96:99], 0
    v_mfma_f32_16x16x32_bf16 v[168:171], v[196:199], v[112:115], 0
    v_mfma_f32_16x16x32_bf16 v[152:155], v[200:203], v[100:103], v[152:155]
    v_max3_f32 v252, v252, v148, v149
    v_max3_f32 v253, v253, v164, v165
    v_max3_f32 v252, v252, v150, v151
    v_max3_f32 v253, v253, v166, v167
    v_mfma_f32_16x16x32_bf16 v[168:171], v[200:203], v[116:119], v[168:171]
    v_fma_f32 v148, v148, s56, -v232
    v_fma_f32 v149, v149, s56, -v232
    v_fma_f32 v150, v150, s56, -v232
    v_fma_f32 v151, v151, s56, -v232
    v_mfma_f32_16x16x32_bf16 v[152:155], v[204:207], v[104:107], v[152:155]
    v_exp_f32 v148, v148
    v_exp_f32 v149, v149
    v_exp_f32 v150, v150
    v_exp_f32 v151, v151
    v_mfma_f32_16x16x32_bf16 v[168:171], v[204:207], v[120:123], v[168:171]
    v_cvt_pk_bf16_f32 v146, v148, v149
    v_cvt_pk_bf16_f32 v147, v150, v151
    v_fma_f32 v164, v164, s56, -v233
    v_fma_f32 v165, v165, s56, -v233
    v_mfma_f32_16x16x32_bf16 v[152:155], v[208:211], v[108:111], v[152:155]
    v_fma_f32 v166, v166, s56, -v233
    v_fma_f32 v167, v167, s56, -v233
    v_exp_f32 v164, v164
    v_exp_f32 v165, v165
    v_mfma_f32_16x16x32_bf16 v[168:171], v[208:211], v[124:127], v[168:171]
    v_exp_f32 v166, v166
    v_exp_f32 v167, v167
    v_cvt_pk_bf16_f32 v162, v164, v165
    v_cvt_pk_bf16_f32 v163, v166, v167
    v_add_u32 v196, s70, v235
    ds_read_b128 v[196:199], v196 offset:32768
    v_add_u32 v200, s70, v236
    ds_read_b128 v[200:203], v200 offset:32768
    v_add_u32 v204, s70, v237
    ds_read_b128 v[204:207], v204 offset:32768
    v_add_u32 v208, s70, v238
    ds_read_b128 v[208:211], v208 offset:32768
    s_waitcnt lgkmcnt(4)
    v_mfma_f32_16x16x32_bf16 v[156:159], v[212:215], v[96:99], 0
    v_mfma_f32_16x16x32_bf16 v[172:175], v[212:215], v[112:115], 0
    v_mfma_f32_16x16x32_bf16 v[156:159], v[216:219], v[100:103], v[156:159]
    v_max3_f32 v252, v252, v152, v153
    v_max3_f32 v253, v253, v168, v169
    v_max3_f32 v252, v252, v154, v155
    v_max3_f32 v253, v253, v170, v171
    v_mfma_f32_16x16x32_bf16 v[172:175], v[216:219], v[116:119], v[172:175]
    v_fma_f32 v152, v152, s56, -v232
    v_fma_f32 v153, v153, s56, -v232
    v_fma_f32 v154, v154, s56, -v232
    v_fma_f32 v155, v155, s56, -v232
    v_mfma_f32_16x16x32_bf16 v[156:159], v[220:223], v[104:107], v[156:159]
    v_exp_f32 v152, v152
    v_exp_f32 v153, v153
    v_exp_f32 v154, v154
    v_exp_f32 v155, v155
    v_mfma_f32_16x16x32_bf16 v[172:175], v[220:223], v[120:123], v[172:175]
    v_cvt_pk_bf16_f32 v152, v152, v153
    v_cvt_pk_bf16_f32 v153, v154, v155
    v_fma_f32 v168, v168, s56, -v233
    v_fma_f32 v169, v169, s56, -v233
    v_mfma_f32_16x16x32_bf16 v[156:159], v[224:227], v[108:111], v[156:159]
    v_fma_f32 v170, v170, s56, -v233
    v_fma_f32 v171, v171, s56, -v233
    v_exp_f32 v168, v168
    v_exp_f32 v169, v169
    v_mfma_f32_16x16x32_bf16 v[172:175], v[224:227], v[124:127], v[172:175]
    v_exp_f32 v170, v170
    v_exp_f32 v171, v171
    v_cvt_pk_bf16_f32 v168, v168, v169
    v_cvt_pk_bf16_f32 v169, v170, v171
    s_waitcnt lgkmcnt(0)
    v_mfma_f32_16x16x32_bf16 v[176:179], v[196:199], v[128:131], 0
    v_mfma_f32_16x16x32_bf16 v[176:179], v[200:203], v[132:135], v[176:179]
    v_mfma_f32_16x16x32_bf16 v[176:179], v[204:207], v[136:139], v[176:179]
    v_mfma_f32_16x16x32_bf16 v[176:179], v[208:211], v[140:143], v[176:179]
    s_setprio 0
    v_max3_f32 v252, v252, v156, v157
    v_max3_f32 v253, v253, v172, v173
    v_max3_f32 v252, v252, v158, v159
    v_max3_f32 v253, v253, v174, v175
    s_nop 2
    v_max3_f32 v254, v176, v177, v178
    v_max_f32 v254, v254, v179
    v_fma_f32 v249, v252, s56, -v232
    v_fma_f32 v250, v253, s56, -v233
    v_fma_f32 v251, v254, s56, -v234
    v_max3_f32 v249, v249, v250, v251
    v_cmp_lt_f32 s[72:73], s71, v249
    s_nop 1
    s_cmp_lg_u64 s[72:73], 0
    s_cbranch_scc0 L1_nr6
    v_mov_b32 v249, v252
    v_mov_b32 v250, v253
    v_mov_b32 v251, v254
    v_permlane32_swap_b32 v252, v249
    v_permlane32_swap_b32 v253, v250
    v_permlane32_swap_b32 v254, v251
    v_max_f32 v252, v252, v249
    v_max_f32 v253, v253, v250
    v_max_f32 v254, v254, v251
    v_mov_b32 v249, v252
    v_mov_b32 v250, v253
    v_mov_b32 v251, v254
    v_permlane16_swap_b32 v252, v249
    v_permlane16_swap_b32 v253, v250
    v_permlane16_swap_b32 v254, v251
    v_max_f32 v252, v252, v249
    v_max_f32 v253, v253, v250
    v_max_f32 v254, v254, v251
    v_mul_f32 v252, s56, v252
    v_max_f32 v252, v252, v232
    v_sub_f32 v249, v232, v252
    v_exp_f32 v249, v249
    v_mov_b32 v232, v252
    v_mul_f32 v0, v0, v249
    v_mul_f32 v1, v1, v249
    v_mul_f32 v2, v2, v249
    v_mul_f32 v3, v3, v249
    v_mul_f32 v4, v4, v249
    v_mul_f32 v5, v5, v249
    v_mul_f32 v6, v6, v249
    v_mul_f32 v7, v7, v249
    v_mul_f32 v8, v8, v249
    v_mul_f32 v9, v9, v249
    v_mul_f32 v10, v10, v249
    v_mul_f32 v11, v11, v249
    v_mul_f32 v12, v12, v249
    v_mul_f32 v13, v13, v249
    v_mul_f32 v14, v14, v249
    v_mul_f32 v15, v15, v249
    v_mul_f32 v16, v16, v249
    v_mul_f32 v17, v17, v249
    v_mul_f32 v18, v18, v249
    v_mul_f32 v19, v19, v249
    v_mul_f32 v20, v20, v249
    v_mul_f32 v21, v21, v249
    v_mul_f32 v22, v22, v249
    v_mul_f32 v23, v23, v249
    v_mul_f32 v24, v24, v249
    v_mul_f32 v25, v25, v249
    v_mul_f32 v26, v26, v249
    v_mul_f32 v27, v27, v249
    v_mul_f32 v28, v28, v249
    v_mul_f32 v29, v29, v249
    v_mul_f32 v30, v30, v249
    v_mul_f32 v31, v31, v249
    v_mul_f32 v180, v180, v249
    v_mul_f32 v181, v181, v249
    v_mul_f32 v182, v182, v249
    v_mul_f32 v183, v183, v249
    v_mul_f32 v253, s56, v253
    v_max_f32 v253, v253, v233
    v_sub_f32 v249, v233, v253
    v_exp_f32 v249, v249
    v_mov_b32 v233, v253
    v_mul_f32 v32, v32, v249
    v_mul_f32 v33, v33, v249
    v_mul_f32 v34, v34, v249
    v_mul_f32 v35, v35, v249
    v_mul_f32 v36, v36, v249
    v_mul_f32 v37, v37, v249
    v_mul_f32 v38, v38, v249
    v_mul_f32 v39, v39, v249
    v_mul_f32 v40, v40, v249
    v_mul_f32 v41, v41, v249
    v_mul_f32 v42, v42, v249
    v_mul_f32 v43, v43, v249
    v_mul_f32 v44, v44, v249
    v_mul_f32 v45, v45, v249
    v_mul_f32 v46, v46, v249
    v_mul_f32 v47, v47, v249
    v_mul_f32 v48, v48, v249
    v_mul_f32 v49, v49, v249
    v_mul_f32 v50, v50, v249
    v_mul_f32 v51, v51, v249
    v_mul_f32 v52, v52, v249
    v_mul_f32 v53, v53, v249
    v_mul_f32 v54, v54, v249
    v_mul_f32 v55, v55, v249
    v_mul_f32 v56, v56, v249
    v_mul_f32 v57, v57, v249
    v_mul_f32 v58, v58, v249
    v_mul_f32 v59, v59, v249
    v_mul_f32 v60, v60, v249
    v_mul_f32 v61, v61, v249
    v_mul_f32 v62, v62, v249
    v_mul_f32 v63, v63, v249
    v_mul_f32 v184, v184, v249
    v_mul_f32 v185, v185, v249
    v_mul_f32 v186, v186, v249
    v_mul_f32 v187, v187, v249
    v_mul_f32 v254, s56, v254
    v_max_f32 v254, v254, v234
    v_sub_f32 v249, v234, v254
    v_exp_f32 v249, v249
    v_mov_b32 v234, v254
    v_mul_f32 v64, v64, v249
    v_mul_f32 v65, v65, v249
    v_mul_f32 v66, v66, v249
    v_mul_f32 v67, v67, v249
    v_mul_f32 v68, v68, v249
    v_mul_f32 v69, v69, v249
    v_mul_f32 v70, v70, v249
    v_mul_f32 v71, v71, v249
    v_mul_f32 v72, v72, v249
    v_mul_f32 v73, v73, v249
    v_mul_f32 v74, v74, v249
    v_mul_f32 v75, v75, v249
    v_mul_f32 v76, v76, v249
    v_mul_f32 v77, v77, v249
    v_mul_f32 v78, v78, v249
    v_mul_f32 v79, v79, v249
    v_mul_f32 v80, v80, v249
    v_mul_f32 v81, v81, v249
    v_mul_f32 v82, v82, v249
    v_mul_f32 v83, v83, v249
    v_mul_f32 v84, v84, v249
    v_mul_f32 v85, v85, v249
    v_mul_f32 v86, v86, v249
    v_mul_f32 v87, v87, v249
    v_mul_f32 v88, v88, v249
    v_mul_f32 v89, v89, v249
    v_mul_f32 v90, v90, v249
    v_mul_f32 v91, v91, v249
    v_mul_f32 v92, v92, v249
    v_mul_f32 v93, v93, v249
    v_mul_f32 v94, v94, v249
    v_mul_f32 v95, v95, v249
    v_mul_f32 v188, v188, v249
    v_mul_f32 v189, v189, v249
    v_mul_f32 v190, v190, v249
    v_mul_f32 v191, v191, v249
    s_nop 1
    s_branch L1_redo6
L1_nr6:
    s_waitcnt vmcnt(4)
    s_barrier
    ds_read_b64_tr_b16 v[196:197], v239 offset:0
    ds_read_b64_tr_b16 v[198:199], v239 offset:4096
    ds_read_b64_tr_b16 v[200:201], v240 offset:0
    ds_read_b64_tr_b16 v[202:203], v240 offset:4096
    ds_read_b64_tr_b16 v[204:205], v241 offset:0
    ds_read_b64_tr_b16 v[206:207], v241 offset:4096
    ds_read_b64_tr_b16 v[208:209], v242 offset:0
    ds_read_b64_tr_b16 v[210:211], v242 offset:4096
    ds_read_b64_tr_b16 v[212:213], v243 offset:0
    ds_read_b64_tr_b16 v[214:215], v243 offset:4096
    ds_read_b64_tr_b16 v[216:217], v244 offset:0
    ds_read_b64_tr_b16 v[218:219], v244 offset:4096
    ds_read_b64_tr_b16 v[220:221], v245 offset:0
    ds_read_b64_tr_b16 v[222:223], v245 offset:4096
    s_setprio 2
    v_mfma_f32_16x16x32_bf16 v[180:183], v[192:195], v[144:147], v[180:183]
    v_mfma_f32_16x16x32_bf16 v[184:187], v[192:195], v[160:163], v[184:187]
    s_waitcnt lgkmcnt(10)
    v_mfma_f32_16x16x32_bf16 v[0:3], v[196:199], v[144:147], v[0:3]
    v_fma_f32 v156, v156, s56, -v232
    v_fma_f32 v157, v157, s56, -v232
    v_mfma_f32_16x16x32_bf16 v[32:35], v[196:199], v[160:163], v[32:35]
    v_fma_f32 v158, v158, s56, -v232
    v_fma_f32 v159, v159, s56, -v232
    ds_read_b64_tr_b16 v[224:225], v246 offset:0
    ds_read_b64_tr_b16 v[226:227], v246 offset:4096
    v_mfma_f32_16x16x32_bf16 v[4:7], v[200:203], v[144:147], v[4:7]
    v_exp_f32 v156, v156
    v_exp_f32 v157, v157
    v_mfma_f32_16x16x32_bf16 v[36:39], v[200:203], v[160:163], v[36:39]
    v_exp_f32 v158, v158
    v_exp_f32 v159, v159
    ds_read_b64_tr_b16 v[228:229], v239 offset:8192
    ds_read_b64_tr_b16 v[230:231], v239 offset:12288
    s_waitcnt lgkmcnt(10)
    v_mfma_f32_16x16x32_bf16 v[8:11], v[204:207], v[144:147], v[8:11]
    v_cvt_pk_bf16_f32 v154, v156, v157
    v_cvt_pk_bf16_f32 v155, v158, v159
    v_mfma_f32_16x16x32_bf16 v[40:43], v[204:207], v[160:163], v[40:43]
    v_fma_f32 v172, v172, s56, -v233
    v_fma_f32 v173, v173, s56, -v233
    ds_read_b64_tr_b16 v[196:197], v240 offset:8192
    ds_read_b64_tr_b16 v[198:199], v240 offset:12288
    v_mfma_f32_16x16x32_bf16 v[12:15], v[208:211], v[144:147], v[12:15]
    v_fma_f32 v174, v174, s56, -v233
    v_fma_f32 v175, v175, s56, -v233
    v_mfma_f32_16x16x32_bf16 v[44:47], v[208:211], v[160:163], v[44:47]
    v_exp_f32 v172, v172
    v_exp_f32 v173, v173
    ds_read_b64_tr_b16 v[200:201], v241 offset:8192
    ds_read_b64_tr_b16 v[202:203], v241 offset:12288
    s_waitcnt lgkmcnt(10)
    v_mfma_f32_16x16x32_bf16 v[16:19], v[212:215], v[144:147], v[16:19]
    v_exp_f32 v174, v174
    v_exp_f32 v175, v175
    v_mfma_f32_16x16x32_bf16 v[48:51], v[212:215], v[160:163], v[48:51]
    v_cvt_pk_bf16_f32 v170, v172, v173
    v_cvt_pk_bf16_f32 v171, v174, v175
    ds_read_b64_tr_b16 v[204:205], v242 offset:8192
    ds_read_b64_tr_b16 v[206:207], v242 offset:12288
    v_mfma_f32_16x16x32_bf16 v[20:23], v[216:219], v[144:147], v[20:23]
    v_fma_f32 v176, v176, s56, -v234
    v_fma_f32 v177, v177, s56, -v234
    v_mfma_f32_16x16x32_bf16 v[52:55], v[216:219], v[160:163], v[52:55]
    v_fma_f32 v178, v178, s56, -v234
    v_fma_f32 v179, v179, s56, -v234
    ds_read_b64_tr_b16 v[208:209], v243 offset:8192
    ds_read_b64_tr_b16 v[210:211], v243 offset:12288
    s_waitcnt lgkmcnt(10)
    v_mfma_f32_16x16x32_bf16 v[24:27], v[220:223], v[144:147], v[24:27]
    v_exp_f32 v176, v176
    v_exp_f32 v177, v177
    v_mfma_f32_16x16x32_bf16 v[56:59], v[220:223], v[160:163], v[56:59]
    v_exp_f32 v178, v178
    v_exp_f32 v179, v179
    ds_read_b64_tr_b16 v[212:213], v244 offset:8192
    ds_read_b64_tr_b16 v[214:215], v244 offset:12288
    v_mfma_f32_16x16x32_bf16 v[28:31], v[224:227], v[144:147], v[28:31]
    v_cvt_pk_bf16_f32 v176, v176, v177
    v_cvt_pk_bf16_f32 v177, v178, v179
    v_mfma_f32_16x16x32_bf16 v[60:63], v[224:227], v[160:163], v[60:63]
    ds_read_b64_tr_b16 v[216:217], v245 offset:8192
    ds_read_b64_tr_b16 v[218:219], v245 offset:12288
    v_mfma_f32_16x16x32_bf16 v[180:183], v[192:195], v[152:155], v[180:183]
    v_mfma_f32_16x16x32_bf16 v[184:187], v[192:195], v[168:171], v[184:187]
    v_mfma_f32_16x16x16_bf16 v[188:191], v[192:193], v[176:177], v[188:191]
    s_waitcnt lgkmcnt(10)
    v_mfma_f32_16x16x32_bf16 v[0:3], v[228:231], v[152:155], v[0:3]
    v_mfma_f32_16x16x32_bf16 v[32:35], v[228:231], v[168:171], v[32:35]
    ds_read_b64_tr_b16 v[220:221], v246 offset:8192
    ds_read_b64_tr_b16 v[222:223], v246 offset:12288
    v_mfma_f32_16x16x32_bf16 v[4:7], v[196:199], v[152:155], v[4:7]
    v_mfma_f32_16x16x32_bf16 v[36:39], v[196:199], v[168:171], v[36:39]
    v_add_u32 v224, s70, v239
    ds_read_b64_tr_b16 v[224:225], v224 offset:0
    v_add_u32 v226, s70, v240
    ds_read_b64_tr_b16 v[226:227], v226 offset:0
    s_waitcnt lgkmcnt(10)
    v_mfma_f32_16x16x32_bf16 v[8:11], v[200:203], v[152:155], v[8:11]
    v_mfma_f32_16x16x32_bf16 v[40:43], v[200:203], v[168:171], v[40:43]
    v_add_u32 v228, s70, v241
    ds_read_b64_tr_b16 v[228:229], v228 offset:0
    v_add_u32 v230, s70, v242
    ds_read_b64_tr_b16 v[230:231], v230 offset:0
    v_mfma_f32_16x16x32_bf16 v[12:15], v[204:207], v[152:155], v[12:15]
    v_mfma_f32_16x16x32_bf16 v[44:47], v[204:207], v[168:171], v[44:47]
    v_add_u32 v196, s70, v243
    ds_read_b64_tr_b16 v[196:197], v196 offset:0
    v_add_u32 v198, s70, v244
    ds_read_b64_tr_b16 v[198:199], v198 offset:0
    s_waitcnt lgkmcnt(10)
    v_mfma_f32_16x16x32_bf16 v[16:19], v[208:211], v[152:155], v[16:19]
    v_mfma_f32_16x16x32_bf16 v[48:51], v[208:211], v[168:171], v[48:51]
    v_add_u32 v200, s70, v245
    ds_read_b64_tr_b16 v[200:201], v200 offset:0
    v_add_u32 v202, s70, v246
    ds_read_b64_tr_b16 v[202:203], v202 offset:0
    v_mfma_f32_16x16x32_bf16 v[20:23], v[212:215], v[152:155], v[20:23]
    v_mfma_f32_16x16x32_bf16 v[52:55], v[212:215], v[168:171], v[52:55]
    s_waitcnt lgkmcnt(8)
    v_mfma_f32_16x16x32_bf16 v[24:27], v[216:219], v[152:155], v[24:27]
    v_mfma_f32_16x16x32_bf16 v[56:59], v[216:219], v[168:171], v[56:59]
    v_mfma_f32_16x16x32_bf16 v[28:31], v[220:223], v[152:155], v[28:31]
    v_mfma_f32_16x16x32_bf16 v[60:63], v[220:223], v[168:171], v[60:63]
    s_waitcnt lgkmcnt(4)
    v_mfma_f32_16x16x16_bf16 v[64:67], v[224:225], v[176:177], v[64:67]
    v_mfma_f32_16x16x16_bf16 v[68:71], v[226:227], v[176:177], v[68:71]
    v_mfma_f32_16x16x16_bf16 v[72:75], v[228:229], v[176:177], v[72:75]
    v_mfma_f32_16x16x16_bf16 v[76:79], v[230:231], v[176:177], v[76:79]
    s_waitcnt lgkmcnt(0)
    v_mfma_f32_16x16x16_bf16 v[80:83], v[196:197], v[176:177], v[80:83]
    v_mfma_f32_16x16x16_bf16 v[84:87], v[198:199], v[176:177], v[84:87]
    v_mfma_f32_16x16x16_bf16 v[88:91], v[200:201], v[176:177], v[88:91]
    v_mfma_f32_16x16x16_bf16 v[92:95], v[202:203], v[176:177], v[92:95]
    s_waitcnt vmcnt(4)
    s_barrier
    s_nop 5
L1_redo7:
    ds_read_b128 v[196:199], v235 offset:0
    ds_read_b128 v[200:203], v236 offset:0
    ds_read_b128 v[204:207], v237 offset:0
    ds_read_b128 v[208:211], v238 offset:0
    ds_read_b128 v[212:215], v235 offset:4096
    ds_read_b128 v[216:219], v236 offset:4096
    ds_read_b128 v[220:223], v237 offset:4096
    ds_read_b128 v[224:227], v238 offset:4096
    s_setprio 2
    s_waitcnt lgkmcnt(4)
    v_mfma_f32_16x16x32_bf16 v[144:147], v[196:199], v[96:99], 0
    v_mfma_f32_16x16x32_bf16 v[160:163], v[196:199], v[112:115], 0
    v_mfma_f32_16x16x32_bf16 v[144:147], v[200:203], v[100:103], v[144:147]
    v_mfma_f32_16x16x32_bf16 v[160:163], v[200:203], v[116:119], v[160:163]
    v_mfma_f32_16x16x32_bf16 v[144:147], v[204:207], v[104:107], v[144:147]
    v_mfma_f32_16x16x32_bf16 v[160:163], v[204:207], v[120:123], v[160:163]
    v_mfma_f32_16x16x32_bf16 v[144:147], v[208:211], v[108:111], v[144:147]
    v_mfma_f32_16x16x32_bf16 v[160:163], v[208:211], v[124:127], v[160:163]
    ds_read_b128 v[196:199], v235 offset:8192
    ds_read_b128 v[200:203], v236 offset:8192
    ds_read_b128 v[204:207], v237 offset:8192
    ds_read_b128 v[208:211], v238 offset:8192
    s_waitcnt lgkmcnt(4)
    v_mfma_f32_16x16x32_bf16 v[148:151], v[212:215], v[96:99], 0
    v_mfma_f32_16x16x32_bf16 v[164:167], v[212:215], v[112:115], 0
    v_mfma_f32_16x16x32_bf16 v[148:151], v[216:219], v[100:103], v[148:151]
    v_max3_f32 v252, v144, v145, v146
    v_max3_f32 v253, v160, v161, v162
    v_max_f32 v252, v252, v147
    v_max_f32 v253, v253, v163
    v_mfma_f32_16x16x32_bf16 v[164:167], v[216:219], v[116:119], v[164:167]
    v_fma_f32 v144, v144, s56, -v232
    v_fma_f32 v145, v145, s56, -v232
    v_fma_f32 v146, v146, s56, -v232
    v_fma_f32 v147, v147, s56, -v232
    v_mfma_f32_16x16x32_bf16 v[148:151], v[220:223], v[104:107], v[148:151]
    v_exp_f32 v144, v144
    v_exp_f32 v145, v145
    v_exp_f32 v146, v146
    v_exp_f32 v147, v147
    v_mfma_f32_16x16x32_bf16 v[164:167], v[220:223], v[120:123], v[164:167]
    v_cvt_pk_bf16_f32 v144, v144, v145
    v_cvt_pk_bf16_f32 v145, v146, v147
    v_fma_f32 v160, v160, s56, -v233
    v_fma_f32 v161, v161, s56, -v233
    v_mfma_f32_16x16x32_bf16 v[148:151], v[224:227], v[108:111], v[148:151]
    v_fma_f32 v162, v162, s56, -v233
    v_fma_f32 v163, v163, s56, -v233
    v_exp_f32 v160, v160
    v_exp_f32 v161, v161
    v_mfma_f32_16x16x32_bf16 v[164:167], v[224:227], v[124:127], v[164:167]
    v_exp_f32 v162, v162
    v_exp_f32 v163, v163
    v_cvt_pk_bf16_f32 v160, v160, v161
    v_cvt_pk_bf16_f32 v161, v162, v163
    ds_read_b128 v[212:215], v235 offset:12288
    ds_read_b128 v[216:219], v236 offset:12288
    ds_read_b128 v[220:223], v237 offset:12288
    ds_read_b128 v[224:227], v238 offset:12288
    s_waitcnt lgkmcnt(4)
    v_mfma_f32_16x16x32_bf16 v[152:155], v[196:199], v[96:99], 0
    v_mfma_f32_16x16x32_bf16 v[168:171], v[196:199], v[112:115], 0
    v_mfma_f32_16x16x32_bf16 v[152:155], v[200:203], v[100:103], v[152:155]
    v_max3_f32 v252, v252, v148, v149
    v_max3_f32 v253, v253, v164, v165
    v_max3_f32 v252, v252, v150, v151
    v_max3_f32 v253, v253, v166, v167
    v_mfma_f32_16x16x32_bf16 v[168:171], v[200:203], v[116:119], v[168:171]
    v_fma_f32 v148, v148, s56, -v232
    v_fma_f32 v149, v149, s56, -v232
    v_fma_f32 v150, v150, s56, -v232
    v_fma_f32 v151, v151, s56, -v232
    v_mfma_f32_16x16x32_bf16 v[152:155], v[204:207], v[104:107], v[152:155]
    v_exp_f32 v148, v148
    v_exp_f32 v149, v149
    v_exp_f32 v150, v150
    v_exp_f32 v151, v151
    v_mfma_f32_16x16x32_bf16 v[168:171], v[204:207], v[120:123], v[168:171]
    v_cvt_pk_bf16_f32 v146, v148, v149
    v_cvt_pk_bf16_f32 v147, v150, v151
    v_fma_f32 v164, v164, s56, -v233
    v_fma_f32 v165, v165, s56, -v233
    v_mfma_f32_16x16x32_bf16 v[152:155], v[208:211], v[108:111], v[152:155]
    v_fma_f32 v166, v166, s56, -v233
    v_fma_f32 v167, v167, s56, -v233
    v_exp_f32 v164, v164
    v_exp_f32 v165, v165
    v_mfma_f32_16x16x32_bf16 v[168:171], v[208:211], v[124:127], v[168:171]
    v_exp_f32 v166, v166
    v_exp_f32 v167, v167
    v_cvt_pk_bf16_f32 v162, v164, v165
    v_cvt_pk_bf16_f32 v163, v166, v167
    v_add_u32 v196, s70, v235
    ds_read_b128 v[196:199], v196 offset:0
    v_add_u32 v200, s70, v236
    ds_read_b128 v[200:203], v200 offset:0
    v_add_u32 v204, s70, v237
    ds_read_b128 v[204:207], v204 offset:0
    v_add_u32 v208, s70, v238
    ds_read_b128 v[208:211], v208 offset:0
    s_waitcnt lgkmcnt(4)
    v_mfma_f32_16x16x32_bf16 v[156:159], v[212:215], v[96:99], 0
    v_mfma_f32_16x16x32_bf16 v[172:175], v[212:215], v[112:115], 0
    v_mfma_f32_16x16x32_bf16 v[156:159], v[216:219], v[100:103], v[156:159]
    v_max3_f32 v252, v252, v152, v153
    v_max3_f32 v253, v253, v168, v169
    v_max3_f32 v252, v252, v154, v155
    v_max3_f32 v253, v253, v170, v171
    v_mfma_f32_16x16x32_bf16 v[172:175], v[216:219], v[116:119], v[172:175]
    v_fma_f32 v152, v152, s56, -v232
    v_fma_f32 v153, v153, s56, -v232
    v_fma_f32 v154, v154, s56, -v232
    v_fma_f32 v155, v155, s56, -v232
    v_mfma_f32_16x16x32_bf16 v[156:159], v[220:223], v[104:107], v[156:159]
    v_exp_f32 v152, v152
    v_exp_f32 v153, v153
    v_exp_f32 v154, v154
    v_exp_f32 v155, v155
    v_mfma_f32_16x16x32_bf16 v[172:175], v[220:223], v[120:123], v[172:175]
    v_cvt_pk_bf16_f32 v152, v152, v153
    v_cvt_pk_bf16_f32 v153, v154, v155
    v_fma_f32 v168, v168, s56, -v233
    v_fma_f32 v169, v169, s56, -v233
    v_mfma_f32_16x16x32_bf16 v[156:159], v[224:227], v[108:111], v[156:159]
    v_fma_f32 v170, v170, s56, -v233
    v_fma_f32 v171, v171, s56, -v233
    v_exp_f32 v168, v168
    v_exp_f32 v169, v169
    v_mfma_f32_16x16x32_bf16 v[172:175], v[224:227], v[124:127], v[172:175]
    v_exp_f32 v170, v170
    v_exp_f32 v171, v171
    v_cvt_pk_bf16_f32 v168, v168, v169
    v_cvt_pk_bf16_f32 v169, v170, v171
    s_waitcnt lgkmcnt(0)
    v_mfma_f32_16x16x32_bf16 v[176:179], v[196:199], v[128:131], 0
    v_mfma_f32_16x16x32_bf16 v[176:179], v[200:203], v[132:135], v[176:179]
    v_mfma_f32_16x16x32_bf16 v[176:179], v[204:207], v[136:139], v[176:179]
    v_mfma_f32_16x16x32_bf16 v[176:179], v[208:211], v[140:143], v[176:179]
    s_setprio 0
    v_max3_f32 v252, v252, v156, v157
    v_max3_f32 v253, v253, v172, v173
    v_max3_f32 v252, v252, v158, v159
    v_max3_f32 v253, v253, v174, v175
    s_nop 2
    v_max3_f32 v254, v176, v177, v178
    v_max_f32 v254, v254, v179
    v_fma_f32 v249, v252, s56, -v232
    v_fma_f32 v250, v253, s56, -v233
    v_fma_f32 v251, v254, s56, -v234
    v_max3_f32 v249, v249, v250, v251
    v_cmp_lt_f32 s[72:73], s71, v249
    s_nop 1
    s_cmp_lg_u64 s[72:73], 0
    s_cbranch_scc0 L1_nr7
    v_mov_b32 v249, v252
    v_mov_b32 v250, v253
    v_mov_b32 v251, v254
    v_permlane32_swap_b32 v252, v249
    v_permlane32_swap_b32 v253, v250
    v_permlane32_swap_b32 v254, v251
    v_max_f32 v252, v252, v249
    v_max_f32 v253, v253, v250
    v_max_f32 v254, v254, v251
    v_mov_b32 v249, v252
    v_mov_b32 v250, v253
    v_mov_b32 v251, v254
    v_permlane16_swap_b32 v252, v249
    v_permlane16_swap_b32 v253, v250
    v_permlane16_swap_b32 v254, v251
    v_max_f32 v252, v252, v249
    v_max_f32 v253, v253, v250
    v_max_f32 v254, v254, v251
    v_mul_f32 v252, s56, v252
    v_max_f32 v252, v252, v232
    v_sub_f32 v249, v232, v252
    v_exp_f32 v249, v249
    v_mov_b32 v232, v252
    v_mul_f32 v0, v0, v249
    v_mul_f32 v1, v1, v249
    v_mul_f32 v2, v2, v249
    v_mul_f32 v3, v3, v249
    v_mul_f32 v4, v4, v249
    v_mul_f32 v5, v5, v249
    v_mul_f32 v6, v6, v249
    v_mul_f32 v7, v7, v249
    v_mul_f32 v8, v8, v249
    v_mul_f32 v9, v9, v249
    v_mul_f32 v10, v10, v249
    v_mul_f32 v11, v11, v249
    v_mul_f32 v12, v12, v249
    v_mul_f32 v13, v13, v249
    v_mul_f32 v14, v14, v249
    v_mul_f32 v15, v15, v249
    v_mul_f32 v16, v16, v249
    v_mul_f32 v17, v17, v249
    v_mul_f32 v18, v18, v249
    v_mul_f32 v19, v19, v249
    v_mul_f32 v20, v20, v249
    v_mul_f32 v21, v21, v249
    v_mul_f32 v22, v22, v249
    v_mul_f32 v23, v23, v249
    v_mul_f32 v24, v24, v249
    v_mul_f32 v25, v25, v249
    v_mul_f32 v26, v26, v249
    v_mul_f32 v27, v27, v249
    v_mul_f32 v28, v28, v249
    v_mul_f32 v29, v29, v249
    v_mul_f32 v30, v30, v249
    v_mul_f32 v31, v31, v249
    v_mul_f32 v180, v180, v249
    v_mul_f32 v181, v181, v249
    v_mul_f32 v182, v182, v249
    v_mul_f32 v183, v183, v249
    v_mul_f32 v253, s56, v253
    v_max_f32 v253, v253, v233
    v_sub_f32 v249, v233, v253
    v_exp_f32 v249, v249
    v_mov_b32 v233, v253
    v_mul_f32 v32, v32, v249
    v_mul_f32 v33, v33, v249
    v_mul_f32 v34, v34, v249
    v_mul_f32 v35, v35, v249
    v_mul_f32 v36, v36, v249
    v_mul_f32 v37, v37, v249
    v_mul_f32 v38, v38, v249
    v_mul_f32 v39, v39, v249
    v_mul_f32 v40, v40, v249
    v_mul_f32 v41, v41, v249
    v_mul_f32 v42, v42, v249
    v_mul_f32 v43, v43, v249
    v_mul_f32 v44, v44, v249
    v_mul_f32 v45, v45, v249
    v_mul_f32 v46, v46, v249
    v_mul_f32 v47, v47, v249
    v_mul_f32 v48, v48, v249
    v_mul_f32 v49, v49, v249
    v_mul_f32 v50, v50, v249
    v_mul_f32 v51, v51, v249
    v_mul_f32 v52, v52, v249
    v_mul_f32 v53, v53, v249
    v_mul_f32 v54, v54, v249
    v_mul_f32 v55, v55, v249
    v_mul_f32 v56, v56, v249
    v_mul_f32 v57, v57, v249
    v_mul_f32 v58, v58, v249
    v_mul_f32 v59, v59, v249
    v_mul_f32 v60, v60, v249
    v_mul_f32 v61, v61, v249
    v_mul_f32 v62, v62, v249
    v_mul_f32 v63, v63, v249
    v_mul_f32 v184, v184, v249
    v_mul_f32 v185, v185, v249
    v_mul_f32 v186, v186, v249
    v_mul_f32 v187, v187, v249
    v_mul_f32 v254, s56, v254
    v_max_f32 v254, v254, v234
    v_sub_f32 v249, v234, v254
    v_exp_f32 v249, v249
    v_mov_b32 v234, v254
    v_mul_f32 v64, v64, v249
    v_mul_f32 v65, v65, v249
    v_mul_f32 v66, v66, v249
    v_mul_f32 v67, v67, v249
    v_mul_f32 v68, v68, v249
    v_mul_f32 v69, v69, v249
    v_mul_f32 v70, v70, v249
    v_mul_f32 v71, v71, v249
    v_mul_f32 v72, v72, v249
    v_mul_f32 v73, v73, v249
    v_mul_f32 v74, v74, v249
    v_mul_f32 v75, v75, v249
    v_mul_f32 v76, v76, v249
    v_mul_f32 v77, v77, v249
    v_mul_f32 v78, v78, v249
    v_mul_f32 v79, v79, v249
    v_mul_f32 v80, v80, v249
    v_mul_f32 v81, v81, v249
    v_mul_f32 v82, v82, v249
    v_mul_f32 v83, v83, v249
    v_mul_f32 v84, v84, v249
    v_mul_f32 v85, v85, v249
    v_mul_f32 v86, v86, v249
    v_mul_f32 v87, v87, v249
    v_mul_f32 v88, v88, v249
    v_mul_f32 v89, v89, v249
    v_mul_f32 v90, v90, v249
    v_mul_f32 v91, v91, v249
    v_mul_f32 v92, v92, v249
    v_mul_f32 v93, v93, v249
    v_mul_f32 v94, v94, v249
    v_mul_f32 v95, v95, v249
    v_mul_f32 v188, v188, v249
    v_mul_f32 v189, v189, v249
    v_mul_f32 v190, v190, v249
    v_mul_f32 v191, v191, v249
    s_nop 1
    s_branch L1_redo7
L1_nr7:
    s_waitcnt vmcnt(0)
    s_barrier
    ds_read_b64_tr_b16 v[196:197], v239 offset:16384
    ds_read_b64_tr_b16 v[198:199], v239 offset:20480
    ds_read_b64_tr_b16 v[200:201], v240 offset:16384
    ds_read_b64_tr_b16 v[202:203], v240 offset:20480
    ds_read_b64_tr_b16 v[204:205], v241 offset:16384
    ds_read_b64_tr_b16 v[206:207], v241 offset:20480
    ds_read_b64_tr_b16 v[208:209], v242 offset:16384
    ds_read_b64_tr_b16 v[210:211], v242 offset:20480
    ds_read_b64_tr_b16 v[212:213], v243 offset:16384
    ds_read_b64_tr_b16 v[214:215], v243 offset:20480
    ds_read_b64_tr_b16 v[216:217], v244 offset:16384
    ds_read_b64_tr_b16 v[218:219], v244 offset:20480
    ds_read_b64_tr_b16 v[220:221], v245 offset:16384
    ds_read_b64_tr_b16 v[222:223], v245 offset:20480
    s_setprio 2
    v_mfma_f32_16x16x32_bf16 v[180:183], v[192:195], v[144:147], v[180:183]
    v_mfma_f32_16x16x32_bf16 v[184:187], v[192:195], v[160:163], v[184:187]
    s_waitcnt lgkmcnt(10)
    v_mfma_f32_16x16x32_bf16 v[0:3], v[196:199], v[144:147], v[0:3]
    v_fma_f32 v156, v156, s56, -v232
    v_fma_f32 v157, v157, s56, -v232
    v_mfma_f32_16x16x32_bf16 v[32:35], v[196:199], v[160:163], v[32:35]
    v_fma_f32 v158, v158, s56, -v232
    v_fma_f32 v159, v159, s56, -v232
    ds_read_b64_tr_b16 v[224:225], v246 offset:16384
    ds_read_b64_tr_b16 v[226:227], v246 offset:20480
    v_mfma_f32_16x16x32_bf16 v[4:7], v[200:203], v[144:147], v[4:7]
    v_exp_f32 v156, v156
    v_exp_f32 v157, v157
    v_mfma_f32_16x16x32_bf16 v[36:39], v[200:203], v[160:163], v[36:39]
    v_exp_f32 v158, v158
    v_exp_f32 v159, v159
    ds_read_b64_tr_b16 v[228:229], v239 offset:24576
    ds_read_b64_tr_b16 v[230:231], v239 offset:28672
    s_waitcnt lgkmcnt(10)
    v_mfma_f32_16x16x32_bf16 v[8:11], v[204:207], v[144:147], v[8:11]
    v_cvt_pk_bf16_f32 v154, v156, v157
    v_cvt_pk_bf16_f32 v155, v158, v159
    v_mfma_f32_16x16x32_bf16 v[40:43], v[204:207], v[160:163], v[40:43]
    v_fma_f32 v172, v172, s56, -v233
    v_fma_f32 v173, v173, s56, -v233
    ds_read_b64_tr_b16 v[196:197], v240 offset:24576
    ds_read_b64_tr_b16 v[198:199], v240 offset:28672
    v_mfma_f32_16x16x32_bf16 v[12:15], v[208:211], v[144:147], v[12:15]
    v_fma_f32 v174, v174, s56, -v233
    v_fma_f32 v175, v175, s56, -v233
    v_mfma_f32_16x16x32_bf16 v[44:47], v[208:211], v[160:163], v[44:47]
    v_exp_f32 v172, v172
    v_exp_f32 v173, v173
    ds_read_b64_tr_b16 v[200:201], v241 offset:24576
    ds_read_b64_tr_b16 v[202:203], v241 offset:28672
    s_waitcnt lgkmcnt(10)
    v_mfma_f32_16x16x32_bf16 v[16:19], v[212:215], v[144:147], v[16:19]
    v_exp_f32 v174, v174
    v_exp_f32 v175, v175
    v_mfma_f32_16x16x32_bf16 v[48:51], v[212:215], v[160:163], v[48:51]
    v_cvt_pk_bf16_f32 v170, v172, v173
    v_cvt_pk_bf16_f32 v171, v174, v175
    ds_read_b64_tr_b16 v[204:205], v242 offset:24576
    ds_read_b64_tr_b16 v[206:207], v242 offset:28672
    v_mfma_f32_16x16x32_bf16 v[20:23], v[216:219], v[144:147], v[20:23]
    v_fma_f32 v176, v176, s56, -v234
    v_fma_f32 v177, v177, s56, -v234
    v_mfma_f32_16x16x32_bf16 v[52:55], v[216:219], v[160:163], v[52:55]
    v_fma_f32 v178, v178, s56, -v234
    v_fma_f32 v179, v179, s56, -v234
    ds_read_b64_tr_b16 v[208:209], v243 offset:24576
    ds_read_b64_tr_b16 v[210:211], v243 offset:28672
    s_waitcnt lgkmcnt(10)
    v_mfma_f32_16x16x32_bf16 v[24:27], v[220:223], v[144:147], v[24:27]
    v_exp_f32 v176, v176
    v_exp_f32 v177, v177
    v_mfma_f32_16x16x32_bf16 v[56:59], v[220:223], v[160:163], v[56:59]
    v_exp_f32 v178, v178
    v_exp_f32 v179, v179
    ds_read_b64_tr_b16 v[212:213], v244 offset:24576
    ds_read_b64_tr_b16 v[214:215], v244 offset:28672
    v_mfma_f32_16x16x32_bf16 v[28:31], v[224:227], v[144:147], v[28:31]
    v_cvt_pk_bf16_f32 v176, v176, v177
    v_cvt_pk_bf16_f32 v177, v178, v179
    v_mfma_f32_16x16x32_bf16 v[60:63], v[224:227], v[160:163], v[60:63]
    ds_read_b64_tr_b16 v[216:217], v245 offset:24576
    ds_read_b64_tr_b16 v[218:219], v245 offset:28672
    v_mfma_f32_16x16x32_bf16 v[180:183], v[192:195], v[152:155], v[180:183]
    v_mfma_f32_16x16x32_bf16 v[184:187], v[192:195], v[168:171], v[184:187]
    v_mfma_f32_16x16x16_bf16 v[188:191], v[192:193], v[176:177], v[188:191]
    s_waitcnt lgkmcnt(10)
    v_mfma_f32_16x16x32_bf16 v[0:3], v[228:231], v[152:155], v[0:3]
    v_mfma_f32_16x16x32_bf16 v[32:35], v[228:231], v[168:171], v[32:35]
    ds_read_b64_tr_b16 v[220:221], v246 offset:24576
    ds_read_b64_tr_b16 v[222:223], v246 offset:28672
    v_mfma_f32_16x16x32_bf16 v[4:7], v[196:199], v[152:155], v[4:7]
    v_mfma_f32_16x16x32_bf16 v[36:39], v[196:199], v[168:171], v[36:39]
    v_add_u32 v224, s70, v239
    ds_read_b64_tr_b16 v[224:225], v224 offset:16384
    v_add_u32 v226, s70, v240
    ds_read_b64_tr_b16 v[226:227], v226 offset:16384
    s_waitcnt lgkmcnt(10)
    v_mfma_f32_16x16x32_bf16 v[8:11], v[200:203], v[152:155], v[8:11]
    v_mfma_f32_16x16x32_bf16 v[40:43], v[200:203], v[168:171], v[40:43]
    v_add_u32 v228, s70, v241
    ds_read_b64_tr_b16 v[228:229], v228 offset:16384
    v_add_u32 v230, s70, v242
    ds_read_b64_tr_b16 v[230:231], v230 offset:16384
    v_mfma_f32_16x16x32_bf16 v[12:15], v[204:207], v[152:155], v[12:15]
    v_mfma_f32_16x16x32_bf16 v[44:47], v[204:207], v[168:171], v[44:47]
    v_add_u32 v196, s70, v243
    ds_read_b64_tr_b16 v[196:197], v196 offset:16384
    v_add_u32 v198, s70, v244
    ds_read_b64_tr_b16 v[198:199], v198 offset:16384
    s_waitcnt lgkmcnt(10)
    v_mfma_f32_16x16x32_bf16 v[16:19], v[208:211], v[152:155], v[16:19]
    v_mfma_f32_16x16x32_bf16 v[48:51], v[208:211], v[168:171], v[48:51]
    v_add_u32 v200, s70, v245
    ds_read_b64_tr_b16 v[200:201], v200 offset:16384
    v_add_u32 v202, s70, v246
    ds_read_b64_tr_b16 v[202:203], v202 offset:16384
    v_mfma_f32_16x16x32_bf16 v[20:23], v[212:215], v[152:155], v[20:23]
    v_mfma_f32_16x16x32_bf16 v[52:55], v[212:215], v[168:171], v[52:55]
    s_waitcnt lgkmcnt(8)
    v_mfma_f32_16x16x32_bf16 v[24:27], v[216:219], v[152:155], v[24:27]
    v_mfma_f32_16x16x32_bf16 v[56:59], v[216:219], v[168:171], v[56:59]
    v_mfma_f32_16x16x32_bf16 v[28:31], v[220:223], v[152:155], v[28:31]
    v_mfma_f32_16x16x32_bf16 v[60:63], v[220:223], v[168:171], v[60:63]
    s_waitcnt lgkmcnt(4)
    v_mfma_f32_16x16x16_bf16 v[64:67], v[224:225], v[176:177], v[64:67]
    v_mfma_f32_16x16x16_bf16 v[68:71], v[226:227], v[176:177], v[68:71]
    v_mfma_f32_16x16x16_bf16 v[72:75], v[228:229], v[176:177], v[72:75]
    v_mfma_f32_16x16x16_bf16 v[76:79], v[230:231], v[176:177], v[76:79]
    s_waitcnt lgkmcnt(0)
    v_mfma_f32_16x16x16_bf16 v[80:83], v[196:197], v[176:177], v[80:83]
    v_mfma_f32_16x16x16_bf16 v[84:87], v[198:199], v[176:177], v[84:87]
    v_mfma_f32_16x16x16_bf16 v[88:91], v[200:201], v[176:177], v[88:91]
    v_mfma_f32_16x16x16_bf16 v[92:95], v[202:203], v[176:177], v[92:95]
    s_barrier
    v_lshlrev_b32 v251, 4, v255
    s_lshl_b32 s58, s33, 13
    v_add_u32 v252, s58, v251
    ds_write_b128 v252, v[64:67] offset:0
    ds_write_b128 v252, v[68:71] offset:1024
    ds_write_b128 v252, v[72:75] offset:2048
    ds_write_b128 v252, v[76:79] offset:3072
    ds_write_b128 v252, v[80:83] offset:4096
    ds_write_b128 v252, v[84:87] offset:5120
    ds_write_b128 v252, v[88:91] offset:6144
    ds_write_b128 v252, v[92:95] offset:7168
    v_and_b32 v253, 15, v255
    v_lshlrev_b32 v253, 3, v253
    s_lshl_b32 s58, s33, 7
    v_add_u32 v254, s58, v253
    v_mov_b32 v236, v234
    v_mov_b32 v237, v188
    ds_write_b64 v254, v[236:237] offset:32768
    s_lshl_b32 s58, s33, 13
    v_rcp_f32 v250, v180
    s_nop 0
    v_mul_f32 v0, v0, v250
    v_mul_f32 v1, v1, v250
    v_mul_f32 v2, v2, v250
    v_mul_f32 v3, v3, v250
    v_mul_f32 v4, v4, v250
    v_mul_f32 v5, v5, v250
    v_mul_f32 v6, v6, v250
    v_mul_f32 v7, v7, v250
    v_mul_f32 v8, v8, v250
    v_mul_f32 v9, v9, v250
    v_mul_f32 v10, v10, v250
    v_mul_f32 v11, v11, v250
    v_mul_f32 v12, v12, v250
    v_mul_f32 v13, v13, v250
    v_mul_f32 v14, v14, v250
    v_mul_f32 v15, v15, v250
    v_mul_f32 v16, v16, v250
    v_mul_f32 v17, v17, v250
    v_mul_f32 v18, v18, v250
    v_mul_f32 v19, v19, v250
    v_mul_f32 v20, v20, v250
    v_mul_f32 v21, v21, v250
    v_mul_f32 v22, v22, v250
    v_mul_f32 v23, v23, v250
    v_mul_f32 v24, v24, v250
    v_mul_f32 v25, v25, v250
    v_mul_f32 v26, v26, v250
    v_mul_f32 v27, v27, v250
    v_mul_f32 v28, v28, v250
    v_mul_f32 v29, v29, v250
    v_mul_f32 v30, v30, v250
    v_mul_f32 v31, v31, v250
    v_cvt_pk_bf16_f32 v96, v0, v1
    v_cvt_pk_bf16_f32 v97, v2, v3
    v_cvt_pk_bf16_f32 v98, v4, v5
    v_cvt_pk_bf16_f32 v99, v6, v7
    buffer_store_dwordx4 v[96:99], v251, s[52:55], s58 offen offset:0 sc1
    v_cvt_pk_bf16_f32 v100, v8, v9
    v_cvt_pk_bf16_f32 v101, v10, v11
    v_cvt_pk_bf16_f32 v102, v12, v13
    v_cvt_pk_bf16_f32 v103, v14, v15
    buffer_store_dwordx4 v[100:103], v251, s[52:55], s58 offen offset:1024 sc1
    v_cvt_pk_bf16_f32 v104, v16, v17
    v_cvt_pk_bf16_f32 v105, v18, v19
    v_cvt_pk_bf16_f32 v106, v20, v21
    v_cvt_pk_bf16_f32 v107, v22, v23
    buffer_store_dwordx4 v[104:107], v251, s[52:55], s58 offen offset:2048 sc1
    v_cvt_pk_bf16_f32 v108, v24, v25
    v_cvt_pk_bf16_f32 v109, v26, v27
    v_cvt_pk_bf16_f32 v110, v28, v29
    v_cvt_pk_bf16_f32 v111, v30, v31
    buffer_store_dwordx4 v[108:111], v251, s[52:55], s58 offen offset:3072 sc1
    s_add_u32 s58, s58, 4096
    v_rcp_f32 v250, v184
    s_nop 0
    v_mul_f32 v32, v32, v250
    v_mul_f32 v33, v33, v250
    v_mul_f32 v34, v34, v250
    v_mul_f32 v35, v35, v250
    v_mul_f32 v36, v36, v250
    v_mul_f32 v37, v37, v250
    v_mul_f32 v38, v38, v250
    v_mul_f32 v39, v39, v250
    v_mul_f32 v40, v40, v250
    v_mul_f32 v41, v41, v250
    v_mul_f32 v42, v42, v250
    v_mul_f32 v43, v43, v250
    v_mul_f32 v44, v44, v250
    v_mul_f32 v45, v45, v250
    v_mul_f32 v46, v46, v250
    v_mul_f32 v47, v47, v250
    v_mul_f32 v48, v48, v250
    v_mul_f32 v49, v49, v250
    v_mul_f32 v50, v50, v250
    v_mul_f32 v51, v51, v250
    v_mul_f32 v52, v52, v250
    v_mul_f32 v53, v53, v250
    v_mul_f32 v54, v54, v250
    v_mul_f32 v55, v55, v250
    v_mul_f32 v56, v56, v250
    v_mul_f32 v57, v57, v250
    v_mul_f32 v58, v58, v250
    v_mul_f32 v59, v59, v250
    v_mul_f32 v60, v60, v250
    v_mul_f32 v61, v61, v250
    v_mul_f32 v62, v62, v250
    v_mul_f32 v63, v63, v250
    v_cvt_pk_bf16_f32 v112, v32, v33
    v_cvt_pk_bf16_f32 v113, v34, v35
    v_cvt_pk_bf16_f32 v114, v36, v37
    v_cvt_pk_bf16_f32 v115, v38, v39
    buffer_store_dwordx4 v[112:115], v251, s[52:55], s58 offen offset:0 sc1
    v_cvt_pk_bf16_f32 v116, v40, v41
    v_cvt_pk_bf16_f32 v117, v42, v43
    v_cvt_pk_bf16_f32 v118, v44, v45
    v_cvt_pk_bf16_f32 v119, v46, v47
    buffer_store_dwordx4 v[116:119], v251, s[52:55], s58 offen offset:1024 sc1
    v_cvt_pk_bf16_f32 v120, v48, v49
    v_cvt_pk_bf16_f32 v121, v50, v51
    v_cvt_pk_bf16_f32 v122, v52, v53
    v_cvt_pk_bf16_f32 v123, v54, v55
    buffer_store_dwordx4 v[120:123], v251, s[52:55], s58 offen offset:2048 sc1
    v_cvt_pk_bf16_f32 v124, v56, v57
    v_cvt_pk_bf16_f32 v125, v58, v59
    v_cvt_pk_bf16_f32 v126, v60, v61
    v_cvt_pk_bf16_f32 v127, v62, v63
    buffer_store_dwordx4 v[124:127], v251, s[52:55], s58 offen offset:3072 sc1
    s_waitcnt lgkmcnt(0)
    s_barrier
    ds_read_b64 v[144:145], v253 offset:32768
    ds_read_b64 v[146:147], v253 offset:32896
    ds_read_b64 v[148:149], v253 offset:33024
    ds_read_b64 v[150:151], v253 offset:33152
    s_lshl_b32 s58, s33, 11
    v_add_u32 v252, s58, v251
    ds_read_b128 v[196:199], v252 offset:0
    ds_read_b128 v[200:203], v252 offset:1024
    ds_read_b128 v[204:207], v252 offset:8192
    ds_read_b128 v[208:211], v252 offset:9216
    ds_read_b128 v[212:215], v252 offset:16384
    ds_read_b128 v[216:219], v252 offset:17408
    ds_read_b128 v[220:223], v252 offset:24576
    ds_read_b128 v[224:227], v252 offset:25600
    s_waitcnt lgkmcnt(0)
    v_max3_f32 v250, v144, v146, v148
    v_max_f32 v250, v250, v150
    v_sub_f32 v144, v144, v250
    v_exp_f32 v144, v144
    v_sub_f32 v146, v146, v250
    v_exp_f32 v146, v146
    v_sub_f32 v148, v148, v250
    v_exp_f32 v148, v148
    v_sub_f32 v150, v150, v250
    v_exp_f32 v150, v150
    v_mul_f32 v254, v144, v145
    v_fma_f32 v254, v146, v147, v254
    v_fma_f32 v254, v148, v149, v254
    v_fma_f32 v254, v150, v151, v254
    v_rcp_f32 v254, v254
    s_nop 0
    v_mul_f32 v144, v144, v254
    v_mul_f32 v146, v146, v254
    v_mul_f32 v148, v148, v254
    v_mul_f32 v150, v150, v254
    v_mul_f32 v0, v196, v144
    v_fma_f32 v0, v204, v146, v0
    v_fma_f32 v0, v212, v148, v0
    v_fma_f32 v0, v220, v150, v0
    v_mul_f32 v1, v197, v144
    v_fma_f32 v1, v205, v146, v1
    v_fma_f32 v1, v213, v148, v1
    v_fma_f32 v1, v221, v150, v1
    v_mul_f32 v2, v198, v144
    v_fma_f32 v2, v206, v146, v2
    v_fma_f32 v2, v214, v148, v2
    v_fma_f32 v2, v222, v150, v2
    v_mul_f32 v3, v199, v144
    v_fma_f32 v3, v207, v146, v3
    v_fma_f32 v3, v215, v148, v3
    v_fma_f32 v3, v223, v150, v3
    v_mul_f32 v4, v200, v144
    v_fma_f32 v4, v208, v146, v4
    v_fma_f32 v4, v216, v148, v4
    v_fma_f32 v4, v224, v150, v4
    v_mul_f32 v5, v201, v144
    v_fma_f32 v5, v209, v146, v5
    v_fma_f32 v5, v217, v148, v5
    v_fma_f32 v5, v225, v150, v5
    v_mul_f32 v6, v202, v144
    v_fma_f32 v6, v210, v146, v6
    v_fma_f32 v6, v218, v148, v6
    v_fma_f32 v6, v226, v150, v6
    v_mul_f32 v7, v203, v144
    v_fma_f32 v7, v211, v146, v7
    v_fma_f32 v7, v219, v148, v7
    v_fma_f32 v7, v227, v150, v7
    s_lshl_b32 s58, s33, 10
    s_add_u32 s58, s58, 32768
    v_cvt_pk_bf16_f32 v128, v0, v1
    v_cvt_pk_bf16_f32 v129, v2, v3
    v_cvt_pk_bf16_f32 v130, v4, v5
    v_cvt_pk_bf16_f32 v131, v6, v7
    buffer_store_dwordx4 v[128:131], v251, s[52:55], s58 offen sc1
    s_nop 1
L1_done:
    s_endpgm
.globl oproj_kernel
.p2align 8
.type oproj_kernel,@function
oproj_kernel:
    s_cmp_ge_u32 s2, 256
    s_cbranch_scc1 L2_done
    s_load_dwordx16 s[4:19], s[0:1], 0
    s_load_dwordx8 s[20:27], s[0:1], 64
    s_load_dwordx2 s[28:29], s[0:1], 96
    s_and_b32 s35, s2, 7
    s_lshr_b32 s30, s35, 2
    s_and_b32 s31, s35, 3
    s_lshr_b32 s35, s2, 3
    s_lshr_b32 s32, s35, 2
    s_and_b32 s33, s35, 3
    v_and_b32 v254, 63, v0
    v_lshrrev_b32 v238, 6, v0
    s_nop 0
    v_readfirstlane_b32 s40, v238
    s_and_b32 s34, s40, 3
    s_lshr_b32 s39, s40, 2
    s_waitcnt lgkmcnt(0)
    s_cmp_eq_u32 s30, 0
    s_cselect_b64 s[12:13], s[12:13], s[22:23]
    s_lshl_b32 s35, s31, 1
    s_add_u32 s38, s35, s39
    s_lshl_b32 s35, s38, 19
    s_lshl_b32 s36, s33, 8
    s_add_u32 s35, s35, s36
    s_sub_u32 s37, 524288, s36
    s_add_u32 s44, s12, s35
    s_addc_u32 s45, s13, 0
    s_and_b32 s45, s45, 0xffff
    s_mov_b32 s46, s37
    s_mov_b32 s47, 0x00020000
    s_mul_i32 s35, s30, 9437184
    s_lshl_b32 s36, s32, 3
    s_add_u32 s36, s36, s38
    s_mul_i32 s36, s36, 147456
    s_add_u32 s35, s35, s36
    s_add_u32 s48, s28, s35
    s_addc_u32 s49, s29, 0
    s_and_b32 s49, s49, 0xffff
    s_mov_b32 s50, 147456
    s_mov_b32 s51, 0x00020000
    s_lshl_b32 s68, s33, 1
    s_add_u32 s68, s68, s32
    s_lshl_b32 s68, s68, 1
    s_lshl_b32 s41, s30, 5
    s_lshl_b32 s35, s32, 2
    s_add_u32 s41, s41, s35
    s_add_u32 s41, s41, s33
    s_lshl_b32 s35, s41, 2
    s_add_u32 s35, s35, s31
    s_mul_i32 s35, s35, 40960
    s_mul_i32 s36, s40, 5120
    s_add_u32 s35, s35, s36
    s_add_u32 s35, s35, 18874368
    s_add_u32 s52, s28, s35
    s_addc_u32 s53, s29, 0
    s_and_b32 s53, s53, 0xffff
    s_mov_b32 s54, 5120
    s_mov_b32 s55, 0x00020000
    s_lshl_b32 s69, s39, 16
    v_lshrrev_b32 v238, 4, v254
    v_and_b32 v239, 15, v254
    v_mov_b32 v240, v238
    v_lshrrev_b32 v241, 1, v239
    v_xor_b32 v240, v240, v241
    v_lshlrev_b32 v240, 5, v240
    v_and_b32 v241, 1, v254
    v_lshl_add_u32 v240, v241, 4, v240
    v_mul_u32_u24 v241, 1024, v238
    v_add_u32 v80, v240, v241
    v_xor_b32 v81, 0x80, v80
    v_lshlrev_b32 v82, 4, v254
    v_lshrrev_b32 v241, 2, v254
    v_and_b32 v240, 7, v241
    s_lshl_b32 s64, s34, 1
    v_xor_b32 v240, s64, v240
    v_lshlrev_b32 v240, 5, v240
    v_lshl_add_u32 v240, v241, 8, v240
    v_and_b32 v241, 3, v254
    v_lshl_add_u32 v72, v241, 3, v240
    v_add_u32 v72, s69, v72
    v_xor_b32 v73, 32, v72
    v_xor_b32 v74, 64, v72
    v_xor_b32 v75, 96, v72
    v_xor_b32 v76, 128, v72
    v_xor_b32 v77, 160, v72
    v_xor_b32 v78, 192, v72
    v_xor_b32 v79, 224, v72
    s_lshl_b32 s60, s34, 13
    s_mul_i32 s62, s34, 8192
    s_lshl_b32 s63, s34, 11
    s_add_u32 s63, s63, s69
    s_lshl_b32 s67, s34, 10
    s_add_u32 s65, s68, 0
    s_and_b32 s65, s65, 15
    s_mul_i32 s64, s65, 32768
    s_add_u32 s64, s64, s62
    s_add_u32 m0, s63, 0
    s_nop 0
    buffer_load_dwordx4 v80, s[44:47], s64 offen lds
    s_add_u32 m0, s63, 1024
    s_add_u32 s64, s64, 4096
    buffer_load_dwordx4 v81, s[44:47], s64 offen lds
    s_add_u32 s65, s68, 0
    s_and_b32 s65, s65, 15
    s_lshr_b32 s66, s65, 2
    s_mul_i32 s66, s66, 36864
    s_and_b32 s64, s65, 3
    s_lshl_b32 s64, s64, 10
    s_add_u32 s66, s66, s64
    s_add_u32 s64, s66, s60
    buffer_load_dwordx4 v[88:91], v82, s[48:51], s64 offen
    s_add_u32 s64, s64, 4096
    buffer_load_dwordx4 v[92:95], v82, s[48:51], s64 offen
    s_add_u32 s64, s66, 32768
    buffer_load_dwordx4 v[96:99], v82, s[48:51], s64 offen
    s_add_u32 s65, s68, 1
    s_and_b32 s65, s65, 15
    s_mul_i32 s64, s65, 32768
    s_add_u32 s64, s64, s62
    s_add_u32 m0, s63, 8192
    s_nop 0
    buffer_load_dwordx4 v80, s[44:47], s64 offen lds
    s_add_u32 m0, s63, 9216
    s_add_u32 s64, s64, 4096
    buffer_load_dwordx4 v81, s[44:47], s64 offen lds
    s_add_u32 s65, s68, 1
    s_and_b32 s65, s65, 15
    s_lshr_b32 s66, s65, 2
    s_mul_i32 s66, s66, 36864
    s_and_b32 s64, s65, 3
    s_lshl_b32 s64, s64, 10
    s_add_u32 s66, s66, s64
    s_add_u32 s64, s66, s60
    buffer_load_dwordx4 v[100:103], v82, s[48:51], s64 offen
    s_add_u32 s64, s64, 4096
    buffer_load_dwordx4 v[104:107], v82, s[48:51], s64 offen
    s_add_u32 s64, s66, 32768
    buffer_load_dwordx4 v[108:111], v82, s[48:51], s64 offen
    s_waitcnt vmcnt(8)
    s_barrier
    s_add_u32 s65, s68, 2
    s_and_b32 s65, s65, 15
    s_mul_i32 s64, s65, 32768
    s_add_u32 s64, s64, s62
    s_add_u32 m0, s63, 16384
    s_nop 0
    buffer_load_dwordx4 v80, s[44:47], s64 offen lds
    s_add_u32 m0, s63, 17408
    s_add_u32 s64, s64, 4096
    buffer_load_dwordx4 v81, s[44:47], s64 offen lds
    s_add_u32 s65, s68, 3
    s_and_b32 s65, s65, 15
    s_mul_i32 s64, s65, 32768
    s_add_u32 s64, s64, s62
    s_add_u32 m0, s63, 24576
    s_nop 0
    buffer_load_dwordx4 v80, s[44:47], s64 offen lds
    s_add_u32 m0, s63, 25600
    s_add_u32 s64, s64, 4096
    buffer_load_dwordx4 v81, s[44:47], s64 offen lds
    s_add_u32 s65, s68, 2
    s_and_b32 s65, s65, 15
    s_lshr_b32 s66, s65, 2
    s_mul_i32 s66, s66, 36864
    s_and_b32 s64, s65, 3
    s_lshl_b32 s64, s64, 10
    s_add_u32 s66, s66, s64
    s_add_u32 s64, s66, s60
    buffer_load_dwordx4 v[112:115], v82, s[48:51], s64 offen
    s_add_u32 s64, s64, 4096
    buffer_load_dwordx4 v[116:119], v82, s[48:51], s64 offen
    s_add_u32 s64, s66, 32768
    buffer_load_dwordx4 v[120:123], v82, s[48:51], s64 offen
    s_add_u32 s65, s68, 3
    s_and_b32 s65, s65, 15
    s_lshr_b32 s66, s65, 2
    s_mul_i32 s66, s66, 36864
    s_and_b32 s64, s65, 3
    s_lshl_b32 s64, s64, 10
    s_add_u32 s66, s66, s64
    s_add_u32 s64, s66, s60
    buffer_load_dwordx4 v[124:127], v82, s[48:51], s64 offen
    s_add_u32 s64, s64, 4096
    buffer_load_dwordx4 v[128:131], v82, s[48:51], s64 offen
    s_add_u32 s64, s66, 32768
    buffer_load_dwordx4 v[132:135], v82, s[48:51], s64 offen
    ds_read_b64_tr_b16 v[172:173], v72 offset:0
    ds_read_b64_tr_b16 v[174:175], v72 offset:4096
    ds_read_b64_tr_b16 v[176:177], v73 offset:0
    ds_read_b64_tr_b16 v[178:179], v73 offset:4096
    ds_read_b64_tr_b16 v[180:181], v74 offset:0
    ds_read_b64_tr_b16 v[182:183], v74 offset:4096
    ds_read_b64_tr_b16 v[184:185], v75 offset:0
    ds_read_b64_tr_b16 v[186:187], v75 offset:4096
    ds_read_b64_tr_b16 v[188:189], v76 offset:0
    ds_read_b64_tr_b16 v[190:191], v76 offset:4096
    ds_read_b64_tr_b16 v[192:193], v77 offset:0
    ds_read_b64_tr_b16 v[194:195], v77 offset:4096
    ds_read_b64_tr_b16 v[196:197], v78 offset:0
    ds_read_b64_tr_b16 v[198:199], v78 offset:4096
    ds_read_b64_tr_b16 v[200:201], v79 offset:0
    ds_read_b64_tr_b16 v[202:203], v79 offset:4096
    s_waitcnt vmcnt(13) lgkmcnt(0)
    s_barrier
    s_add_u32 s65, s68, 4
    s_and_b32 s65, s65, 15
    s_mul_i32 s64, s65, 32768
    s_add_u32 s64, s64, s62
    s_add_u32 m0, s63, 32768
    s_nop 0
    buffer_load_dwordx4 v80, s[44:47], s64 offen lds
    s_add_u32 m0, s63, 33792
    s_add_u32 s64, s64, 4096
    buffer_load_dwordx4 v81, s[44:47], s64 offen lds
    s_add_u32 s65, s68, 5
    s_and_b32 s65, s65, 15
    s_mul_i32 s64, s65, 32768
    s_add_u32 s64, s64, s62
    s_add_u32 m0, s63, 40960
    s_nop 0
    buffer_load_dwordx4 v80, s[44:47], s64 offen lds
    s_add_u32 m0, s63, 41984
    s_add_u32 s64, s64, 4096
    buffer_load_dwordx4 v81, s[44:47], s64 offen lds
    s_add_u32 s65, s68, 4
    s_and_b32 s65, s65, 15
    s_lshr_b32 s66, s65, 2
    s_mul_i32 s66, s66, 36864
    s_and_b32 s64, s65, 3
    s_lshl_b32 s64, s64, 10
    s_add_u32 s66, s66, s64
    s_add_u32 s64, s66, s60
    buffer_load_dwordx4 v[136:139], v82, s[48:51], s64 offen
    s_add_u32 s64, s64, 4096
    buffer_load_dwordx4 v[140:143], v82, s[48:51], s64 offen
    s_add_u32 s64, s66, 32768
    buffer_load_dwordx4 v[144:147], v82, s[48:51], s64 offen
    s_add_u32 s65, s68, 5
    s_and_b32 s65, s65, 15
    s_lshr_b32 s66, s65, 2
    s_mul_i32 s66, s66, 36864
    s_and_b32 s64, s65, 3
    s_lshl_b32 s64, s64, 10
    s_add_u32 s66, s66, s64
    s_add_u32 s64, s66, s60
    buffer_load_dwordx4 v[148:151], v82, s[48:51], s64 offen
    s_add_u32 s64, s64, 4096
    buffer_load_dwordx4 v[152:155], v82, s[48:51], s64 offen
    s_add_u32 s64, s66, 32768
    buffer_load_dwordx4 v[156:159], v82, s[48:51], s64 offen
    ds_read_b64_tr_b16 v[204:205], v72 offset:8192
    ds_read_b64_tr_b16 v[206:207], v72 offset:12288
    v_mfma_f32_16x16x32_bf16 v[0:3], v[172:175], v[88:91], 0
    v_mfma_f32_16x16x32_bf16 v[32:35], v[172:175], v[92:95], 0
    v_mfma_f32_16x16x32_bf16 v[64:67], v[172:175], v[96:99], 0
    ds_read_b64_tr_b16 v[208:209], v73 offset:8192
    ds_read_b64_tr_b16 v[210:211], v73 offset:12288
    v_mfma_f32_16x16x32_bf16 v[4:7], v[176:179], v[88:91], 0
    v_mfma_f32_16x16x32_bf16 v[36:39], v[176:179], v[92:95], 0
    v_mfma_f32_16x16x32_bf16 v[68:71], v[176:179], v[96:99], 0
    ds_read_b64_tr_b16 v[212:213], v74 offset:8192
    ds_read_b64_tr_b16 v[214:215], v74 offset:12288
    v_mfma_f32_16x16x32_bf16 v[8:11], v[180:183], v[88:91], 0
    v_mfma_f32_16x16x32_bf16 v[40:43], v[180:183], v[92:95], 0
    ds_read_b64_tr_b16 v[216:217], v75 offset:8192
    ds_read_b64_tr_b16 v[218:219], v75 offset:12288
    v_mfma_f32_16x16x32_bf16 v[12:15], v[184:187], v[88:91], 0
    v_mfma_f32_16x16x32_bf16 v[44:47], v[184:187], v[92:95], 0
    ds_read_b64_tr_b16 v[220:221], v76 offset:8192
    ds_read_b64_tr_b16 v[222:223], v76 offset:12288
    v_mfma_f32_16x16x32_bf16 v[16:19], v[188:191], v[88:91], 0
    v_mfma_f32_16x16x32_bf16 v[48:51], v[188:191], v[92:95], 0
    ds_read_b64_tr_b16 v[224:225], v77 offset:8192
    ds_read_b64_tr_b16 v[226:227], v77 offset:12288
    v_mfma_f32_16x16x32_bf16 v[20:23], v[192:195], v[88:91], 0
    v_mfma_f32_16x16x32_bf16 v[52:55], v[192:195], v[92:95], 0
    ds_read_b64_tr_b16 v[228:229], v78 offset:8192
    ds_read_b64_tr_b16 v[230:231], v78 offset:12288
    v_mfma_f32_16x16x32_bf16 v[24:27], v[196:199], v[88:91], 0
    v_mfma_f32_16x16x32_bf16 v[56:59], v[196:199], v[92:95], 0
    ds_read_b64_tr_b16 v[232:233], v79 offset:8192
    ds_read_b64_tr_b16 v[234:235], v79 offset:12288
    v_mfma_f32_16x16x32_bf16 v[28:31], v[200:203], v[88:91], 0
    v_mfma_f32_16x16x32_bf16 v[60:63], v[200:203], v[92:95], 0
    s_waitcnt vmcnt(18) lgkmcnt(0)
    s_barrier
    s_add_u32 s65, s68, 6
    s_and_b32 s65, s65, 15
    s_mul_i32 s64, s65, 32768
    s_add_u32 s64, s64, s62
    s_add_u32 m0, s63, 49152
    s_nop 0
    buffer_load_dwordx4 v80, s[44:47], s64 offen lds
    s_add_u32 m0, s63, 50176
    s_add_u32 s64, s64, 4096
    buffer_load_dwordx4 v81, s[44:47], s64 offen lds
    s_add_u32 s65, s68, 7
    s_and_b32 s65, s65, 15
    s_mul_i32 s64, s65, 32768
    s_add_u32 s64, s64, s62
    s_add_u32 m0, s63, 57344
    s_nop 0
    buffer_load_dwordx4 v80, s[44:47], s64 offen lds
    s_add_u32 m0, s63, 58368
    s_add_u32 s64, s64, 4096
    buffer_load_dwordx4 v81, s[44:47], s64 offen lds
    s_add_u32 s65, s68, 6
    s_and_b32 s65, s65, 15
    s_lshr_b32 s66, s65, 2
    s_mul_i32 s66, s66, 36864
    s_and_b32 s64, s65, 3
    s_lshl_b32 s64, s64, 10
    s_add_u32 s66, s66, s64
    s_add_u32 s64, s66, s60
    buffer_load_dwordx4 v[160:163], v82, s[48:51], s64 offen
    s_add_u32 s64, s64, 4096
    buffer_load_dwordx4 v[164:167], v82, s[48:51], s64 offen
    s_add_u32 s64, s66, 32768
    buffer_load_dwordx4 v[168:171], v82, s[48:51], s64 offen
    s_add_u32 s65, s68, 7
    s_and_b32 s65, s65, 15
    s_lshr_b32 s66, s65, 2
    s_mul_i32 s66, s66, 36864
    s_and_b32 s64, s65, 3
    s_lshl_b32 s64, s64, 10
    s_add_u32 s66, s66, s64
    s_add_u32 s64, s66, s60
    buffer_load_dwordx4 v[88:91], v82, s[48:51], s64 offen
    s_add_u32 s64, s64, 4096
    buffer_load_dwordx4 v[92:95], v82, s[48:51], s64 offen
    s_add_u32 s64, s66, 32768
    buffer_load_dwordx4 v[96:99], v82, s[48:51], s64 offen
    ds_read_b64_tr_b16 v[172:173], v72 offset:16384
    ds_read_b64_tr_b16 v[174:175], v72 offset:20480
    v_mfma_f32_16x16x32_bf16 v[0:3], v[204:207], v[100:103], v[0:3]
    v_mfma_f32_16x16x32_bf16 v[32:35], v[204:207], v[104:107], v[32:35]
    v_mfma_f32_16x16x32_bf16 v[64:67], v[204:207], v[108:111], v[64:67]
    ds_read_b64_tr_b16 v[176:177], v73 offset:16384
    ds_read_b64_tr_b16 v[178:179], v73 offset:20480
    v_mfma_f32_16x16x32_bf16 v[4:7], v[208:211], v[100:103], v[4:7]
    v_mfma_f32_16x16x32_bf16 v[36:39], v[208:211], v[104:107], v[36:39]
    v_mfma_f32_16x16x32_bf16 v[68:71], v[208:211], v[108:111], v[68:71]
    ds_read_b64_tr_b16 v[180:181], v74 offset:16384
    ds_read_b64_tr_b16 v[182:183], v74 offset:20480
    v_mfma_f32_16x16x32_bf16 v[8:11], v[212:215], v[100:103], v[8:11]
    v_mfma_f32_16x16x32_bf16 v[40:43], v[212:215], v[104:107], v[40:43]
    ds_read_b64_tr_b16 v[184:185], v75 offset:16384
    ds_read_b64_tr_b16 v[186:187], v75 offset:20480
    v_mfma_f32_16x16x32_bf16 v[12:15], v[216:219], v[100:103], v[12:15]
    v_mfma_f32_16x16x32_bf16 v[44:47], v[216:219], v[104:107], v[44:47]
    ds_read_b64_tr_b16 v[188:189], v76 offset:16384
    ds_read_b64_tr_b16 v[190:191], v76 offset:20480
    v_mfma_f32_16x16x32_bf16 v[16:19], v[220:223], v[100:103], v[16:19]
    v_mfma_f32_16x16x32_bf16 v[48:51], v[220:223], v[104:107], v[48:51]
    ds_read_b64_tr_b16 v[192:193], v77 offset:16384
    ds_read_b64_tr_b16 v[194:195], v77 offset:20480
    v_mfma_f32_16x16x32_bf16 v[20:23], v[224:227], v[100:103], v[20:23]
    v_mfma_f32_16x16x32_bf16 v[52:55], v[224:227], v[104:107], v[52:55]
    ds_read_b64_tr_b16 v[196:197], v78 offset:16384
    ds_read_b64_tr_b16 v[198:199], v78 offset:20480
    v_mfma_f32_16x16x32_bf16 v[24:27], v[228:231], v[100:103], v[24:27]
    v_mfma_f32_16x16x32_bf16 v[56:59], v[228:231], v[104:107], v[56:59]
    ds_read_b64_tr_b16 v[200:201], v79 offset:16384
    ds_read_b64_tr_b16 v[202:203], v79 offset:20480
    v_mfma_f32_16x16x32_bf16 v[28:31], v[232:235], v[100:103], v[28:31]
    v_mfma_f32_16x16x32_bf16 v[60:63], v[232:235], v[104:107], v[60:63]
    s_waitcnt vmcnt(23) lgkmcnt(0)
    s_barrier
    s_add_u32 s65, s68, 8
    s_and_b32 s65, s65, 15
    s_mul_i32 s64, s65, 32768
    s_add_u32 s64, s64, s62
    s_add_u32 m0, s63, 0
    s_nop 0
    buffer_load_dwordx4 v80, s[44:47], s64 offen lds
    s_add_u32 m0, s63, 1024
    s_add_u32 s64, s64, 4096
    buffer_load_dwordx4 v81, s[44:47], s64 offen lds
    s_add_u32 s65, s68, 9
    s_and_b32 s65, s65, 15
    s_mul_i32 s64, s65, 32768
    s_add_u32 s64, s64, s62
    s_add_u32 m0, s63, 8192
    s_nop 0
    buffer_load_dwordx4 v80, s[44:47], s64 offen lds
    s_add_u32 m0, s63, 9216
    s_add_u32 s64, s64, 4096
    buffer_load_dwordx4 v81, s[44:47], s64 offen lds
    s_add_u32 s65, s68, 8
    s_and_b32 s65, s65, 15
    s_lshr_b32 s66, s65, 2
    s_mul_i32 s66, s66, 36864
    s_and_b32 s64, s65, 3
    s_lshl_b32 s64, s64, 10
    s_add_u32 s66, s66, s64
    s_add_u32 s64, s66, s60
    buffer_load_dwordx4 v[100:103], v82, s[48:51], s64 offen
    s_add_u32 s64, s64, 4096
    buffer_load_dwordx4 v[104:107], v82, s[48:51], s64 offen
    s_add_u32 s64, s66, 32768
    buffer_load_dwordx4 v[108:111], v82, s[48:51], s64 offen
    ds_read_b64_tr_b16 v[204:205], v72 offset:24576
    ds_read_b64_tr_b16 v[206:207], v72 offset:28672
    v_mfma_f32_16x16x32_bf16 v[0:3], v[172:175], v[112:115], v[0:3]
    v_mfma_f32_16x16x32_bf16 v[32:35], v[172:175], v[116:119], v[32:35]
    v_mfma_f32_16x16x32_bf16 v[64:67], v[172:175], v[120:123], v[64:67]
    ds_read_b64_tr_b16 v[208:209], v73 offset:24576
    ds_read_b64_tr_b16 v[210:211], v73 offset:28672
    v_mfma_f32_16x16x32_bf16 v[4:7], v[176:179], v[112:115], v[4:7]
    v_mfma_f32_16x16x32_bf16 v[36:39], v[176:179], v[116:119], v[36:39]
    v_mfma_f32_16x16x32_bf16 v[68:71], v[176:179], v[120:123], v[68:71]
    ds_read_b64_tr_b16 v[212:213], v74 offset:24576
    ds_read_b64_tr_b16 v[214:215], v74 offset:28672
    v_mfma_f32_16x16x32_bf16 v[8:11], v[180:183], v[112:115], v[8:11]
    v_mfma_f32_16x16x32_bf16 v[40:43], v[180:183], v[116:119], v[40:43]
    ds_read_b64_tr_b16 v[216:217], v75 offset:24576
    ds_read_b64_tr_b16 v[218:219], v75 offset:28672
    v_mfma_f32_16x16x32_bf16 v[12:15], v[184:187], v[112:115], v[12:15]
    v_mfma_f32_16x16x32_bf16 v[44:47], v[184:187], v[116:119], v[44:47]
    ds_read_b64_tr_b16 v[220:221], v76 offset:24576
    ds_read_b64_tr_b16 v[222:223], v76 offset:28672
    v_mfma_f32_16x16x32_bf16 v[16:19], v[188:191], v[112:115], v[16:19]
    v_mfma_f32_16x16x32_bf16 v[48:51], v[188:191], v[116:119], v[48:51]
    ds_read_b64_tr_b16 v[224:225], v77 offset:24576
    ds_read_b64_tr_b16 v[226:227], v77 offset:28672
    v_mfma_f32_16x16x32_bf16 v[20:23], v[192:195], v[112:115], v[20:23]
    v_mfma_f32_16x16x32_bf16 v[52:55], v[192:195], v[116:119], v[52:55]
    ds_read_b64_tr_b16 v[228:229], v78 offset:24576
    ds_read_b64_tr_b16 v[230:231], v78 offset:28672
    v_mfma_f32_16x16x32_bf16 v[24:27], v[196:199], v[112:115], v[24:27]
    v_mfma_f32_16x16x32_bf16 v[56:59], v[196:199], v[116:119], v[56:59]
    ds_read_b64_tr_b16 v[232:233], v79 offset:24576
    ds_read_b64_tr_b16 v[234:235], v79 offset:28672
    v_mfma_f32_16x16x32_bf16 v[28:31], v[200:203], v[112:115], v[28:31]
    v_mfma_f32_16x16x32_bf16 v[60:63], v[200:203], v[116:119], v[60:63]
    s_waitcnt vmcnt(25) lgkmcnt(0)
    s_barrier
    s_add_u32 s65, s68, 10
    s_and_b32 s65, s65, 15
    s_mul_i32 s64, s65, 32768
    s_add_u32 s64, s64, s62
    s_add_u32 m0, s63, 16384
    s_nop 0
    buffer_load_dwordx4 v80, s[44:47], s64 offen lds
    s_add_u32 m0, s63, 17408
    s_add_u32 s64, s64, 4096
    buffer_load_dwordx4 v81, s[44:47], s64 offen lds
    s_add_u32 s65, s68, 11
    s_and_b32 s65, s65, 15
    s_mul_i32 s64, s65, 32768
    s_add_u32 s64, s64, s62
    s_add_u32 m0, s63, 24576
    s_nop 0
    buffer_load_dwordx4 v80, s[44:47], s64 offen lds
    s_add_u32 m0, s63, 25600
    s_add_u32 s64, s64, 4096
    buffer_load_dwordx4 v81, s[44:47], s64 offen lds
    s_add_u32 s65, s68, 9
    s_and_b32 s65, s65, 15
    s_lshr_b32 s66, s65, 2
    s_mul_i32 s66, s66, 36864
    s_and_b32 s64, s65, 3
    s_lshl_b32 s64, s64, 10
    s_add_u32 s66, s66, s64
    s_add_u32 s64, s66, s60
    buffer_load_dwordx4 v[112:115], v82, s[48:51], s64 offen
    s_add_u32 s64, s64, 4096
    buffer_load_dwordx4 v[116:119], v82, s[48:51], s64 offen
    s_add_u32 s64, s66, 32768
    buffer_load_dwordx4 v[120:123], v82, s[48:51], s64 offen
    ds_read_b64_tr_b16 v[172:173], v72 offset:32768
    ds_read_b64_tr_b16 v[174:175], v72 offset:36864
    v_mfma_f32_16x16x32_bf16 v[0:3], v[204:207], v[124:127], v[0:3]
    v_mfma_f32_16x16x32_bf16 v[32:35], v[204:207], v[128:131], v[32:35]
    v_mfma_f32_16x16x32_bf16 v[64:67], v[204:207], v[132:135], v[64:67]
    ds_read_b64_tr_b16 v[176:177], v73 offset:32768
    ds_read_b64_tr_b16 v[178:179], v73 offset:36864
    v_mfma_f32_16x16x32_bf16 v[4:7], v[208:211], v[124:127], v[4:7]
    v_mfma_f32_16x16x32_bf16 v[36:39], v[208:211], v[128:131], v[36:39]
    v_mfma_f32_16x16x32_bf16 v[68:71], v[208:211], v[132:135], v[68:71]
    ds_read_b64_tr_b16 v[180:181], v74 offset:32768
    ds_read_b64_tr_b16 v[182:183], v74 offset:36864
    v_mfma_f32_16x16x32_bf16 v[8:11], v[212:215], v[124:127], v[8:11]
    v_mfma_f32_16x16x32_bf16 v[40:43], v[212:215], v[128:131], v[40:43]
    ds_read_b64_tr_b16 v[184:185], v75 offset:32768
    ds_read_b64_tr_b16 v[186:187], v75 offset:36864
    v_mfma_f32_16x16x32_bf16 v[12:15], v[216:219], v[124:127], v[12:15]
    v_mfma_f32_16x16x32_bf16 v[44:47], v[216:219], v[128:131], v[44:47]
    ds_read_b64_tr_b16 v[188:189], v76 offset:32768
    ds_read_b64_tr_b16 v[190:191], v76 offset:36864
    v_mfma_f32_16x16x32_bf16 v[16:19], v[220:223], v[124:127], v[16:19]
    v_mfma_f32_16x16x32_bf16 v[48:51], v[220:223], v[128:131], v[48:51]
    ds_read_b64_tr_b16 v[192:193], v77 offset:32768
    ds_read_b64_tr_b16 v[194:195], v77 offset:36864
    v_mfma_f32_16x16x32_bf16 v[20:23], v[224:227], v[124:127], v[20:23]
    v_mfma_f32_16x16x32_bf16 v[52:55], v[224:227], v[128:131], v[52:55]
    ds_read_b64_tr_b16 v[196:197], v78 offset:32768
    ds_read_b64_tr_b16 v[198:199], v78 offset:36864
    v_mfma_f32_16x16x32_bf16 v[24:27], v[228:231], v[124:127], v[24:27]
    v_mfma_f32_16x16x32_bf16 v[56:59], v[228:231], v[128:131], v[56:59]
    ds_read_b64_tr_b16 v[200:201], v79 offset:32768
    ds_read_b64_tr_b16 v[202:203], v79 offset:36864
    v_mfma_f32_16x16x32_bf16 v[28:31], v[232:235], v[124:127], v[28:31]
    v_mfma_f32_16x16x32_bf16 v[60:63], v[232:235], v[128:131], v[60:63]
    s_waitcnt vmcnt(27) lgkmcnt(0)
    s_barrier
    s_add_u32 s65, s68, 12
    s_and_b32 s65, s65, 15
    s_mul_i32 s64, s65, 32768
    s_add_u32 s64, s64, s62
    s_add_u32 m0, s63, 32768
    s_nop 0
    buffer_load_dwordx4 v80, s[44:47], s64 offen lds
    s_add_u32 m0, s63, 33792
    s_add_u32 s64, s64, 4096
    buffer_load_dwordx4 v81, s[44:47], s64 offen lds
    s_add_u32 s65, s68, 10
    s_and_b32 s65, s65, 15
    s_lshr_b32 s66, s65, 2
    s_mul_i32 s66, s66, 36864
    s_and_b32 s64, s65, 3
    s_lshl_b32 s64, s64, 10
    s_add_u32 s66, s66, s64
    s_add_u32 s64, s66, s60
    buffer_load_dwordx4 v[124:127], v82, s[48:51], s64 offen
    s_add_u32 s64, s64, 4096
    buffer_load_dwordx4 v[128:131], v82, s[48:51], s64 offen
    s_add_u32 s64, s66, 32768
    buffer_load_dwordx4 v[132:135], v82, s[48:51], s64 offen
    ds_read_b64_tr_b16 v[204:205], v72 offset:40960
    ds_read_b64_tr_b16 v[206:207], v72 offset:45056
    v_mfma_f32_16x16x32_bf16 v[0:3], v[172:175], v[136:139], v[0:3]
    v_mfma_f32_16x16x32_bf16 v[32:35], v[172:175], v[140:143], v[32:35]
    v_mfma_f32_16x16x32_bf16 v[64:67], v[172:175], v[144:147], v[64:67]
    ds_read_b64_tr_b16 v[208:209], v73 offset:40960
    ds_read_b64_tr_b16 v[210:211], v73 offset:45056
    v_mfma_f32_16x16x32_bf16 v[4:7], v[176:179], v[136:139], v[4:7]
    v_mfma_f32_16x16x32_bf16 v[36:39], v[176:179], v[140:143], v[36:39]
    v_mfma_f32_16x16x32_bf16 v[68:71], v[176:179], v[144:147], v[68:71]
    ds_read_b64_tr_b16 v[212:213], v74 offset:40960
    ds_read_b64_tr_b16 v[214:215], v74 offset:45056
    v_mfma_f32_16x16x32_bf16 v[8:11], v[180:183], v[136:139], v[8:11]
    v_mfma_f32_16x16x32_bf16 v[40:43], v[180:183], v[140:143], v[40:43]
    ds_read_b64_tr_b16 v[216:217], v75 offset:40960
    ds_read_b64_tr_b16 v[218:219], v75 offset:45056
    v_mfma_f32_16x16x32_bf16 v[12:15], v[184:187], v[136:139], v[12:15]
    v_mfma_f32_16x16x32_bf16 v[44:47], v[184:187], v[140:143], v[44:47]
    ds_read_b64_tr_b16 v[220:221], v76 offset:40960
    ds_read_b64_tr_b16 v[222:223], v76 offset:45056
    v_mfma_f32_16x16x32_bf16 v[16:19], v[188:191], v[136:139], v[16:19]
    v_mfma_f32_16x16x32_bf16 v[48:51], v[188:191], v[140:143], v[48:51]
    ds_read_b64_tr_b16 v[224:225], v77 offset:40960
    ds_read_b64_tr_b16 v[226:227], v77 offset:45056
    v_mfma_f32_16x16x32_bf16 v[20:23], v[192:195], v[136:139], v[20:23]
    v_mfma_f32_16x16x32_bf16 v[52:55], v[192:195], v[140:143], v[52:55]
    ds_read_b64_tr_b16 v[228:229], v78 offset:40960
    ds_read_b64_tr_b16 v[230:231], v78 offset:45056
    v_mfma_f32_16x16x32_bf16 v[24:27], v[196:199], v[136:139], v[24:27]
    v_mfma_f32_16x16x32_bf16 v[56:59], v[196:199], v[140:143], v[56:59]
    ds_read_b64_tr_b16 v[232:233], v79 offset:40960
    ds_read_b64_tr_b16 v[234:235], v79 offset:45056
    v_mfma_f32_16x16x32_bf16 v[28:31], v[200:203], v[136:139], v[28:31]
    v_mfma_f32_16x16x32_bf16 v[60:63], v[200:203], v[140:143], v[60:63]
    s_waitcnt vmcnt(27) lgkmcnt(0)
    s_barrier
    s_add_u32 s65, s68, 13
    s_and_b32 s65, s65, 15
    s_mul_i32 s64, s65, 32768
    s_add_u32 s64, s64, s62
    s_add_u32 m0, s63, 40960
    s_nop 0
    buffer_load_dwordx4 v80, s[44:47], s64 offen lds
    s_add_u32 m0, s63, 41984
    s_add_u32 s64, s64, 4096
    buffer_load_dwordx4 v81, s[44:47], s64 offen lds
    s_add_u32 s65, s68, 11
    s_and_b32 s65, s65, 15
    s_lshr_b32 s66, s65, 2
    s_mul_i32 s66, s66, 36864
    s_and_b32 s64, s65, 3
    s_lshl_b32 s64, s64, 10
    s_add_u32 s66, s66, s64
    s_add_u32 s64, s66, s60
    buffer_load_dwordx4 v[136:139], v82, s[48:51], s64 offen
    s_add_u32 s64, s64, 4096
    buffer_load_dwordx4 v[140:143], v82, s[48:51], s64 offen
    s_add_u32 s64, s66, 32768
    buffer_load_dwordx4 v[144:147], v82, s[48:51], s64 offen
    ds_read_b64_tr_b16 v[172:173], v72 offset:49152
    ds_read_b64_tr_b16 v[174:175], v72 offset:53248
    v_mfma_f32_16x16x32_bf16 v[0:3], v[204:207], v[148:151], v[0:3]
    v_mfma_f32_16x16x32_bf16 v[32:35], v[204:207], v[152:155], v[32:35]
    v_mfma_f32_16x16x32_bf16 v[64:67], v[204:207], v[156:159], v[64:67]
    ds_read_b64_tr_b16 v[176:177], v73 offset:49152
    ds_read_b64_tr_b16 v[178:179], v73 offset:53248
    v_mfma_f32_16x16x32_bf16 v[4:7], v[208:211], v[148:151], v[4:7]
    v_mfma_f32_16x16x32_bf16 v[36:39], v[208:211], v[152:155], v[36:39]
    v_mfma_f32_16x16x32_bf16 v[68:71], v[208:211], v[156:159], v[68:71]
    ds_read_b64_tr_b16 v[180:181], v74 offset:49152
    ds_read_b64_tr_b16 v[182:183], v74 offset:53248
    v_mfma_f32_16x16x32_bf16 v[8:11], v[212:215], v[148:151], v[8:11]
    v_mfma_f32_16x16x32_bf16 v[40:43], v[212:215], v[152:155], v[40:43]
    ds_read_b64_tr_b16 v[184:185], v75 offset:49152
    ds_read_b64_tr_b16 v[186:187], v75 offset:53248
    v_mfma_f32_16x16x32_bf16 v[12:15], v[216:219], v[148:151], v[12:15]
    v_mfma_f32_16x16x32_bf16 v[44:47], v[216:219], v[152:155], v[44:47]
    ds_read_b64_tr_b16 v[188:189], v76 offset:49152
    ds_read_b64_tr_b16 v[190:191], v76 offset:53248
    v_mfma_f32_16x16x32_bf16 v[16:19], v[220:223], v[148:151], v[16:19]
    v_mfma_f32_16x16x32_bf16 v[48:51], v[220:223], v[152:155], v[48:51]
    ds_read_b64_tr_b16 v[192:193], v77 offset:49152
    ds_read_b64_tr_b16 v[194:195], v77 offset:53248
    v_mfma_f32_16x16x32_bf16 v[20:23], v[224:227], v[148:151], v[20:23]
    v_mfma_f32_16x16x32_bf16 v[52:55], v[224:227], v[152:155], v[52:55]
    ds_read_b64_tr_b16 v[196:197], v78 offset:49152
    ds_read_b64_tr_b16 v[198:199], v78 offset:53248
    v_mfma_f32_16x16x32_bf16 v[24:27], v[228:231], v[148:151], v[24:27]
    v_mfma_f32_16x16x32_bf16 v[56:59], v[228:231], v[152:155], v[56:59]
    ds_read_b64_tr_b16 v[200:201], v79 offset:49152
    ds_read_b64_tr_b16 v[202:203], v79 offset:53248
    v_mfma_f32_16x16x32_bf16 v[28:31], v[232:235], v[148:151], v[28:31]
    v_mfma_f32_16x16x32_bf16 v[60:63], v[232:235], v[152:155], v[60:63]
    s_waitcnt vmcnt(27) lgkmcnt(0)
    s_barrier
    s_add_u32 s65, s68, 14
    s_and_b32 s65, s65, 15
    s_mul_i32 s64, s65, 32768
    s_add_u32 s64, s64, s62
    s_add_u32 m0, s63, 49152
    s_nop 0
    buffer_load_dwordx4 v80, s[44:47], s64 offen lds
    s_add_u32 m0, s63, 50176
    s_add_u32 s64, s64, 4096
    buffer_load_dwordx4 v81, s[44:47], s64 offen lds
    s_add_u32 s65, s68, 12
    s_and_b32 s65, s65, 15
    s_lshr_b32 s66, s65, 2
    s_mul_i32 s66, s66, 36864
    s_and_b32 s64, s65, 3
    s_lshl_b32 s64, s64, 10
    s_add_u32 s66, s66, s64
    s_add_u32 s64, s66, s60
    buffer_load_dwordx4 v[148:151], v82, s[48:51], s64 offen
    s_add_u32 s64, s64, 4096
    buffer_load_dwordx4 v[152:155], v82, s[48:51], s64 offen
    s_add_u32 s64, s66, 32768
    buffer_load_dwordx4 v[156:159], v82, s[48:51], s64 offen
    ds_read_b64_tr_b16 v[204:205], v72 offset:57344
    ds_read_b64_tr_b16 v[206:207], v72 offset:61440
    v_mfma_f32_16x16x32_bf16 v[0:3], v[172:175], v[160:163], v[0:3]
    v_mfma_f32_16x16x32_bf16 v[32:35], v[172:175], v[164:167], v[32:35]
    v_mfma_f32_16x16x32_bf16 v[64:67], v[172:175], v[168:171], v[64:67]
    ds_read_b64_tr_b16 v[208:209], v73 offset:57344
    ds_read_b64_tr_b16 v[210:211], v73 offset:61440
    v_mfma_f32_16x16x32_bf16 v[4:7], v[176:179], v[160:163], v[4:7]
    v_mfma_f32_16x16x32_bf16 v[36:39], v[176:179], v[164:167], v[36:39]
    v_mfma_f32_16x16x32_bf16 v[68:71], v[176:179], v[168:171], v[68:71]
    ds_read_b64_tr_b16 v[212:213], v74 offset:57344
    ds_read_b64_tr_b16 v[214:215], v74 offset:61440
    v_mfma_f32_16x16x32_bf16 v[8:11], v[180:183], v[160:163], v[8:11]
    v_mfma_f32_16x16x32_bf16 v[40:43], v[180:183], v[164:167], v[40:43]
    ds_read_b64_tr_b16 v[216:217], v75 offset:57344
    ds_read_b64_tr_b16 v[218:219], v75 offset:61440
    v_mfma_f32_16x16x32_bf16 v[12:15], v[184:187], v[160:163], v[12:15]
    v_mfma_f32_16x16x32_bf16 v[44:47], v[184:187], v[164:167], v[44:47]
    ds_read_b64_tr_b16 v[220:221], v76 offset:57344
    ds_read_b64_tr_b16 v[222:223], v76 offset:61440
    v_mfma_f32_16x16x32_bf16 v[16:19], v[188:191], v[160:163], v[16:19]
    v_mfma_f32_16x16x32_bf16 v[48:51], v[188:191], v[164:167], v[48:51]
    ds_read_b64_tr_b16 v[224:225], v77 offset:57344
    ds_read_b64_tr_b16 v[226:227], v77 offset:61440
    v_mfma_f32_16x16x32_bf16 v[20:23], v[192:195], v[160:163], v[20:23]
    v_mfma_f32_16x16x32_bf16 v[52:55], v[192:195], v[164:167], v[52:55]
    ds_read_b64_tr_b16 v[228:229], v78 offset:57344
    ds_read_b64_tr_b16 v[230:231], v78 offset:61440
    v_mfma_f32_16x16x32_bf16 v[24:27], v[196:199], v[160:163], v[24:27]
    v_mfma_f32_16x16x32_bf16 v[56:59], v[196:199], v[164:167], v[56:59]
    ds_read_b64_tr_b16 v[232:233], v79 offset:57344
    ds_read_b64_tr_b16 v[234:235], v79 offset:61440
    v_mfma_f32_16x16x32_bf16 v[28:31], v[200:203], v[160:163], v[28:31]
    v_mfma_f32_16x16x32_bf16 v[60:63], v[200:203], v[164:167], v[60:63]
    s_waitcnt vmcnt(27) lgkmcnt(0)
    s_barrier
    s_add_u32 s65, s68, 15
    s_and_b32 s65, s65, 15
    s_mul_i32 s64, s65, 32768
    s_add_u32 s64, s64, s62
    s_add_u32 m0, s63, 57344
    s_nop 0
    buffer_load_dwordx4 v80, s[44:47], s64 offen lds
    s_add_u32 m0, s63, 58368
    s_add_u32 s64, s64, 4096
    buffer_load_dwordx4 v81, s[44:47], s64 offen lds
    s_add_u32 s65, s68, 13
    s_and_b32 s65, s65, 15
    s_lshr_b32 s66, s65, 2
    s_mul_i32 s66, s66, 36864
    s_and_b32 s64, s65, 3
    s_lshl_b32 s64, s64, 10
    s_add_u32 s66, s66, s64
    s_add_u32 s64, s66, s60
    buffer_load_dwordx4 v[160:163], v82, s[48:51], s64 offen
    s_add_u32 s64, s64, 4096
    buffer_load_dwordx4 v[164:167], v82, s[48:51], s64 offen
    s_add_u32 s64, s66, 32768
    buffer_load_dwordx4 v[168:171], v82, s[48:51], s64 offen
    ds_read_b64_tr_b16 v[172:173], v72 offset:0
    ds_read_b64_tr_b16 v[174:175], v72 offset:4096
    v_mfma_f32_16x16x32_bf16 v[0:3], v[204:207], v[88:91], v[0:3]
    v_mfma_f32_16x16x32_bf16 v[32:35], v[204:207], v[92:95], v[32:35]
    v_mfma_f32_16x16x32_bf16 v[64:67], v[204:207], v[96:99], v[64:67]
    ds_read_b64_tr_b16 v[176:177], v73 offset:0
    ds_read_b64_tr_b16 v[178:179], v73 offset:4096
    v_mfma_f32_16x16x32_bf16 v[4:7], v[208:211], v[88:91], v[4:7]
    v_mfma_f32_16x16x32_bf16 v[36:39], v[208:211], v[92:95], v[36:39]
    v_mfma_f32_16x16x32_bf16 v[68:71], v[208:211], v[96:99], v[68:71]
    ds_read_b64_tr_b16 v[180:181], v74 offset:0
    ds_read_b64_tr_b16 v[182:183], v74 offset:4096
    v_mfma_f32_16x16x32_bf16 v[8:11], v[212:215], v[88:91], v[8:11]
    v_mfma_f32_16x16x32_bf16 v[40:43], v[212:215], v[92:95], v[40:43]
    ds_read_b64_tr_b16 v[184:185], v75 offset:0
    ds_read_b64_tr_b16 v[186:187], v75 offset:4096
    v_mfma_f32_16x16x32_bf16 v[12:15], v[216:219], v[88:91], v[12:15]
    v_mfma_f32_16x16x32_bf16 v[44:47], v[216:219], v[92:95], v[44:47]
    ds_read_b64_tr_b16 v[188:189], v76 offset:0
    ds_read_b64_tr_b16 v[190:191], v76 offset:4096
    v_mfma_f32_16x16x32_bf16 v[16:19], v[220:223], v[88:91], v[16:19]
    v_mfma_f32_16x16x32_bf16 v[48:51], v[220:223], v[92:95], v[48:51]
    ds_read_b64_tr_b16 v[192:193], v77 offset:0
    ds_read_b64_tr_b16 v[194:195], v77 offset:4096
    v_mfma_f32_16x16x32_bf16 v[20:23], v[224:227], v[88:91], v[20:23]
    v_mfma_f32_16x16x32_bf16 v[52:55], v[224:227], v[92:95], v[52:55]
    ds_read_b64_tr_b16 v[196:197], v78 offset:0
    ds_read_b64_tr_b16 v[198:199], v78 offset:4096
    v_mfma_f32_16x16x32_bf16 v[24:27], v[228:231], v[88:91], v[24:27]
    v_mfma_f32_16x16x32_bf16 v[56:59], v[228:231], v[92:95], v[56:59]
    ds_read_b64_tr_b16 v[200:201], v79 offset:0
    ds_read_b64_tr_b16 v[202:203], v79 offset:4096
    v_mfma_f32_16x16x32_bf16 v[28:31], v[232:235], v[88:91], v[28:31]
    v_mfma_f32_16x16x32_bf16 v[60:63], v[232:235], v[92:95], v[60:63]
    s_waitcnt vmcnt(27) lgkmcnt(0)
    s_barrier
    s_add_u32 s65, s68, 14
    s_and_b32 s65, s65, 15
    s_lshr_b32 s66, s65, 2
    s_mul_i32 s66, s66, 36864
    s_and_b32 s64, s65, 3
    s_lshl_b32 s64, s64, 10
    s_add_u32 s66, s66, s64
    s_add_u32 s64, s66, s60
    buffer_load_dwordx4 v[88:91], v82, s[48:51], s64 offen
    s_add_u32 s64, s64, 4096
    buffer_load_dwordx4 v[92:95], v82, s[48:51], s64 offen
    s_add_u32 s64, s66, 32768
    buffer_load_dwordx4 v[96:99], v82, s[48:51], s64 offen
    ds_read_b64_tr_b16 v[204:205], v72 offset:8192
    ds_read_b64_tr_b16 v[206:207], v72 offset:12288
    v_mfma_f32_16x16x32_bf16 v[0:3], v[172:175], v[100:103], v[0:3]
    v_mfma_f32_16x16x32_bf16 v[32:35], v[172:175], v[104:107], v[32:35]
    v_mfma_f32_16x16x32_bf16 v[64:67], v[172:175], v[108:111], v[64:67]
    ds_read_b64_tr_b16 v[208:209], v73 offset:8192
    ds_read_b64_tr_b16 v[210:211], v73 offset:12288
    v_mfma_f32_16x16x32_bf16 v[4:7], v[176:179], v[100:103], v[4:7]
    v_mfma_f32_16x16x32_bf16 v[36:39], v[176:179], v[104:107], v[36:39]
    v_mfma_f32_16x16x32_bf16 v[68:71], v[176:179], v[108:111], v[68:71]
    ds_read_b64_tr_b16 v[212:213], v74 offset:8192
    ds_read_b64_tr_b16 v[214:215], v74 offset:12288
    v_mfma_f32_16x16x32_bf16 v[8:11], v[180:183], v[100:103], v[8:11]
    v_mfma_f32_16x16x32_bf16 v[40:43], v[180:183], v[104:107], v[40:43]
    ds_read_b64_tr_b16 v[216:217], v75 offset:8192
    ds_read_b64_tr_b16 v[218:219], v75 offset:12288
    v_mfma_f32_16x16x32_bf16 v[12:15], v[184:187], v[100:103], v[12:15]
    v_mfma_f32_16x16x32_bf16 v[44:47], v[184:187], v[104:107], v[44:47]
    ds_read_b64_tr_b16 v[220:221], v76 offset:8192
    ds_read_b64_tr_b16 v[222:223], v76 offset:12288
    v_mfma_f32_16x16x32_bf16 v[16:19], v[188:191], v[100:103], v[16:19]
    v_mfma_f32_16x16x32_bf16 v[48:51], v[188:191], v[104:107], v[48:51]
    ds_read_b64_tr_b16 v[224:225], v77 offset:8192
    ds_read_b64_tr_b16 v[226:227], v77 offset:12288
    v_mfma_f32_16x16x32_bf16 v[20:23], v[192:195], v[100:103], v[20:23]
    v_mfma_f32_16x16x32_bf16 v[52:55], v[192:195], v[104:107], v[52:55]
    ds_read_b64_tr_b16 v[228:229], v78 offset:8192
    ds_read_b64_tr_b16 v[230:231], v78 offset:12288
    v_mfma_f32_16x16x32_bf16 v[24:27], v[196:199], v[100:103], v[24:27]
    v_mfma_f32_16x16x32_bf16 v[56:59], v[196:199], v[104:107], v[56:59]
    ds_read_b64_tr_b16 v[232:233], v79 offset:8192
    ds_read_b64_tr_b16 v[234:235], v79 offset:12288
    v_mfma_f32_16x16x32_bf16 v[28:31], v[200:203], v[100:103], v[28:31]
    v_mfma_f32_16x16x32_bf16 v[60:63], v[200:203], v[104:107], v[60:63]
    s_waitcnt vmcnt(23) lgkmcnt(0)
    s_barrier
    s_add_u32 s65, s68, 15
    s_and_b32 s65, s65, 15
    s_lshr_b32 s66, s65, 2
    s_mul_i32 s66, s66, 36864
    s_and_b32 s64, s65, 3
    s_lshl_b32 s64, s64, 10
    s_add_u32 s66, s66, s64
    s_add_u32 s64, s66, s60
    buffer_load_dwordx4 v[100:103], v82, s[48:51], s64 offen
    s_add_u32 s64, s64, 4096
    buffer_load_dwordx4 v[104:107], v82, s[48:51], s64 offen
    s_add_u32 s64, s66, 32768
    buffer_load_dwordx4 v[108:111], v82, s[48:51], s64 offen
    ds_read_b64_tr_b16 v[172:173], v72 offset:16384
    ds_read_b64_tr_b16 v[174:175], v72 offset:20480
    v_mfma_f32_16x16x32_bf16 v[0:3], v[204:207], v[112:115], v[0:3]
    v_mfma_f32_16x16x32_bf16 v[32:35], v[204:207], v[116:119], v[32:35]
    v_mfma_f32_16x16x32_bf16 v[64:67], v[204:207], v[120:123], v[64:67]
    ds_read_b64_tr_b16 v[176:177], v73 offset:16384
    ds_read_b64_tr_b16 v[178:179], v73 offset:20480
    v_mfma_f32_16x16x32_bf16 v[4:7], v[208:211], v[112:115], v[4:7]
    v_mfma_f32_16x16x32_bf16 v[36:39], v[208:211], v[116:119], v[36:39]
    v_mfma_f32_16x16x32_bf16 v[68:71], v[208:211], v[120:123], v[68:71]
    ds_read_b64_tr_b16 v[180:181], v74 offset:16384
    ds_read_b64_tr_b16 v[182:183], v74 offset:20480
    v_mfma_f32_16x16x32_bf16 v[8:11], v[212:215], v[112:115], v[8:11]
    v_mfma_f32_16x16x32_bf16 v[40:43], v[212:215], v[116:119], v[40:43]
    ds_read_b64_tr_b16 v[184:185], v75 offset:16384
    ds_read_b64_tr_b16 v[186:187], v75 offset:20480
    v_mfma_f32_16x16x32_bf16 v[12:15], v[216:219], v[112:115], v[12:15]
    v_mfma_f32_16x16x32_bf16 v[44:47], v[216:219], v[116:119], v[44:47]
    ds_read_b64_tr_b16 v[188:189], v76 offset:16384
    ds_read_b64_tr_b16 v[190:191], v76 offset:20480
    v_mfma_f32_16x16x32_bf16 v[16:19], v[220:223], v[112:115], v[16:19]
    v_mfma_f32_16x16x32_bf16 v[48:51], v[220:223], v[116:119], v[48:51]
    ds_read_b64_tr_b16 v[192:193], v77 offset:16384
    ds_read_b64_tr_b16 v[194:195], v77 offset:20480
    v_mfma_f32_16x16x32_bf16 v[20:23], v[224:227], v[112:115], v[20:23]
    v_mfma_f32_16x16x32_bf16 v[52:55], v[224:227], v[116:119], v[52:55]
    ds_read_b64_tr_b16 v[196:197], v78 offset:16384
    ds_read_b64_tr_b16 v[198:199], v78 offset:20480
    v_mfma_f32_16x16x32_bf16 v[24:27], v[228:231], v[112:115], v[24:27]
    v_mfma_f32_16x16x32_bf16 v[56:59], v[228:231], v[116:119], v[56:59]
    ds_read_b64_tr_b16 v[200:201], v79 offset:16384
    ds_read_b64_tr_b16 v[202:203], v79 offset:20480
    v_mfma_f32_16x16x32_bf16 v[28:31], v[232:235], v[112:115], v[28:31]
    v_mfma_f32_16x16x32_bf16 v[60:63], v[232:235], v[116:119], v[60:63]
    s_waitcnt vmcnt(21) lgkmcnt(0)
    s_barrier
    ds_read_b64_tr_b16 v[204:205], v72 offset:24576
    ds_read_b64_tr_b16 v[206:207], v72 offset:28672
    v_mfma_f32_16x16x32_bf16 v[0:3], v[172:175], v[124:127], v[0:3]
    v_mfma_f32_16x16x32_bf16 v[32:35], v[172:175], v[128:131], v[32:35]
    v_mfma_f32_16x16x32_bf16 v[64:67], v[172:175], v[132:135], v[64:67]
    ds_read_b64_tr_b16 v[208:209], v73 offset:24576
    ds_read_b64_tr_b16 v[210:211], v73 offset:28672
    v_mfma_f32_16x16x32_bf16 v[4:7], v[176:179], v[124:127], v[4:7]
    v_mfma_f32_16x16x32_bf16 v[36:39], v[176:179], v[128:131], v[36:39]
    v_mfma_f32_16x16x32_bf16 v[68:71], v[176:179], v[132:135], v[68:71]
    ds_read_b64_tr_b16 v[212:213], v74 offset:24576
    ds_read_b64_tr_b16 v[214:215], v74 offset:28672
    v_mfma_f32_16x16x32_bf16 v[8:11], v[180:183], v[124:127], v[8:11]
    v_mfma_f32_16x16x32_bf16 v[40:43], v[180:183], v[128:131], v[40:43]
    ds_read_b64_tr_b16 v[216:217], v75 offset:24576
    ds_read_b64_tr_b16 v[218:219], v75 offset:28672
    v_mfma_f32_16x16x32_bf16 v[12:15], v[184:187], v[124:127], v[12:15]
    v_mfma_f32_16x16x32_bf16 v[44:47], v[184:187], v[128:131], v[44:47]
    ds_read_b64_tr_b16 v[220:221], v76 offset:24576
    ds_read_b64_tr_b16 v[222:223], v76 offset:28672
    v_mfma_f32_16x16x32_bf16 v[16:19], v[188:191], v[124:127], v[16:19]
    v_mfma_f32_16x16x32_bf16 v[48:51], v[188:191], v[128:131], v[48:51]
    ds_read_b64_tr_b16 v[224:225], v77 offset:24576
    ds_read_b64_tr_b16 v[226:227], v77 offset:28672
    v_mfma_f32_16x16x32_bf16 v[20:23], v[192:195], v[124:127], v[20:23]
    v_mfma_f32_16x16x32_bf16 v[52:55], v[192:195], v[128:131], v[52:55]
    ds_read_b64_tr_b16 v[228:229], v78 offset:24576
    ds_read_b64_tr_b16 v[230:231], v78 offset:28672
    v_mfma_f32_16x16x32_bf16 v[24:27], v[196:199], v[124:127], v[24:27]
    v_mfma_f32_16x16x32_bf16 v[56:59], v[196:199], v[128:131], v[56:59]
    ds_read_b64_tr_b16 v[232:233], v79 offset:24576
    ds_read_b64_tr_b16 v[234:235], v79 offset:28672
    v_mfma_f32_16x16x32_bf16 v[28:31], v[200:203], v[124:127], v[28:31]
    v_mfma_f32_16x16x32_bf16 v[60:63], v[200:203], v[128:131], v[60:63]
    s_waitcnt vmcnt(16) lgkmcnt(0)
    s_barrier
    ds_read_b64_tr_b16 v[172:173], v72 offset:32768
    ds_read_b64_tr_b16 v[174:175], v72 offset:36864
    v_mfma_f32_16x16x32_bf16 v[0:3], v[204:207], v[136:139], v[0:3]
    v_mfma_f32_16x16x32_bf16 v[32:35], v[204:207], v[140:143], v[32:35]
    v_mfma_f32_16x16x32_bf16 v[64:67], v[204:207], v[144:147], v[64:67]
    ds_read_b64_tr_b16 v[176:177], v73 offset:32768
    ds_read_b64_tr_b16 v[178:179], v73 offset:36864
    v_mfma_f32_16x16x32_bf16 v[4:7], v[208:211], v[136:139], v[4:7]
    v_mfma_f32_16x16x32_bf16 v[36:39], v[208:211], v[140:143], v[36:39]
    v_mfma_f32_16x16x32_bf16 v[68:71], v[208:211], v[144:147], v[68:71]
    ds_read_b64_tr_b16 v[180:181], v74 offset:32768
    ds_read_b64_tr_b16 v[182:183], v74 offset:36864
    v_mfma_f32_16x16x32_bf16 v[8:11], v[212:215], v[136:139], v[8:11]
    v_mfma_f32_16x16x32_bf16 v[40:43], v[212:215], v[140:143], v[40:43]
    ds_read_b64_tr_b16 v[184:185], v75 offset:32768
    ds_read_b64_tr_b16 v[186:187], v75 offset:36864
    v_mfma_f32_16x16x32_bf16 v[12:15], v[216:219], v[136:139], v[12:15]
    v_mfma_f32_16x16x32_bf16 v[44:47], v[216:219], v[140:143], v[44:47]
    ds_read_b64_tr_b16 v[188:189], v76 offset:32768
    ds_read_b64_tr_b16 v[190:191], v76 offset:36864
    v_mfma_f32_16x16x32_bf16 v[16:19], v[220:223], v[136:139], v[16:19]
    v_mfma_f32_16x16x32_bf16 v[48:51], v[220:223], v[140:143], v[48:51]
    ds_read_b64_tr_b16 v[192:193], v77 offset:32768
    ds_read_b64_tr_b16 v[194:195], v77 offset:36864
    v_mfma_f32_16x16x32_bf16 v[20:23], v[224:227], v[136:139], v[20:23]
    v_mfma_f32_16x16x32_bf16 v[52:55], v[224:227], v[140:143], v[52:55]
    ds_read_b64_tr_b16 v[196:197], v78 offset:32768
    ds_read_b64_tr_b16 v[198:199], v78 offset:36864
    v_mfma_f32_16x16x32_bf16 v[24:27], v[228:231], v[136:139], v[24:27]
    v_mfma_f32_16x16x32_bf16 v[56:59], v[228:231], v[140:143], v[56:59]
    ds_read_b64_tr_b16 v[200:201], v79 offset:32768
    ds_read_b64_tr_b16 v[202:203], v79 offset:36864
    v_mfma_f32_16x16x32_bf16 v[28:31], v[232:235], v[136:139], v[28:31]
    v_mfma_f32_16x16x32_bf16 v[60:63], v[232:235], v[140:143], v[60:63]
    s_waitcnt vmcnt(11) lgkmcnt(0)
    s_barrier
    ds_read_b64_tr_b16 v[204:205], v72 offset:40960
    ds_read_b64_tr_b16 v[206:207], v72 offset:45056
    v_mfma_f32_16x16x32_bf16 v[0:3], v[172:175], v[148:151], v[0:3]
    v_mfma_f32_16x16x32_bf16 v[32:35], v[172:175], v[152:155], v[32:35]
    v_mfma_f32_16x16x32_bf16 v[64:67], v[172:175], v[156:159], v[64:67]
    ds_read_b64_tr_b16 v[208:209], v73 offset:40960
    ds_read_b64_tr_b16 v[210:211], v73 offset:45056
    v_mfma_f32_16x16x32_bf16 v[4:7], v[176:179], v[148:151], v[4:7]
    v_mfma_f32_16x16x32_bf16 v[36:39], v[176:179], v[152:155], v[36:39]
    v_mfma_f32_16x16x32_bf16 v[68:71], v[176:179], v[156:159], v[68:71]
    ds_read_b64_tr_b16 v[212:213], v74 offset:40960
    ds_read_b64_tr_b16 v[214:215], v74 offset:45056
    v_mfma_f32_16x16x32_bf16 v[8:11], v[180:183], v[148:151], v[8:11]
    v_mfma_f32_16x16x32_bf16 v[40:43], v[180:183], v[152:155], v[40:43]
    ds_read_b64_tr_b16 v[216:217], v75 offset:40960
    ds_read_b64_tr_b16 v[218:219], v75 offset:45056
    v_mfma_f32_16x16x32_bf16 v[12:15], v[184:187], v[148:151], v[12:15]
    v_mfma_f32_16x16x32_bf16 v[44:47], v[184:187], v[152:155], v[44:47]
    ds_read_b64_tr_b16 v[220:221], v76 offset:40960
    ds_read_b64_tr_b16 v[222:223], v76 offset:45056
    v_mfma_f32_16x16x32_bf16 v[16:19], v[188:191], v[148:151], v[16:19]
    v_mfma_f32_16x16x32_bf16 v[48:51], v[188:191], v[152:155], v[48:51]
    ds_read_b64_tr_b16 v[224:225], v77 offset:40960
    ds_read_b64_tr_b16 v[226:227], v77 offset:45056
    v_mfma_f32_16x16x32_bf16 v[20:23], v[192:195], v[148:151], v[20:23]
    v_mfma_f32_16x16x32_bf16 v[52:55], v[192:195], v[152:155], v[52:55]
    ds_read_b64_tr_b16 v[228:229], v78 offset:40960
    ds_read_b64_tr_b16 v[230:231], v78 offset:45056
    v_mfma_f32_16x16x32_bf16 v[24:27], v[196:199], v[148:151], v[24:27]
    v_mfma_f32_16x16x32_bf16 v[56:59], v[196:199], v[152:155], v[56:59]
    ds_read_b64_tr_b16 v[232:233], v79 offset:40960
    ds_read_b64_tr_b16 v[234:235], v79 offset:45056
    v_mfma_f32_16x16x32_bf16 v[28:31], v[200:203], v[148:151], v[28:31]
    v_mfma_f32_16x16x32_bf16 v[60:63], v[200:203], v[152:155], v[60:63]
    s_waitcnt vmcnt(6) lgkmcnt(0)
    s_barrier
    ds_read_b64_tr_b16 v[172:173], v72 offset:49152
    ds_read_b64_tr_b16 v[174:175], v72 offset:53248
    v_mfma_f32_16x16x32_bf16 v[0:3], v[204:207], v[160:163], v[0:3]
    v_mfma_f32_16x16x32_bf16 v[32:35], v[204:207], v[164:167], v[32:35]
    v_mfma_f32_16x16x32_bf16 v[64:67], v[204:207], v[168:171], v[64:67]
    ds_read_b64_tr_b16 v[176:177], v73 offset:49152
    ds_read_b64_tr_b16 v[178:179], v73 offset:53248
    v_mfma_f32_16x16x32_bf16 v[4:7], v[208:211], v[160:163], v[4:7]
    v_mfma_f32_16x16x32_bf16 v[36:39], v[208:211], v[164:167], v[36:39]
    v_mfma_f32_16x16x32_bf16 v[68:71], v[208:211], v[168:171], v[68:71]
    ds_read_b64_tr_b16 v[180:181], v74 offset:49152
    ds_read_b64_tr_b16 v[182:183], v74 offset:53248
    v_mfma_f32_16x16x32_bf16 v[8:11], v[212:215], v[160:163], v[8:11]
    v_mfma_f32_16x16x32_bf16 v[40:43], v[212:215], v[164:167], v[40:43]
    ds_read_b64_tr_b16 v[184:185], v75 offset:49152
    ds_read_b64_tr_b16 v[186:187], v75 offset:53248
    v_mfma_f32_16x16x32_bf16 v[12:15], v[216:219], v[160:163], v[12:15]
    v_mfma_f32_16x16x32_bf16 v[44:47], v[216:219], v[164:167], v[44:47]
    ds_read_b64_tr_b16 v[188:189], v76 offset:49152
    ds_read_b64_tr_b16 v[190:191], v76 offset:53248
    v_mfma_f32_16x16x32_bf16 v[16:19], v[220:223], v[160:163], v[16:19]
    v_mfma_f32_16x16x32_bf16 v[48:51], v[220:223], v[164:167], v[48:51]
    ds_read_b64_tr_b16 v[192:193], v77 offset:49152
    ds_read_b64_tr_b16 v[194:195], v77 offset:53248
    v_mfma_f32_16x16x32_bf16 v[20:23], v[224:227], v[160:163], v[20:23]
    v_mfma_f32_16x16x32_bf16 v[52:55], v[224:227], v[164:167], v[52:55]
    ds_read_b64_tr_b16 v[196:197], v78 offset:49152
    ds_read_b64_tr_b16 v[198:199], v78 offset:53248
    v_mfma_f32_16x16x32_bf16 v[24:27], v[228:231], v[160:163], v[24:27]
    v_mfma_f32_16x16x32_bf16 v[56:59], v[228:231], v[164:167], v[56:59]
    ds_read_b64_tr_b16 v[200:201], v79 offset:49152
    ds_read_b64_tr_b16 v[202:203], v79 offset:53248
    v_mfma_f32_16x16x32_bf16 v[28:31], v[232:235], v[160:163], v[28:31]
    v_mfma_f32_16x16x32_bf16 v[60:63], v[232:235], v[164:167], v[60:63]
    s_waitcnt vmcnt(3) lgkmcnt(0)
    s_barrier
    ds_read_b64_tr_b16 v[204:205], v72 offset:57344
    ds_read_b64_tr_b16 v[206:207], v72 offset:61440
    v_mfma_f32_16x16x32_bf16 v[0:3], v[172:175], v[88:91], v[0:3]
    v_mfma_f32_16x16x32_bf16 v[32:35], v[172:175], v[92:95], v[32:35]
    v_mfma_f32_16x16x32_bf16 v[64:67], v[172:175], v[96:99], v[64:67]
    ds_read_b64_tr_b16 v[208:209], v73 offset:57344
    ds_read_b64_tr_b16 v[210:211], v73 offset:61440
    v_mfma_f32_16x16x32_bf16 v[4:7], v[176:179], v[88:91], v[4:7]
    v_mfma_f32_16x16x32_bf16 v[36:39], v[176:179], v[92:95], v[36:39]
    v_mfma_f32_16x16x32_bf16 v[68:71], v[176:179], v[96:99], v[68:71]
    ds_read_b64_tr_b16 v[212:213], v74 offset:57344
    ds_read_b64_tr_b16 v[214:215], v74 offset:61440
    v_mfma_f32_16x16x32_bf16 v[8:11], v[180:183], v[88:91], v[8:11]
    v_mfma_f32_16x16x32_bf16 v[40:43], v[180:183], v[92:95], v[40:43]
    ds_read_b64_tr_b16 v[216:217], v75 offset:57344
    ds_read_b64_tr_b16 v[218:219], v75 offset:61440
    v_mfma_f32_16x16x32_bf16 v[12:15], v[184:187], v[88:91], v[12:15]
    v_mfma_f32_16x16x32_bf16 v[44:47], v[184:187], v[92:95], v[44:47]
    ds_read_b64_tr_b16 v[220:221], v76 offset:57344
    ds_read_b64_tr_b16 v[222:223], v76 offset:61440
    v_mfma_f32_16x16x32_bf16 v[16:19], v[188:191], v[88:91], v[16:19]
    v_mfma_f32_16x16x32_bf16 v[48:51], v[188:191], v[92:95], v[48:51]
    ds_read_b64_tr_b16 v[224:225], v77 offset:57344
    ds_read_b64_tr_b16 v[226:227], v77 offset:61440
    v_mfma_f32_16x16x32_bf16 v[20:23], v[192:195], v[88:91], v[20:23]
    v_mfma_f32_16x16x32_bf16 v[52:55], v[192:195], v[92:95], v[52:55]
    ds_read_b64_tr_b16 v[228:229], v78 offset:57344
    ds_read_b64_tr_b16 v[230:231], v78 offset:61440
    v_mfma_f32_16x16x32_bf16 v[24:27], v[196:199], v[88:91], v[24:27]
    v_mfma_f32_16x16x32_bf16 v[56:59], v[196:199], v[92:95], v[56:59]
    ds_read_b64_tr_b16 v[232:233], v79 offset:57344
    ds_read_b64_tr_b16 v[234:235], v79 offset:61440
    v_mfma_f32_16x16x32_bf16 v[28:31], v[200:203], v[88:91], v[28:31]
    v_mfma_f32_16x16x32_bf16 v[60:63], v[200:203], v[92:95], v[60:63]
    s_waitcnt vmcnt(0) lgkmcnt(0)
    s_barrier
    v_mfma_f32_16x16x32_bf16 v[0:3], v[204:207], v[100:103], v[0:3]
    v_mfma_f32_16x16x32_bf16 v[32:35], v[204:207], v[104:107], v[32:35]
    v_mfma_f32_16x16x32_bf16 v[64:67], v[204:207], v[108:111], v[64:67]
    v_mfma_f32_16x16x32_bf16 v[4:7], v[208:211], v[100:103], v[4:7]
    v_mfma_f32_16x16x32_bf16 v[36:39], v[208:211], v[104:107], v[36:39]
    v_mfma_f32_16x16x32_bf16 v[68:71], v[208:211], v[108:111], v[68:71]
    v_mfma_f32_16x16x32_bf16 v[8:11], v[212:215], v[100:103], v[8:11]
    v_mfma_f32_16x16x32_bf16 v[40:43], v[212:215], v[104:107], v[40:43]
    v_mfma_f32_16x16x32_bf16 v[12:15], v[216:219], v[100:103], v[12:15]
    v_mfma_f32_16x16x32_bf16 v[44:47], v[216:219], v[104:107], v[44:47]
    v_mfma_f32_16x16x32_bf16 v[16:19], v[220:223], v[100:103], v[16:19]
    v_mfma_f32_16x16x32_bf16 v[48:51], v[220:223], v[104:107], v[48:51]
    v_mfma_f32_16x16x32_bf16 v[20:23], v[224:227], v[100:103], v[20:23]
    v_mfma_f32_16x16x32_bf16 v[52:55], v[224:227], v[104:107], v[52:55]
    v_mfma_f32_16x16x32_bf16 v[24:27], v[228:231], v[100:103], v[24:27]
    v_mfma_f32_16x16x32_bf16 v[56:59], v[228:231], v[104:107], v[56:59]
    v_mfma_f32_16x16x32_bf16 v[28:31], v[232:235], v[100:103], v[28:31]
    v_mfma_f32_16x16x32_bf16 v[60:63], v[232:235], v[104:107], v[60:63]
    s_barrier
    v_lshlrev_b32 v238, 4, v254
    s_mul_i32 s35, s40, 9216
    v_add_u32 v239, s35, v238
    s_xor_b32 s36, s40, 4
    s_mul_i32 s36, s36, 9216
    v_add_u32 v240, s36, v238
    s_cmp_eq_u32 s39, 0
    s_cbranch_scc0 L2_grB
    ds_write_b128 v239, v[36:39] offset:0
    ds_write_b128 v239, v[40:43] offset:1024
    ds_write_b128 v239, v[44:47] offset:2048
    ds_write_b128 v239, v[48:51] offset:3072
    ds_write_b128 v239, v[52:55] offset:4096
    ds_write_b128 v239, v[56:59] offset:5120
    ds_write_b128 v239, v[60:63] offset:6144
    ds_write_b128 v239, v[64:67] offset:7168
    ds_write_b128 v239, v[68:71] offset:8192
    s_waitcnt lgkmcnt(0)
    s_barrier
    ds_read_b128 v[96:99], v240 offset:0
    ds_read_b128 v[100:103], v240 offset:1024
    ds_read_b128 v[104:107], v240 offset:2048
    ds_read_b128 v[108:111], v240 offset:3072
    ds_read_b128 v[112:115], v240 offset:4096
    ds_read_b128 v[116:119], v240 offset:5120
    ds_read_b128 v[120:123], v240 offset:6144
    ds_read_b128 v[124:127], v240 offset:7168
    ds_read_b128 v[128:131], v240 offset:8192
    s_waitcnt lgkmcnt(0)
    v_add_f32 v96, v96, v0
    v_add_f32 v97, v97, v1
    v_add_f32 v98, v98, v2
    v_add_f32 v99, v99, v3
    v_add_f32 v100, v100, v4
    v_add_f32 v101, v101, v5
    v_add_f32 v102, v102, v6
    v_add_f32 v103, v103, v7
    v_add_f32 v104, v104, v8
    v_add_f32 v105, v105, v9
    v_add_f32 v106, v106, v10
    v_add_f32 v107, v107, v11
    v_add_f32 v108, v108, v12
    v_add_f32 v109, v109, v13
    v_add_f32 v110, v110, v14
    v_add_f32 v111, v111, v15
    v_add_f32 v112, v112, v16
    v_add_f32 v113, v113, v17
    v_add_f32 v114, v114, v18
    v_add_f32 v115, v115, v19
    v_add_f32 v116, v116, v20
    v_add_f32 v117, v117, v21
    v_add_f32 v118, v118, v22
    v_add_f32 v119, v119, v23
    v_add_f32 v120, v120, v24
    v_add_f32 v121, v121, v25
    v_add_f32 v122, v122, v26
    v_add_f32 v123, v123, v27
    v_add_f32 v124, v124, v28
    v_add_f32 v125, v125, v29
    v_add_f32 v126, v126, v30
    v_add_f32 v127, v127, v31
    v_add_f32 v128, v128, v32
    v_add_f32 v129, v129, v33
    v_add_f32 v130, v130, v34
    v_add_f32 v131, v131, v35
    s_nop 1
    s_branch L2_join
L2_grB:
    ds_write_b128 v239, v[0:3] offset:0
    ds_write_b128 v239, v[4:7] offset:1024
    ds_write_b128 v239, v[8:11] offset:2048
    ds_write_b128 v239, v[12:15] offset:3072
    ds_write_b128 v239, v[16:19] offset:4096
    ds_write_b128 v239, v[20:23] offset:5120
    ds_write_b128 v239, v[24:27] offset:6144
    ds_write_b128 v239, v[28:31] offset:7168
    ds_write_b128 v239, v[32:35] offset:8192
    s_waitcnt lgkmcnt(0)
    s_barrier
    ds_read_b128 v[96:99], v240 offset:0
    ds_read_b128 v[100:103], v240 offset:1024
    ds_read_b128 v[104:107], v240 offset:2048
    ds_read_b128 v[108:111], v240 offset:3072
    ds_read_b128 v[112:115], v240 offset:4096
    ds_read_b128 v[116:119], v240 offset:5120
    ds_read_b128 v[120:123], v240 offset:6144
    ds_read_b128 v[124:127], v240 offset:7168
    ds_read_b128 v[128:131], v240 offset:8192
    s_waitcnt lgkmcnt(0)
    v_add_f32 v96, v96, v36
    v_add_f32 v97, v97, v37
    v_add_f32 v98, v98, v38
    v_add_f32 v99, v99, v39
    v_add_f32 v100, v100, v40
    v_add_f32 v101, v101, v41
    v_add_f32 v102, v102, v42
    v_add_f32 v103, v103, v43
    v_add_f32 v104, v104, v44
    v_add_f32 v105, v105, v45
    v_add_f32 v106, v106, v46
    v_add_f32 v107, v107, v47
    v_add_f32 v108, v108, v48
    v_add_f32 v109, v109, v49
    v_add_f32 v110, v110, v50
    v_add_f32 v111, v111, v51
    v_add_f32 v112, v112, v52
    v_add_f32 v113, v113, v53
    v_add_f32 v114, v114, v54
    v_add_f32 v115, v115, v55
    v_add_f32 v116, v116, v56
    v_add_f32 v117, v117, v57
    v_add_f32 v118, v118, v58
    v_add_f32 v119, v119, v59
    v_add_f32 v120, v120, v60
    v_add_f32 v121, v121, v61
    v_add_f32 v122, v122, v62
    v_add_f32 v123, v123, v63
    v_add_f32 v124, v124, v64
    v_add_f32 v125, v125, v65
    v_add_f32 v126, v126, v66
    v_add_f32 v127, v127, v67
    v_add_f32 v128, v128, v68
    v_add_f32 v129, v129, v69
    v_add_f32 v130, v130, v70
    v_add_f32 v131, v131, v71
    s_nop 1
L2_join:
    s_mov_b32 s35, 0
    v_cvt_pk_bf16_f32 v0, v96, v97
    v_cvt_pk_bf16_f32 v1, v98, v99
    v_cvt_pk_bf16_f32 v2, v100, v101
    v_cvt_pk_bf16_f32 v3, v102, v103
    buffer_store_dwordx4 v[0:3], v238, s[52:55], s35 offen offset:0 sc1
    v_cvt_pk_bf16_f32 v4, v104, v105
    v_cvt_pk_bf16_f32 v5, v106, v107
    v_cvt_pk_bf16_f32 v6, v108, v109
    v_cvt_pk_bf16_f32 v7, v110, v111
    buffer_store_dwordx4 v[4:7], v238, s[52:55], s35 offen offset:1024 sc1
    v_cvt_pk_bf16_f32 v8, v112, v113
    v_cvt_pk_bf16_f32 v9, v114, v115
    v_cvt_pk_bf16_f32 v10, v116, v117
    v_cvt_pk_bf16_f32 v11, v118, v119
    buffer_store_dwordx4 v[8:11], v238, s[52:55], s35 offen offset:2048 sc1
    v_cvt_pk_bf16_f32 v12, v120, v121
    v_cvt_pk_bf16_f32 v13, v122, v123
    v_cvt_pk_bf16_f32 v14, v124, v125
    v_cvt_pk_bf16_f32 v15, v126, v127
    buffer_store_dwordx4 v[12:15], v238, s[52:55], s35 offen offset:3072 sc1
    v_cvt_pk_bf16_f32 v16, v128, v129
    v_cvt_pk_bf16_f32 v17, v130, v131
    s_mov_b32 s35, 4096
    buffer_store_dwordx4 v[16:19], v238, s[52:55], s35 offen offset:0 sc1
    s_nop 1
L2_done:
    s_endpgm
.globl reduce_kernel
.p2align 8
.type reduce_kernel,@function
reduce_kernel:
    s_cmp_ge_u32 s2, 640
    s_cbranch_scc1 L3_done
    s_load_dwordx2 s[24:25], s[0:1], 80
    s_load_dwordx2 s[28:29], s[0:1], 96
    v_lshrrev_b32 v1, 6, v0
    v_and_b32 v2, 63, v0
    v_readfirstlane_b32 s30, v1
    s_lshl_b32 s31, s2, 2
    s_add_u32 s30, s30, s31
    s_mul_hi_u32 s31, s30, 107374183
    s_mul_i32 s32, s31, 40
    s_sub_u32 s32, s30, s32
    s_mul_hi_u32 s33, s32, 858993460
    s_mul_i32 s34, s33, 5
    s_sub_u32 s34, s32, s34
    s_mul_i32 s35, s31, 163840
    s_lshl_b32 s36, s32, 10
    s_add_u32 s35, s35, s36
    s_add_u32 s35, s35, 18874368
    s_waitcnt lgkmcnt(0)
    s_add_u32 s40, s28, s35
    s_addc_u32 s41, s29, 0
    s_and_b32 s41, s41, 0xffff
    s_mov_b32 s42, 123904
    s_mov_b32 s43, 0x00020000
    v_lshlrev_b32 v3, 4, v2
    s_mov_b32 s48, 0
    buffer_load_dwordx4 v[40:43], v3, s[40:43], s48 offen
    s_mov_b32 s49, 40960
    buffer_load_dwordx4 v[44:47], v3, s[40:43], s49 offen
    s_mov_b32 s50, 81920
    buffer_load_dwordx4 v[48:51], v3, s[40:43], s50 offen
    s_mov_b32 s51, 122880
    buffer_load_dwordx4 v[52:55], v3, s[40:43], s51 offen
    s_lshr_b32 s52, s31, 5
    s_lshr_b32 s53, s31, 2
    s_and_b32 s53, s53, 7
    s_and_b32 s54, s31, 3
    s_mul_i32 s53, s53, 294912
    s_lshl_b32 s52, s52, 10
    s_lshl_b32 s54, s54, 8
    s_add_u32 s53, s53, s52
    s_add_u32 s53, s53, s54
    s_and_b32 s37, s33, 3
    s_lshl_b32 s37, s37, 1
    s_lshr_b32 s55, s33, 2
    s_mul_i32 s55, s55, 9
    s_lshl_b32 s56, s34, 1
    s_add_u32 s55, s55, s56
    s_add_u32 s36, s55, 0
    s_lshr_b32 s38, s36, 3
    s_add_u32 s39, s37, s38
    s_cmp_ge_u32 s36, 16
    s_cselect_b32 s39, 8, s39
    s_and_b32 s36, s36, 7
    s_xor_b32 s36, s36, s37
    s_lshl_b32 s39, s39, 15
    s_lshl_b32 s36, s36, 5
    s_add_u32 s57, s53, s39
    s_add_u32 s57, s57, s36
    s_add_u32 s36, s55, 1
    s_lshr_b32 s38, s36, 3
    s_add_u32 s39, s37, s38
    s_cmp_ge_u32 s36, 16
    s_cselect_b32 s39, 8, s39
    s_and_b32 s36, s36, 7
    s_xor_b32 s36, s36, s37
    s_lshl_b32 s39, s39, 15
    s_lshl_b32 s36, s36, 5
    s_add_u32 s58, s53, s39
    s_add_u32 s58, s58, s36
    s_cmp_eq_u32 s34, 4
    s_cselect_b32 s58, 0x7ff00000, s58
    s_mov_b32 s59, 0
    s_add_u32 s44, s24, s59
    s_addc_u32 s45, s25, 0
    s_and_b32 s45, s45, 0xffff
    s_mov_b32 s46, 2359296
    s_mov_b32 s47, 0x00020000
    v_and_b32 v1, 15, v2
    v_lshlrev_b32 v1, 11, v1
    v_lshrrev_b32 v2, 4, v2
    v_lshl_add_u32 v1, v2, 3, v1
    s_waitcnt vmcnt(0)
    v_lshlrev_b32 v4, 16, v40
    v_and_b32 v5, 0xffff0000, v40
    v_lshlrev_b32 v6, 16, v41
    v_and_b32 v7, 0xffff0000, v41
    v_lshlrev_b32 v8, 16, v42
    v_and_b32 v9, 0xffff0000, v42
    v_lshlrev_b32 v10, 16, v43
    v_and_b32 v11, 0xffff0000, v43
    v_lshlrev_b32 v12, 16, v44
    v_and_b32 v13, 0xffff0000, v44
    v_lshlrev_b32 v14, 16, v45
    v_and_b32 v15, 0xffff0000, v45
    v_lshlrev_b32 v16, 16, v46
    v_and_b32 v17, 0xffff0000, v46
    v_lshlrev_b32 v18, 16, v47
    v_and_b32 v19, 0xffff0000, v47
    v_lshlrev_b32 v20, 16, v48
    v_and_b32 v21, 0xffff0000, v48
    v_lshlrev_b32 v22, 16, v49
    v_and_b32 v23, 0xffff0000, v49
    v_lshlrev_b32 v24, 16, v50
    v_and_b32 v25, 0xffff0000, v50
    v_lshlrev_b32 v26, 16, v51
    v_and_b32 v27, 0xffff0000, v51
    v_lshlrev_b32 v28, 16, v52
    v_and_b32 v29, 0xffff0000, v52
    v_lshlrev_b32 v30, 16, v53
    v_and_b32 v31, 0xffff0000, v53
    v_lshlrev_b32 v32, 16, v54
    v_and_b32 v33, 0xffff0000, v54
    v_lshlrev_b32 v34, 16, v55
    v_and_b32 v35, 0xffff0000, v55
    v_add_f32 v4, v4, v12
    v_add_f32 v20, v20, v28
    v_add_f32 v5, v5, v13
    v_add_f32 v21, v21, v29
    v_add_f32 v6, v6, v14
    v_add_f32 v22, v22, v30
    v_add_f32 v7, v7, v15
    v_add_f32 v23, v23, v31
    v_add_f32 v8, v8, v16
    v_add_f32 v24, v24, v32
    v_add_f32 v9, v9, v17
    v_add_f32 v25, v25, v33
    v_add_f32 v10, v10, v18
    v_add_f32 v26, v26, v34
    v_add_f32 v11, v11, v19
    v_add_f32 v27, v27, v35
    v_add_f32 v4, v4, v20
    v_add_f32 v5, v5, v21
    v_add_f32 v6, v6, v22
    v_add_f32 v7, v7, v23
    v_add_f32 v8, v8, v24
    v_add_f32 v9, v9, v25
    v_add_f32 v10, v10, v26
    v_add_f32 v11, v11, v27
    v_cvt_pk_bf16_f32 v36, v4, v5
    v_cvt_pk_bf16_f32 v37, v6, v7
    v_cvt_pk_bf16_f32 v38, v8, v9
    v_cvt_pk_bf16_f32 v39, v10, v11
    buffer_store_dwordx2 v[36:37], v1, s[44:47], s57 offen
    buffer_store_dwordx2 v[38:39], v1, s[44:47], s58 offen
L3_done:
    s_endpgm
.section .rodata,"a"
.p2align 6
.amdhsa_kernel attn_kernel
  .amdhsa_next_free_vgpr 256
  .amdhsa_next_free_sgpr 76
  .amdhsa_accum_offset 256
  .amdhsa_group_segment_fixed_size 0
  .amdhsa_kernarg_size 104
  .amdhsa_user_sgpr_count 2
  .amdhsa_user_sgpr_kernarg_segment_ptr 1
  .amdhsa_system_sgpr_workgroup_id_x 1
.end_amdhsa_kernel
.p2align 6
.amdhsa_kernel oproj_kernel
  .amdhsa_next_free_vgpr 256
  .amdhsa_next_free_sgpr 74
  .amdhsa_accum_offset 256
  .amdhsa_group_segment_fixed_size 0
  .amdhsa_kernarg_size 104
  .amdhsa_user_sgpr_count 2
  .amdhsa_user_sgpr_kernarg_segment_ptr 1
  .amdhsa_system_sgpr_workgroup_id_x 1
.end_amdhsa_kernel
.p2align 6
.amdhsa_kernel reduce_kernel
  .amdhsa_next_free_vgpr 56
  .amdhsa_next_free_sgpr 64
  .amdhsa_accum_offset 56
  .amdhsa_group_segment_fixed_size 0
  .amdhsa_kernarg_size 104
  .amdhsa_user_sgpr_count 2
  .amdhsa_user_sgpr_kernarg_segment_ptr 1
  .amdhsa_system_sgpr_workgroup_id_x 1
.end_amdhsa_kernel
```
